```python
import torch

def _softmax(x, axis=-1):
    return torch.softmax(x, dim=axis)
def _gelu(x):
    return torch.nn.functional.gelu(x, approximate="tanh")
def _silu(x):
    return torch.nn.functional.silu(x)
def _sigmoid(x):
    return torch.sigmoid(x)
def _layernorm(x, axis=-1, eps=1e-5):
    m = x.mean(dim=axis, keepdim=True)
    v = x.var(dim=axis, keepdim=True, unbiased=False)
    return (x - m) / torch.sqrt(v + eps)
def _scatter_add(tgt, idx, src, axis=0):
    return tgt.clone().index_add_(axis, idx, src)
def _segment_sum(src, seg, n):
    out = torch.zeros((n,) + src.shape[1:], dtype=src.dtype)
    return out.index_add_(0, seg, src)
def _pad(x, pw):
    flat = tuple(v for pair in reversed(pw) for v in pair)
    return torch.nn.functional.pad(x, flat)

kernel_name = 'recurrent_scan__sliding_block_cached__dense_activation_squared_relu__prompt'

def setup_inputs():

    _w = (lambda a: (lambda t: t.to(torch.bfloat16) if t.is_floating_point() else t)(torch.as_tensor(a)))
    def _A_setup():
        B, Sq, D = 1, 2048, 512
        Hq, Hkv, Sk, Dh = 32, 8, 2048, 128
        assert Hq % Hkv == 0, (Hq, Hkv)
        return {
            "x": _w((lambda *s: torch.randn(*s, dtype=torch.bfloat16) * 0.05)(B, Sq, D)),
            "k_cache": _w((lambda *s: torch.randn(*s, dtype=torch.bfloat16) * 0.8)(B, Hkv, Sk, Dh)),
            "v_cache": _w((lambda *s: torch.randn(*s, dtype=torch.bfloat16) * 0.2)(B, Hkv, Sk, Dh)),
            "wq": _w((lambda *s: torch.randn(*s, dtype=torch.bfloat16) * 0.8)(D, Hq * Dh) * (D ** -0.5)),
            "wo": _w((lambda *s: torch.randn(*s, dtype=torch.bfloat16) * 0.2)(Hq * Dh, D) * ((Hq * Dh) ** -0.5)),
        }
    _A_in = _A_setup()

    def _B_setup():
        B, S, D, F = 1, 2048, 512, 1792
        return {
            "x": _w((lambda *s: torch.randn(*s, dtype=torch.bfloat16) * 0.05)(B, S, D)),
            "w1": _w((lambda *s: torch.randn(*s, dtype=torch.bfloat16) * 0.1)(D, F)),
            "b1": _w((lambda *s: torch.randn(*s, dtype=torch.bfloat16) * 0.4)(F)),
            "w2": _w((lambda *s: torch.randn(*s, dtype=torch.bfloat16) * 0.1)(F, D)),
            "b2": _w((lambda *s: torch.randn(*s, dtype=torch.bfloat16) * 6.4)(D)),
        }
    _B_in = _B_setup()

    return {
        "A_x": _A_in["x"],
        "A_k_cache": _A_in["k_cache"],
        "A_v_cache": _A_in["v_cache"],
        "A_wq": _A_in["wq"],
        "A_wo": _A_in["wo"],
        "B_x": _B_in["x"],
        "B_w1": _B_in["w1"],
        "B_b1": _B_in["b1"],
        "B_w2": _B_in["w2"],
        "B_b2": _B_in["b2"],
    }

def reference(A_x, A_k_cache, A_v_cache, A_wq, A_wo, B_x, B_w1, B_b1, B_w2, B_b2):
    def _A_ref(x, k_cache, v_cache, wq, wo):
        B, Sq, D = x.shape
        Hq, Dh = 32, 128
        Hkv, Sk = k_cache.shape[1], k_cache.shape[2]
        W = min(4096, max(256, Sk // 4))
        rep = Hq // Hkv
        q = (lambda x, *d: x.permute(*d))((x @ wq).reshape(B, Sq, Hq, Dh), 0, 2, 1, 3)
        k = (lambda x, n, axis: torch.repeat_interleave(x, n, dim=axis))(k_cache[:, :, Sk - W:, :], rep, axis=1)
        v = (lambda x, n, axis: torch.repeat_interleave(x, n, dim=axis))(v_cache[:, :, Sk - W:, :], rep, axis=1)
        scores = torch.einsum("bhqd,bhkd->bhqk", q, k) * (Dh ** -0.5)
        p = _softmax(scores, axis=-1)
        o = torch.einsum("bhqk,bhkd->bhqd", p, v)
        return (lambda x, *d: x.permute(*d))(o, 0, 2, 1, 3).reshape(B, Sq, Hq * Dh) @ wo

    def _B_ref(x, w1, b1, w2, b2):
        h = torch.einsum("bsd,df->bsf", x, w1) + b1
        zero = torch.zeros_like(h)
        r = torch.where(h > zero, h, zero)
        h = r * r
        out = torch.einsum("bsf,fd->bsd", h, w2) + b2
        return out

    x = A_x
    xn = _layernorm(x, axis=-1)
    s = _A_ref(xn, A_k_cache, A_v_cache, A_wq, A_wo)
    g = _silu(_B_ref(xn, B_w1, B_b1, B_w2, B_b2))
    return x + s * g
```

```asm
; @launch grid=(256,1,1) block=(256,1,1) lds=163840
.amdgcn_target "amdgcn-amd-amdhsa--gfx950"
.text
.p2align 12
.p2align 8
.globl recurrent_scan__sliding_block_cached__dense_activation_squared_relu__prompt_kernel
.type recurrent_scan__sliding_block_cached__dense_activation_squared_relu__prompt_kernel,@function
recurrent_scan__sliding_block_cached__dense_activation_squared_relu__prompt_kernel:
    s_cmp_ge_u32 s2, 256
    s_cbranch_scc1 L_main_end
    s_mov_b32 s54, 0
    v_mov_b32 v32, 0
    v_mov_b32 v33, 0
    v_mov_b32 v34, 0
    v_mov_b32 v35, 0
L_restart:
    s_load_dwordx8 s[60:67], s[0:1], 0
    s_load_dwordx2 s[68:69], s[0:1], 32
    s_load_dwordx4 s[88:91], s[0:1], 48
    s_load_dwordx8 s[92:99], s[0:1], 64
    s_load_dwordx2 s[58:59], s[0:1], 96
    s_getpc_b64 s[100:101]
L_pc:
    s_sub_u32 s100, s100, L_pc-recurrent_scan__sliding_block_cached__dense_activation_squared_relu__prompt_kernel
    s_subb_u32 s101, s101, 0
    s_bfe_u32 s46, s2, 0x30003
    s_lshl_b32 s46, s46, 14
    v_lshlrev_b32 v50, 6, v0
    v_add_u32 v50, s46, v50
    v_min_u32 v50, L_code_end-recurrent_scan__sliding_block_cached__dense_activation_squared_relu__prompt_kernel-4, v50
    v_mov_b32 v51, s101
    v_add_co_u32 v50, vcc, s100, v50
    s_nop 1
    v_addc_co_u32 v51, vcc, 0, v51, vcc
    global_load_dword v49, v[50:51], off
    v_lshrrev_b32 v130, 6, v0
    v_and_b32 v1, 63, v0
    s_and_b32 s41, s2, 3
    s_lshl_b32 s41, s41, 1
    s_bfe_u32 s46, s2, 65539
    s_or_b32 s41, s41, s46
    s_lshr_b32 s57, s2, 4
    s_bfe_u32 s42, s2, 65538
    s_lshl_b32 s42, s42, 4
    s_or_b32 s42, s42, s57
    v_readfirstlane_b32 s40, v130
    v_bfe_u32 v128, v0, 3, 3
    v_lshl_add_u32 v131, v130, 4, v128
    v_and_b32 v129, 7, v0
    v_lshlrev_b32 v140, 4, v129
    v_lshl_add_u32 v140, v131, 10, v140
    v_add_u32 v141, 8192, v140
    s_and_b32 s56, s57, 7
    s_mul_i32 s56, s56, 1
    s_lshl_b32 s8, s56, 7
    s_add_u32 s9, s8, 128
    s_and_b32 s9, s9, 1023
    s_add_u32 s10, s8, 256
    s_and_b32 s10, s10, 1023
    s_add_u32 s11, s8, 384
    s_and_b32 s11, s11, 1023
    s_add_u32 s12, s8, 512
    s_and_b32 s12, s12, 1023
    s_add_u32 s13, s8, 640
    s_and_b32 s13, s13, 1023
    s_add_u32 s14, s8, 768
    s_and_b32 s14, s14, 1023
    s_add_u32 s15, s8, 896
    s_and_b32 s15, s15, 1023
    s_lshl_b32 s56, s56, 19
    s_bfe_u32 s46, s42, 0x10004
    s_lshl_b32 s46, s46, 7
    s_add_u32 s56, s56, s46
    s_and_b32 s57, s57, 0
    s_lshl_b32 s57, s57, 13
    s_or_b32 s46, s41, s40
    s_or_b32 s46, s46, s54
    s_cmp_eq_u32 s46, 0
    s_cselect_b32 s52, 0, 1073741824
    v_lshlrev_b32 v135, 8, v128
    v_lshl_add_u32 v135, v129, 2, v135
    v_add_u32 v135, s52, v135
    v_mov_b32 v136, 0
    v_mov_b32 v36, s52
    v_mov_b32 v37, 1
    s_mul_i32 s43, s40, 24576
    s_add_u32 s43, s43, 65536
    s_lshl_b32 s50, s40, 11
    s_mov_b32 s51, 0xffff0000
    v_lshrrev_b32 v132, 4, v1
    v_lshlrev_b32 v132, 1, v132
    v_xor_b32 v133, v129, v132
    v_lshlrev_b32 v131, 4, v133
    v_lshrrev_b32 v130, 5, v1
    v_and_b32 v132, 3, v128
    v_lshl_add_u32 v130, v130, 3, v132
    v_mul_u32_u24 v132, 3584, v130
    s_lshl_b32 s55, s40, 7
    v_add3_u32 v44, v132, v131, s55
    v_lshl_add_u32 v28, v128, 8, v131
    s_lshl_b32 s46, s40, 8
    v_add_u32 v131, s46, v131
    v_lshl_add_u32 v40, v130, 13, v131
    v_lshl_add_u32 v14, v128, 10, v131
    s_and_b32 s46, s41, 1
    s_xor_b32 s46, s46, 1
    s_mul_i32 s46, s46, 7
    s_lshl_b32 s53, s40, 1
    v_lshrrev_b32 v133, 2, v133
    v_or_b32 v133, s53, v133
    v_cmp_eq_u32 vcc, s46, v133
    v_mov_b32 v132, 1073741824
    s_nop 0
    v_cndmask_b32 v44, v44, v132, vcc
    v_add_u32 v41, 130048, v40
    v_add_u32 v42, 30720, v40
    v_add_u32 v43, 160768, v40
    v_xor_b32 v130, v128, v129
    v_and_b32 v131, 3, v129
    v_lshl_add_u32 v130, v131, 4, v130
    v_lshlrev_b32 v130, 4, v130
    v_lshrrev_b32 v131, 2, v129
    v_lshl_add_u32 v130, v131, 12, v130
    s_lshl_b32 s46, s40, 10
    v_add_u32 v58, s46, v130
    s_lshl_b32 s46, s42, 16
    s_lshl_b32 s47, s42, 12
    s_add_u32 s47, s47, 50331648
    s_lshr_b32 s53, s41, 1
    s_mul_i32 s53, s53, 896
    s_and_b32 s52, s41, 1
    s_mul_i32 s52, s52, 384
    s_add_u32 s53, s53, s52
    s_waitcnt lgkmcnt(0)
    s_add_u32 s4, s60, s46
    s_addc_u32 s5, s61, 0
    s_mov_b32 s6, 65536
    s_mov_b32 s7, 0x00020000
    buffer_load_dwordx4 v[64:67], v140, s[4:7], s8 offen
    s_add_u32 s32, s90, s53
    s_addc_u32 s33, s91, 0
    s_sub_u32 s34, 3584, s53
    s_mov_b32 s35, 0x00020000
    s_add_u32 s36, s58, s47
    s_addc_u32 s37, s59, 0
    s_mov_b32 s38, 1024
    buffer_load_dwordx4 v[96:99], v141, s[4:7], s8 offen
    s_mov_b32 s39, 0x00020000
    buffer_store_dword v136, v135, s[36:39], 0 offen sc1
    s_add_u32 s24, s88, s53
    s_addc_u32 s25, s89, 0
    s_sub_u32 s26, 1835008, s53
    s_mov_b32 s27, 0x00020000
    buffer_load_dwordx4 v[68:71], v140, s[4:7], s9 offen
    v_lshrrev_b32 v130, 2, v1
    v_lshlrev_b32 v130, 7, v130
    v_bfe_u32 v131, v1, 3, 2
    v_and_b32 v132, 3, v1
    v_lshl_add_u32 v133, v132, 3, v130
    buffer_load_dwordx4 v[100:103], v141, s[4:7], s9 offen
    v_xor_b32 v134, 0, v131
    v_lshl_add_u32 v22, v134, 5, v133
    v_add_u32 v2, s43, v22
    v_xor_b32 v134, 1, v131
    v_lshl_add_u32 v23, v134, 5, v133
    buffer_load_dwordx4 v[72:75], v140, s[4:7], s10 offen
    v_add_u32 v3, s43, v23
    v_xor_b32 v134, 2, v131
    v_lshl_add_u32 v24, v134, 5, v133
    v_add_u32 v4, s43, v24
    v_xor_b32 v134, 3, v131
    buffer_load_dwordx4 v[104:107], v141, s[4:7], s10 offen
    v_lshl_add_u32 v25, v134, 5, v133
    v_add_u32 v5, s43, v25
    v_and_b32 v133, 1, v1
    v_lshl_add_u32 v133, v133, 4, v130
    v_add_u32 v133, s43, v133
    buffer_load_dwordx4 v[76:79], v140, s[4:7], s11 offen
    v_lshrrev_b32 v132, 1, v132
    v_xor_b32 v132, v132, v131
    v_xor_b32 v134, 0, v132
    v_lshl_add_u32 v12, v134, 5, v133
    v_xor_b32 v134, 2, v132
    buffer_load_dwordx4 v[108:111], v141, s[4:7], s11 offen
    v_lshl_add_u32 v13, v134, 5, v133
    v_lshrrev_b32 v131, 4, v1
    v_xor_b32 v131, v131, v1
    v_lshlrev_b32 v6, 4, v131
    v_xor_b32 v7, 64, v6
    buffer_load_dwordx4 v[80:83], v140, s[4:7], s12 offen
    v_lshrrev_b32 v133, 4, v0
    v_and_b32 v134, 15, v0
    v_lshlrev_b32 v60, 6, v134
    v_lshl_add_u32 v60, v133, 13, v60
    v_lshlrev_b32 v62, 4, v0
    buffer_load_dwordx4 v[112:115], v141, s[4:7], s12 offen
    v_lshlrev_b32 v63, 5, v0
    v_mul_u32_u24 v133, 3584, v133
    v_lshl_add_u32 v61, v134, 5, v133
    s_lshl_b32 s46, s41, 10
    s_add_u32 s16, s66, s46
    s_addc_u32 s17, s67, 0
    buffer_load_dwordx4 v[84:87], v140, s[4:7], s13 offen
    s_sub_u32 s18, 4194304, s46
    s_mov_b32 s19, 0x00020000
    s_lshl_b32 s46, s41, 19
    s_add_u32 s20, s68, s46
    s_addc_u32 s21, s69, 0
    s_sub_u32 s22, 4194304, s46
    buffer_load_dwordx4 v[116:119], v141, s[4:7], s13 offen
    s_mov_b32 s23, 0x00020000
    s_mul_i32 s52, s41, 229376
    s_add_u32 s28, s92, s52
    s_addc_u32 s29, s93, 0
    s_sub_u32 s30, 1835008, s52
    s_mov_b32 s31, 0x00020000
    buffer_load_dwordx4 v[88:91], v140, s[4:7], s14 offen
    v_add_u32 v45, 56320, v44
    v_add_u32 v15, 7168, v14
    v_add_u32 v46, 12288, v44
    v_add_u32 v16, 14336, v14
    v_add_u32 v47, 68608, v44
    buffer_load_dwordx4 v[120:123], v141, s[4:7], s14 offen
    v_add_u32 v17, 21504, v14
    buffer_load_dwordx4 v[92:95], v140, s[4:7], s15 offen
    buffer_load_dwordx4 v[124:127], v141, s[4:7], s15 offen
    v_lshrrev_b32 v137, 4, v1
    v_lshlrev_b32 v137, 3, v137
    s_lshl_b32 s45, s40, 7
    buffer_load_dwordx2 v[192:193], v137, s[32:35], s45 offen offset:0
    buffer_load_dwordx2 v[194:195], v137, s[32:35], s45 offen offset:32
    buffer_load_dwordx2 v[196:197], v137, s[32:35], s45 offen offset:64
    buffer_load_dwordx2 v[198:199], v137, s[32:35], s45 offen offset:96
    s_add_u32 s46, s46, 393216
    s_add_u32 s8, s62, s46
    s_addc_u32 s9, s63, 0
    s_mov_b32 s10, 131072
    s_mov_b32 s11, 0x00020000
    s_add_u32 s12, s64, s46
    s_addc_u32 s13, s65, 0
    s_mov_b32 s14, 131072
    s_mov_b32 s15, 0x00020000
    s_add_u32 s60, s58, s47
    s_addc_u32 s61, s59, 0
    s_mov_b32 s62, 1024
    s_mov_b32 s63, 0x00020000
    s_lshl_b32 s46, s42, 2
    s_add_u32 s64, s98, s46
    s_addc_u32 s65, s99, 0
    s_mov_b32 s66, 4
    s_mov_b32 s67, 0x00020000
    s_mov_b64 exec, 0
    s_cmp_eq_u32 s40, 0
    s_cbranch_scc1 L_pg0
    s_cmp_eq_u32 s40, 1
    s_cbranch_scc1 L_pg1
    s_cmp_eq_u32 s40, 2
    s_cbranch_scc1 L_pg2
    s_branch L_pg3
L_pgret:
    s_mov_b64 exec, -1
    s_waitcnt vmcnt(20)
    v_lshlrev_b32 v128, 16, v64
    v_and_b32 v64, s51, v64
    v_lshlrev_b32 v129, 16, v65
    v_and_b32 v65, s51, v65
    v_lshlrev_b32 v130, 16, v66
    v_and_b32 v66, s51, v66
    v_lshlrev_b32 v131, 16, v67
    v_and_b32 v67, s51, v67
    v_pk_add_f32 v[50:51], v[128:129], v[64:65]
    v_pk_mul_f32 v[54:55], v[128:129], v[128:129]
    v_pk_fma_f32 v[54:55], v[64:65], v[64:65], v[54:55]
    v_pk_add_f32 v[50:51], v[50:51], v[130:131]
    v_pk_fma_f32 v[54:55], v[130:131], v[130:131], v[54:55]
    v_pk_add_f32 v[50:51], v[50:51], v[66:67]
    v_pk_fma_f32 v[54:55], v[66:67], v[66:67], v[54:55]
    s_waitcnt vmcnt(19)
    v_lshlrev_b32 v160, 16, v96
    v_and_b32 v96, s51, v96
    v_lshlrev_b32 v161, 16, v97
    v_and_b32 v97, s51, v97
    v_lshlrev_b32 v162, 16, v98
    v_and_b32 v98, s51, v98
    v_lshlrev_b32 v163, 16, v99
    v_and_b32 v99, s51, v99
    v_pk_add_f32 v[52:53], v[160:161], v[96:97]
    v_pk_mul_f32 v[56:57], v[160:161], v[160:161]
    v_pk_fma_f32 v[56:57], v[96:97], v[96:97], v[56:57]
    v_pk_add_f32 v[52:53], v[52:53], v[162:163]
    v_pk_fma_f32 v[56:57], v[162:163], v[162:163], v[56:57]
    v_pk_add_f32 v[52:53], v[52:53], v[98:99]
    v_pk_fma_f32 v[56:57], v[98:99], v[98:99], v[56:57]
    s_waitcnt vmcnt(17)
    v_lshlrev_b32 v132, 16, v68
    v_and_b32 v68, s51, v68
    v_lshlrev_b32 v133, 16, v69
    v_and_b32 v69, s51, v69
    v_lshlrev_b32 v134, 16, v70
    v_and_b32 v70, s51, v70
    v_lshlrev_b32 v135, 16, v71
    v_and_b32 v71, s51, v71
    v_pk_add_f32 v[50:51], v[50:51], v[132:133]
    v_pk_fma_f32 v[54:55], v[132:133], v[132:133], v[54:55]
    v_pk_add_f32 v[50:51], v[50:51], v[68:69]
    v_pk_fma_f32 v[54:55], v[68:69], v[68:69], v[54:55]
    v_pk_add_f32 v[50:51], v[50:51], v[134:135]
    v_pk_fma_f32 v[54:55], v[134:135], v[134:135], v[54:55]
    v_pk_add_f32 v[50:51], v[50:51], v[70:71]
    v_pk_fma_f32 v[54:55], v[70:71], v[70:71], v[54:55]
    s_waitcnt vmcnt(16)
    v_lshlrev_b32 v164, 16, v100
    v_and_b32 v100, s51, v100
    v_lshlrev_b32 v165, 16, v101
    v_and_b32 v101, s51, v101
    v_lshlrev_b32 v166, 16, v102
    v_and_b32 v102, s51, v102
    v_lshlrev_b32 v167, 16, v103
    v_and_b32 v103, s51, v103
    v_pk_add_f32 v[52:53], v[52:53], v[164:165]
    v_pk_fma_f32 v[56:57], v[164:165], v[164:165], v[56:57]
    v_pk_add_f32 v[52:53], v[52:53], v[100:101]
    v_pk_fma_f32 v[56:57], v[100:101], v[100:101], v[56:57]
    v_pk_add_f32 v[52:53], v[52:53], v[166:167]
    v_pk_fma_f32 v[56:57], v[166:167], v[166:167], v[56:57]
    v_pk_add_f32 v[52:53], v[52:53], v[102:103]
    v_pk_fma_f32 v[56:57], v[102:103], v[102:103], v[56:57]
    s_waitcnt vmcnt(15)
    v_lshlrev_b32 v136, 16, v72
    v_and_b32 v72, s51, v72
    v_lshlrev_b32 v137, 16, v73
    v_and_b32 v73, s51, v73
    v_lshlrev_b32 v138, 16, v74
    v_and_b32 v74, s51, v74
    v_lshlrev_b32 v139, 16, v75
    v_and_b32 v75, s51, v75
    v_pk_add_f32 v[50:51], v[50:51], v[136:137]
    v_pk_fma_f32 v[54:55], v[136:137], v[136:137], v[54:55]
    v_pk_add_f32 v[50:51], v[50:51], v[72:73]
    v_pk_fma_f32 v[54:55], v[72:73], v[72:73], v[54:55]
    v_pk_add_f32 v[50:51], v[50:51], v[138:139]
    v_pk_fma_f32 v[54:55], v[138:139], v[138:139], v[54:55]
    v_pk_add_f32 v[50:51], v[50:51], v[74:75]
    v_pk_fma_f32 v[54:55], v[74:75], v[74:75], v[54:55]
    s_add_u32 m0, s43, 0
    s_add_u32 s44, s56, 0
    s_and_b32 s44, s44, 4194047
    buffer_load_dwordx4 v40, s[16:19], s44 offen offset:0 lds
    s_waitcnt vmcnt(15)
    v_lshlrev_b32 v168, 16, v104
    v_and_b32 v104, s51, v104
    v_lshlrev_b32 v169, 16, v105
    v_and_b32 v105, s51, v105
    v_lshlrev_b32 v170, 16, v106
    v_and_b32 v106, s51, v106
    v_lshlrev_b32 v171, 16, v107
    v_and_b32 v107, s51, v107
    v_pk_add_f32 v[52:53], v[52:53], v[168:169]
    v_pk_fma_f32 v[56:57], v[168:169], v[168:169], v[56:57]
    v_pk_add_f32 v[52:53], v[52:53], v[104:105]
    v_pk_fma_f32 v[56:57], v[104:105], v[104:105], v[56:57]
    v_pk_add_f32 v[52:53], v[52:53], v[170:171]
    v_pk_fma_f32 v[56:57], v[170:171], v[170:171], v[56:57]
    v_pk_add_f32 v[52:53], v[52:53], v[106:107]
    v_pk_fma_f32 v[56:57], v[106:107], v[106:107], v[56:57]
    buffer_load_dwordx4 v41, s[16:19], s44 offen offset:1024 lds
    s_waitcnt vmcnt(15)
    v_lshlrev_b32 v140, 16, v76
    v_and_b32 v76, s51, v76
    v_lshlrev_b32 v141, 16, v77
    v_and_b32 v77, s51, v77
    v_lshlrev_b32 v142, 16, v78
    v_and_b32 v78, s51, v78
    v_lshlrev_b32 v143, 16, v79
    v_and_b32 v79, s51, v79
    v_pk_add_f32 v[50:51], v[50:51], v[140:141]
    v_pk_fma_f32 v[54:55], v[140:141], v[140:141], v[54:55]
    v_pk_add_f32 v[50:51], v[50:51], v[76:77]
    v_pk_fma_f32 v[54:55], v[76:77], v[76:77], v[54:55]
    v_pk_add_f32 v[50:51], v[50:51], v[142:143]
    v_pk_fma_f32 v[54:55], v[142:143], v[142:143], v[54:55]
    v_pk_add_f32 v[50:51], v[50:51], v[78:79]
    v_pk_fma_f32 v[54:55], v[78:79], v[78:79], v[54:55]
    buffer_load_dwordx4 v42, s[16:19], s44 offen offset:2048 lds
    s_waitcnt vmcnt(15)
    v_lshlrev_b32 v172, 16, v108
    v_and_b32 v108, s51, v108
    v_lshlrev_b32 v173, 16, v109
    v_and_b32 v109, s51, v109
    v_lshlrev_b32 v174, 16, v110
    v_and_b32 v110, s51, v110
    v_lshlrev_b32 v175, 16, v111
    v_and_b32 v111, s51, v111
    v_pk_add_f32 v[52:53], v[52:53], v[172:173]
    v_pk_fma_f32 v[56:57], v[172:173], v[172:173], v[56:57]
    v_pk_add_f32 v[52:53], v[52:53], v[108:109]
    v_pk_fma_f32 v[56:57], v[108:109], v[108:109], v[56:57]
    v_pk_add_f32 v[52:53], v[52:53], v[174:175]
    v_pk_fma_f32 v[56:57], v[174:175], v[174:175], v[56:57]
    v_pk_add_f32 v[52:53], v[52:53], v[110:111]
    v_pk_fma_f32 v[56:57], v[110:111], v[110:111], v[56:57]
    buffer_load_dwordx4 v43, s[16:19], s44 offen offset:3072 lds
    s_waitcnt vmcnt(15)
    v_lshlrev_b32 v144, 16, v80
    v_and_b32 v80, s51, v80
    v_lshlrev_b32 v145, 16, v81
    v_and_b32 v81, s51, v81
    v_lshlrev_b32 v146, 16, v82
    v_and_b32 v82, s51, v82
    v_lshlrev_b32 v147, 16, v83
    v_and_b32 v83, s51, v83
    v_pk_add_f32 v[50:51], v[50:51], v[144:145]
    v_pk_fma_f32 v[54:55], v[144:145], v[144:145], v[54:55]
    v_pk_add_f32 v[50:51], v[50:51], v[80:81]
    v_pk_fma_f32 v[54:55], v[80:81], v[80:81], v[54:55]
    v_pk_add_f32 v[50:51], v[50:51], v[146:147]
    v_pk_fma_f32 v[54:55], v[146:147], v[146:147], v[54:55]
    v_pk_add_f32 v[50:51], v[50:51], v[82:83]
    v_pk_fma_f32 v[54:55], v[82:83], v[82:83], v[54:55]
    s_add_u32 m0, s43, 4096
    s_add_u32 s44, s56, 262144
    s_and_b32 s44, s44, 4194047
    buffer_load_dwordx4 v40, s[16:19], s44 offen offset:0 lds
    s_waitcnt vmcnt(15)
    v_lshlrev_b32 v176, 16, v112
    v_and_b32 v112, s51, v112
    v_lshlrev_b32 v177, 16, v113
    v_and_b32 v113, s51, v113
    v_lshlrev_b32 v178, 16, v114
    v_and_b32 v114, s51, v114
    v_lshlrev_b32 v179, 16, v115
    v_and_b32 v115, s51, v115
    v_pk_add_f32 v[52:53], v[52:53], v[176:177]
    v_pk_fma_f32 v[56:57], v[176:177], v[176:177], v[56:57]
    v_pk_add_f32 v[52:53], v[52:53], v[112:113]
    v_pk_fma_f32 v[56:57], v[112:113], v[112:113], v[56:57]
    v_pk_add_f32 v[52:53], v[52:53], v[178:179]
    v_pk_fma_f32 v[56:57], v[178:179], v[178:179], v[56:57]
    v_pk_add_f32 v[52:53], v[52:53], v[114:115]
    v_pk_fma_f32 v[56:57], v[114:115], v[114:115], v[56:57]
    buffer_load_dwordx4 v41, s[16:19], s44 offen offset:1024 lds
    s_waitcnt vmcnt(15)
    v_lshlrev_b32 v148, 16, v84
    v_and_b32 v84, s51, v84
    v_lshlrev_b32 v149, 16, v85
    v_and_b32 v85, s51, v85
    v_lshlrev_b32 v150, 16, v86
    v_and_b32 v86, s51, v86
    v_lshlrev_b32 v151, 16, v87
    v_and_b32 v87, s51, v87
    v_pk_add_f32 v[50:51], v[50:51], v[148:149]
    v_pk_fma_f32 v[54:55], v[148:149], v[148:149], v[54:55]
    v_pk_add_f32 v[50:51], v[50:51], v[84:85]
    v_pk_fma_f32 v[54:55], v[84:85], v[84:85], v[54:55]
    v_pk_add_f32 v[50:51], v[50:51], v[150:151]
    v_pk_fma_f32 v[54:55], v[150:151], v[150:151], v[54:55]
    v_pk_add_f32 v[50:51], v[50:51], v[86:87]
    v_pk_fma_f32 v[54:55], v[86:87], v[86:87], v[54:55]
    buffer_load_dwordx4 v42, s[16:19], s44 offen offset:2048 lds
    s_waitcnt vmcnt(15)
    v_lshlrev_b32 v180, 16, v116
    v_and_b32 v116, s51, v116
    v_lshlrev_b32 v181, 16, v117
    v_and_b32 v117, s51, v117
    v_lshlrev_b32 v182, 16, v118
    v_and_b32 v118, s51, v118
    v_lshlrev_b32 v183, 16, v119
    v_and_b32 v119, s51, v119
    v_pk_add_f32 v[52:53], v[52:53], v[180:181]
    v_pk_fma_f32 v[56:57], v[180:181], v[180:181], v[56:57]
    v_pk_add_f32 v[52:53], v[52:53], v[116:117]
    v_pk_fma_f32 v[56:57], v[116:117], v[116:117], v[56:57]
    v_pk_add_f32 v[52:53], v[52:53], v[182:183]
    v_pk_fma_f32 v[56:57], v[182:183], v[182:183], v[56:57]
    v_pk_add_f32 v[52:53], v[52:53], v[118:119]
    v_pk_fma_f32 v[56:57], v[118:119], v[118:119], v[56:57]
    buffer_load_dwordx4 v43, s[16:19], s44 offen offset:3072 lds
    s_waitcnt vmcnt(15)
    v_lshlrev_b32 v152, 16, v88
    v_and_b32 v88, s51, v88
    v_lshlrev_b32 v153, 16, v89
    v_and_b32 v89, s51, v89
    v_lshlrev_b32 v154, 16, v90
    v_and_b32 v90, s51, v90
    v_lshlrev_b32 v155, 16, v91
    v_and_b32 v91, s51, v91
    v_pk_add_f32 v[50:51], v[50:51], v[152:153]
    v_pk_fma_f32 v[54:55], v[152:153], v[152:153], v[54:55]
    v_pk_add_f32 v[50:51], v[50:51], v[88:89]
    v_pk_fma_f32 v[54:55], v[88:89], v[88:89], v[54:55]
    v_pk_add_f32 v[50:51], v[50:51], v[154:155]
    v_pk_fma_f32 v[54:55], v[154:155], v[154:155], v[54:55]
    v_pk_add_f32 v[50:51], v[50:51], v[90:91]
    v_pk_fma_f32 v[54:55], v[90:91], v[90:91], v[54:55]
    s_add_u32 m0, s43, 8192
    s_add_u32 s44, s56, 524288
    s_and_b32 s44, s44, 4194047
    buffer_load_dwordx4 v40, s[16:19], s44 offen offset:0 lds
    s_waitcnt vmcnt(15)
    v_lshlrev_b32 v184, 16, v120
    v_and_b32 v120, s51, v120
    v_lshlrev_b32 v185, 16, v121
    v_and_b32 v121, s51, v121
    v_lshlrev_b32 v186, 16, v122
    v_and_b32 v122, s51, v122
    v_lshlrev_b32 v187, 16, v123
    v_and_b32 v123, s51, v123
    v_pk_add_f32 v[52:53], v[52:53], v[184:185]
    v_pk_fma_f32 v[56:57], v[184:185], v[184:185], v[56:57]
    v_pk_add_f32 v[52:53], v[52:53], v[120:121]
    v_pk_fma_f32 v[56:57], v[120:121], v[120:121], v[56:57]
    v_pk_add_f32 v[52:53], v[52:53], v[186:187]
    v_pk_fma_f32 v[56:57], v[186:187], v[186:187], v[56:57]
    v_pk_add_f32 v[52:53], v[52:53], v[122:123]
    v_pk_fma_f32 v[56:57], v[122:123], v[122:123], v[56:57]
    buffer_load_dwordx4 v41, s[16:19], s44 offen offset:1024 lds
    s_waitcnt vmcnt(15)
    v_lshlrev_b32 v156, 16, v92
    v_and_b32 v92, s51, v92
    v_lshlrev_b32 v157, 16, v93
    v_and_b32 v93, s51, v93
    v_lshlrev_b32 v158, 16, v94
    v_and_b32 v94, s51, v94
    v_lshlrev_b32 v159, 16, v95
    v_and_b32 v95, s51, v95
    v_pk_add_f32 v[50:51], v[50:51], v[156:157]
    v_pk_fma_f32 v[54:55], v[156:157], v[156:157], v[54:55]
    v_pk_add_f32 v[50:51], v[50:51], v[92:93]
    v_pk_fma_f32 v[54:55], v[92:93], v[92:93], v[54:55]
    v_pk_add_f32 v[50:51], v[50:51], v[158:159]
    v_pk_fma_f32 v[54:55], v[158:159], v[158:159], v[54:55]
    v_pk_add_f32 v[50:51], v[50:51], v[94:95]
    v_pk_fma_f32 v[54:55], v[94:95], v[94:95], v[54:55]
    buffer_load_dwordx4 v42, s[16:19], s44 offen offset:2048 lds
    s_waitcnt vmcnt(15)
    v_lshlrev_b32 v188, 16, v124
    v_and_b32 v124, s51, v124
    v_lshlrev_b32 v189, 16, v125
    v_and_b32 v125, s51, v125
    v_lshlrev_b32 v190, 16, v126
    v_and_b32 v126, s51, v126
    v_lshlrev_b32 v191, 16, v127
    v_and_b32 v127, s51, v127
    v_pk_add_f32 v[52:53], v[52:53], v[188:189]
    v_pk_fma_f32 v[56:57], v[188:189], v[188:189], v[56:57]
    v_pk_add_f32 v[52:53], v[52:53], v[124:125]
    v_pk_fma_f32 v[56:57], v[124:125], v[124:125], v[56:57]
    v_pk_add_f32 v[52:53], v[52:53], v[190:191]
    v_pk_fma_f32 v[56:57], v[190:191], v[190:191], v[56:57]
    v_pk_add_f32 v[52:53], v[52:53], v[126:127]
    v_pk_fma_f32 v[56:57], v[126:127], v[126:127], v[56:57]
    buffer_load_dwordx4 v43, s[16:19], s44 offen offset:3072 lds
    buffer_store_dword v37, v36, s[64:67], 0 offen sc1
    v_add_f32 v50, v50, v51
    v_add_f32 v52, v52, v53
    v_add_f32 v54, v54, v55
    v_add_f32 v56, v56, v57
    v_add_f32_dpp v50, v50, v50 quad_perm:[1,0,3,2] row_mask:0xf bank_mask:0xf
    v_add_f32_dpp v52, v52, v52 quad_perm:[1,0,3,2] row_mask:0xf bank_mask:0xf
    v_add_f32_dpp v54, v54, v54 quad_perm:[1,0,3,2] row_mask:0xf bank_mask:0xf
    v_add_f32_dpp v56, v56, v56 quad_perm:[1,0,3,2] row_mask:0xf bank_mask:0xf
    v_add_f32_dpp v50, v50, v50 quad_perm:[2,3,0,1] row_mask:0xf bank_mask:0xf
    v_add_f32_dpp v52, v52, v52 quad_perm:[2,3,0,1] row_mask:0xf bank_mask:0xf
    v_add_f32_dpp v54, v54, v54 quad_perm:[2,3,0,1] row_mask:0xf bank_mask:0xf
    v_add_f32_dpp v56, v56, v56 quad_perm:[2,3,0,1] row_mask:0xf bank_mask:0xf
    v_add_f32_dpp v50, v50, v50 row_half_mirror row_mask:0xf bank_mask:0xf
    v_add_f32_dpp v52, v52, v52 row_half_mirror row_mask:0xf bank_mask:0xf
    v_add_f32_dpp v54, v54, v54 row_half_mirror row_mask:0xf bank_mask:0xf
    v_add_f32_dpp v56, v56, v56 row_half_mirror row_mask:0xf bank_mask:0xf
    v_mul_f32 v50, 0x3b000000, v50
    v_mul_f32 v52, 0x3b000000, v52
    v_mul_f32 v54, 0x3b000000, v54
    v_mul_f32 v56, 0x3b000000, v56
    v_fma_f32 v54, -v50, v50, v54
    v_fma_f32 v56, -v52, v52, v56
    v_max_f32 v54, 0, v54
    v_max_f32 v56, 0, v56
    v_cvt_pk_bf16_f32 v54, v54, v50
    v_cvt_pk_bf16_f32 v56, v56, v52
    v_and_b32 v50, s51, v54
    v_and_b32 v52, s51, v56
    v_lshlrev_b32 v54, 16, v54
    v_lshlrev_b32 v56, 16, v56
    v_add_f32 v54, 0x3727c5ac, v54
    v_add_f32 v56, 0x3727c5ac, v56
    v_cvt_pk_bf16_f32 v54, v54, v54
    v_cvt_pk_bf16_f32 v56, v56, v56
    v_lshlrev_b32 v54, 16, v54
    v_lshlrev_b32 v56, 16, v56
    v_sqrt_f32 v54, v54
    v_sqrt_f32 v56, v56
    s_nop 0
    v_cvt_pk_bf16_f32 v54, v54, v54
    v_cvt_pk_bf16_f32 v56, v56, v56
    v_lshlrev_b32 v54, 16, v54
    v_lshlrev_b32 v56, 16, v56
    v_rcp_f32 v54, v54
    v_rcp_f32 v56, v56
    s_nop 0
    v_mul_f32 v54, 0x3e0293ee, v54
    v_mul_f32 v56, 0x3e0293ee, v56
    v_mul_f32 v50, v50, v54
    v_mul_f32 v52, v52, v56
    v_pk_fma_f32 v[128:129], v[128:129], v[54:55], v[50:51] op_sel_hi:[1,0,0] neg_lo:[0,0,1] neg_hi:[0,0,1]
    v_pk_fma_f32 v[64:65], v[64:65], v[54:55], v[50:51] op_sel_hi:[1,0,0] neg_lo:[0,0,1] neg_hi:[0,0,1]
    v_pk_fma_f32 v[130:131], v[130:131], v[54:55], v[50:51] op_sel_hi:[1,0,0] neg_lo:[0,0,1] neg_hi:[0,0,1]
    v_pk_fma_f32 v[66:67], v[66:67], v[54:55], v[50:51] op_sel_hi:[1,0,0] neg_lo:[0,0,1] neg_hi:[0,0,1]
    v_cvt_pk_bf16_f32 v64, v128, v64
    v_cvt_pk_bf16_f32 v65, v129, v65
    v_cvt_pk_bf16_f32 v66, v130, v66
    v_cvt_pk_bf16_f32 v67, v131, v67
    ds_write_b128 v58, v[64:67] offset:0
    v_pk_fma_f32 v[160:161], v[160:161], v[56:57], v[52:53] op_sel_hi:[1,0,0] neg_lo:[0,0,1] neg_hi:[0,0,1]
    v_pk_fma_f32 v[96:97], v[96:97], v[56:57], v[52:53] op_sel_hi:[1,0,0] neg_lo:[0,0,1] neg_hi:[0,0,1]
    v_pk_fma_f32 v[162:163], v[162:163], v[56:57], v[52:53] op_sel_hi:[1,0,0] neg_lo:[0,0,1] neg_hi:[0,0,1]
    v_pk_fma_f32 v[98:99], v[98:99], v[56:57], v[52:53] op_sel_hi:[1,0,0] neg_lo:[0,0,1] neg_hi:[0,0,1]
    v_cvt_pk_bf16_f32 v96, v160, v96
    v_cvt_pk_bf16_f32 v97, v161, v97
    v_cvt_pk_bf16_f32 v98, v162, v98
    v_cvt_pk_bf16_f32 v99, v163, v99
    ds_write_b128 v58, v[96:99] offset:128
    v_pk_fma_f32 v[132:133], v[132:133], v[54:55], v[50:51] op_sel_hi:[1,0,0] neg_lo:[0,0,1] neg_hi:[0,0,1]
    v_pk_fma_f32 v[68:69], v[68:69], v[54:55], v[50:51] op_sel_hi:[1,0,0] neg_lo:[0,0,1] neg_hi:[0,0,1]
    v_pk_fma_f32 v[134:135], v[134:135], v[54:55], v[50:51] op_sel_hi:[1,0,0] neg_lo:[0,0,1] neg_hi:[0,0,1]
    v_pk_fma_f32 v[70:71], v[70:71], v[54:55], v[50:51] op_sel_hi:[1,0,0] neg_lo:[0,0,1] neg_hi:[0,0,1]
    v_cvt_pk_bf16_f32 v68, v132, v68
    v_cvt_pk_bf16_f32 v69, v133, v69
    v_cvt_pk_bf16_f32 v70, v134, v70
    v_cvt_pk_bf16_f32 v71, v135, v71
    ds_write_b128 v58, v[68:71] offset:8192
    v_pk_fma_f32 v[164:165], v[164:165], v[56:57], v[52:53] op_sel_hi:[1,0,0] neg_lo:[0,0,1] neg_hi:[0,0,1]
    v_pk_fma_f32 v[100:101], v[100:101], v[56:57], v[52:53] op_sel_hi:[1,0,0] neg_lo:[0,0,1] neg_hi:[0,0,1]
    v_pk_fma_f32 v[166:167], v[166:167], v[56:57], v[52:53] op_sel_hi:[1,0,0] neg_lo:[0,0,1] neg_hi:[0,0,1]
    v_pk_fma_f32 v[102:103], v[102:103], v[56:57], v[52:53] op_sel_hi:[1,0,0] neg_lo:[0,0,1] neg_hi:[0,0,1]
    v_cvt_pk_bf16_f32 v100, v164, v100
    v_cvt_pk_bf16_f32 v101, v165, v101
    v_cvt_pk_bf16_f32 v102, v166, v102
    v_cvt_pk_bf16_f32 v103, v167, v103
    ds_write_b128 v58, v[100:103] offset:8320
    v_pk_fma_f32 v[136:137], v[136:137], v[54:55], v[50:51] op_sel_hi:[1,0,0] neg_lo:[0,0,1] neg_hi:[0,0,1]
    v_pk_fma_f32 v[72:73], v[72:73], v[54:55], v[50:51] op_sel_hi:[1,0,0] neg_lo:[0,0,1] neg_hi:[0,0,1]
    v_pk_fma_f32 v[138:139], v[138:139], v[54:55], v[50:51] op_sel_hi:[1,0,0] neg_lo:[0,0,1] neg_hi:[0,0,1]
    v_pk_fma_f32 v[74:75], v[74:75], v[54:55], v[50:51] op_sel_hi:[1,0,0] neg_lo:[0,0,1] neg_hi:[0,0,1]
    v_cvt_pk_bf16_f32 v72, v136, v72
    v_cvt_pk_bf16_f32 v73, v137, v73
    v_cvt_pk_bf16_f32 v74, v138, v74
    v_cvt_pk_bf16_f32 v75, v139, v75
    ds_write_b128 v58, v[72:75] offset:16384
    v_pk_fma_f32 v[168:169], v[168:169], v[56:57], v[52:53] op_sel_hi:[1,0,0] neg_lo:[0,0,1] neg_hi:[0,0,1]
    v_pk_fma_f32 v[104:105], v[104:105], v[56:57], v[52:53] op_sel_hi:[1,0,0] neg_lo:[0,0,1] neg_hi:[0,0,1]
    v_pk_fma_f32 v[170:171], v[170:171], v[56:57], v[52:53] op_sel_hi:[1,0,0] neg_lo:[0,0,1] neg_hi:[0,0,1]
    v_pk_fma_f32 v[106:107], v[106:107], v[56:57], v[52:53] op_sel_hi:[1,0,0] neg_lo:[0,0,1] neg_hi:[0,0,1]
    v_cvt_pk_bf16_f32 v104, v168, v104
    v_cvt_pk_bf16_f32 v105, v169, v105
    v_cvt_pk_bf16_f32 v106, v170, v106
    v_cvt_pk_bf16_f32 v107, v171, v107
    ds_write_b128 v58, v[104:107] offset:16512
    v_pk_fma_f32 v[140:141], v[140:141], v[54:55], v[50:51] op_sel_hi:[1,0,0] neg_lo:[0,0,1] neg_hi:[0,0,1]
    v_pk_fma_f32 v[76:77], v[76:77], v[54:55], v[50:51] op_sel_hi:[1,0,0] neg_lo:[0,0,1] neg_hi:[0,0,1]
    v_pk_fma_f32 v[142:143], v[142:143], v[54:55], v[50:51] op_sel_hi:[1,0,0] neg_lo:[0,0,1] neg_hi:[0,0,1]
    v_pk_fma_f32 v[78:79], v[78:79], v[54:55], v[50:51] op_sel_hi:[1,0,0] neg_lo:[0,0,1] neg_hi:[0,0,1]
    v_cvt_pk_bf16_f32 v76, v140, v76
    v_cvt_pk_bf16_f32 v77, v141, v77
    v_cvt_pk_bf16_f32 v78, v142, v78
    v_cvt_pk_bf16_f32 v79, v143, v79
    ds_write_b128 v58, v[76:79] offset:24576
    v_pk_fma_f32 v[172:173], v[172:173], v[56:57], v[52:53] op_sel_hi:[1,0,0] neg_lo:[0,0,1] neg_hi:[0,0,1]
    v_pk_fma_f32 v[108:109], v[108:109], v[56:57], v[52:53] op_sel_hi:[1,0,0] neg_lo:[0,0,1] neg_hi:[0,0,1]
    v_pk_fma_f32 v[174:175], v[174:175], v[56:57], v[52:53] op_sel_hi:[1,0,0] neg_lo:[0,0,1] neg_hi:[0,0,1]
    v_pk_fma_f32 v[110:111], v[110:111], v[56:57], v[52:53] op_sel_hi:[1,0,0] neg_lo:[0,0,1] neg_hi:[0,0,1]
    v_cvt_pk_bf16_f32 v108, v172, v108
    v_cvt_pk_bf16_f32 v109, v173, v109
    v_cvt_pk_bf16_f32 v110, v174, v110
    v_cvt_pk_bf16_f32 v111, v175, v111
    ds_write_b128 v58, v[108:111] offset:24704
    v_pk_fma_f32 v[144:145], v[144:145], v[54:55], v[50:51] op_sel_hi:[1,0,0] neg_lo:[0,0,1] neg_hi:[0,0,1]
    v_pk_fma_f32 v[80:81], v[80:81], v[54:55], v[50:51] op_sel_hi:[1,0,0] neg_lo:[0,0,1] neg_hi:[0,0,1]
    v_pk_fma_f32 v[146:147], v[146:147], v[54:55], v[50:51] op_sel_hi:[1,0,0] neg_lo:[0,0,1] neg_hi:[0,0,1]
    v_pk_fma_f32 v[82:83], v[82:83], v[54:55], v[50:51] op_sel_hi:[1,0,0] neg_lo:[0,0,1] neg_hi:[0,0,1]
    v_cvt_pk_bf16_f32 v80, v144, v80
    v_cvt_pk_bf16_f32 v81, v145, v81
    v_cvt_pk_bf16_f32 v82, v146, v82
    v_cvt_pk_bf16_f32 v83, v147, v83
    ds_write_b128 v58, v[80:83] offset:32768
    v_pk_fma_f32 v[176:177], v[176:177], v[56:57], v[52:53] op_sel_hi:[1,0,0] neg_lo:[0,0,1] neg_hi:[0,0,1]
    v_pk_fma_f32 v[112:113], v[112:113], v[56:57], v[52:53] op_sel_hi:[1,0,0] neg_lo:[0,0,1] neg_hi:[0,0,1]
    v_pk_fma_f32 v[178:179], v[178:179], v[56:57], v[52:53] op_sel_hi:[1,0,0] neg_lo:[0,0,1] neg_hi:[0,0,1]
    v_pk_fma_f32 v[114:115], v[114:115], v[56:57], v[52:53] op_sel_hi:[1,0,0] neg_lo:[0,0,1] neg_hi:[0,0,1]
    v_cvt_pk_bf16_f32 v112, v176, v112
    v_cvt_pk_bf16_f32 v113, v177, v113
    v_cvt_pk_bf16_f32 v114, v178, v114
    v_cvt_pk_bf16_f32 v115, v179, v115
    ds_write_b128 v58, v[112:115] offset:32896
    v_pk_fma_f32 v[148:149], v[148:149], v[54:55], v[50:51] op_sel_hi:[1,0,0] neg_lo:[0,0,1] neg_hi:[0,0,1]
    v_pk_fma_f32 v[84:85], v[84:85], v[54:55], v[50:51] op_sel_hi:[1,0,0] neg_lo:[0,0,1] neg_hi:[0,0,1]
    v_pk_fma_f32 v[150:151], v[150:151], v[54:55], v[50:51] op_sel_hi:[1,0,0] neg_lo:[0,0,1] neg_hi:[0,0,1]
    v_pk_fma_f32 v[86:87], v[86:87], v[54:55], v[50:51] op_sel_hi:[1,0,0] neg_lo:[0,0,1] neg_hi:[0,0,1]
    v_cvt_pk_bf16_f32 v84, v148, v84
    v_cvt_pk_bf16_f32 v85, v149, v85
    v_cvt_pk_bf16_f32 v86, v150, v86
    v_cvt_pk_bf16_f32 v87, v151, v87
    ds_write_b128 v58, v[84:87] offset:40960
    v_pk_fma_f32 v[180:181], v[180:181], v[56:57], v[52:53] op_sel_hi:[1,0,0] neg_lo:[0,0,1] neg_hi:[0,0,1]
    v_pk_fma_f32 v[116:117], v[116:117], v[56:57], v[52:53] op_sel_hi:[1,0,0] neg_lo:[0,0,1] neg_hi:[0,0,1]
    v_pk_fma_f32 v[182:183], v[182:183], v[56:57], v[52:53] op_sel_hi:[1,0,0] neg_lo:[0,0,1] neg_hi:[0,0,1]
    v_pk_fma_f32 v[118:119], v[118:119], v[56:57], v[52:53] op_sel_hi:[1,0,0] neg_lo:[0,0,1] neg_hi:[0,0,1]
    v_cvt_pk_bf16_f32 v116, v180, v116
    v_cvt_pk_bf16_f32 v117, v181, v117
    v_cvt_pk_bf16_f32 v118, v182, v118
    v_cvt_pk_bf16_f32 v119, v183, v119
    ds_write_b128 v58, v[116:119] offset:41088
    v_pk_fma_f32 v[152:153], v[152:153], v[54:55], v[50:51] op_sel_hi:[1,0,0] neg_lo:[0,0,1] neg_hi:[0,0,1]
    v_pk_fma_f32 v[88:89], v[88:89], v[54:55], v[50:51] op_sel_hi:[1,0,0] neg_lo:[0,0,1] neg_hi:[0,0,1]
    v_pk_fma_f32 v[154:155], v[154:155], v[54:55], v[50:51] op_sel_hi:[1,0,0] neg_lo:[0,0,1] neg_hi:[0,0,1]
    v_pk_fma_f32 v[90:91], v[90:91], v[54:55], v[50:51] op_sel_hi:[1,0,0] neg_lo:[0,0,1] neg_hi:[0,0,1]
    v_cvt_pk_bf16_f32 v88, v152, v88
    v_cvt_pk_bf16_f32 v89, v153, v89
    v_cvt_pk_bf16_f32 v90, v154, v90
    v_cvt_pk_bf16_f32 v91, v155, v91
    ds_write_b128 v58, v[88:91] offset:49152
    v_pk_fma_f32 v[184:185], v[184:185], v[56:57], v[52:53] op_sel_hi:[1,0,0] neg_lo:[0,0,1] neg_hi:[0,0,1]
    v_pk_fma_f32 v[120:121], v[120:121], v[56:57], v[52:53] op_sel_hi:[1,0,0] neg_lo:[0,0,1] neg_hi:[0,0,1]
    v_pk_fma_f32 v[186:187], v[186:187], v[56:57], v[52:53] op_sel_hi:[1,0,0] neg_lo:[0,0,1] neg_hi:[0,0,1]
    v_pk_fma_f32 v[122:123], v[122:123], v[56:57], v[52:53] op_sel_hi:[1,0,0] neg_lo:[0,0,1] neg_hi:[0,0,1]
    v_cvt_pk_bf16_f32 v120, v184, v120
    v_cvt_pk_bf16_f32 v121, v185, v121
    v_cvt_pk_bf16_f32 v122, v186, v122
    v_cvt_pk_bf16_f32 v123, v187, v123
    ds_write_b128 v58, v[120:123] offset:49280
    v_pk_fma_f32 v[156:157], v[156:157], v[54:55], v[50:51] op_sel_hi:[1,0,0] neg_lo:[0,0,1] neg_hi:[0,0,1]
    v_pk_fma_f32 v[92:93], v[92:93], v[54:55], v[50:51] op_sel_hi:[1,0,0] neg_lo:[0,0,1] neg_hi:[0,0,1]
    v_pk_fma_f32 v[158:159], v[158:159], v[54:55], v[50:51] op_sel_hi:[1,0,0] neg_lo:[0,0,1] neg_hi:[0,0,1]
    v_pk_fma_f32 v[94:95], v[94:95], v[54:55], v[50:51] op_sel_hi:[1,0,0] neg_lo:[0,0,1] neg_hi:[0,0,1]
    v_cvt_pk_bf16_f32 v92, v156, v92
    v_cvt_pk_bf16_f32 v93, v157, v93
    v_cvt_pk_bf16_f32 v94, v158, v94
    v_cvt_pk_bf16_f32 v95, v159, v95
    ds_write_b128 v58, v[92:95] offset:57344
    v_pk_fma_f32 v[188:189], v[188:189], v[56:57], v[52:53] op_sel_hi:[1,0,0] neg_lo:[0,0,1] neg_hi:[0,0,1]
    v_pk_fma_f32 v[124:125], v[124:125], v[56:57], v[52:53] op_sel_hi:[1,0,0] neg_lo:[0,0,1] neg_hi:[0,0,1]
    v_pk_fma_f32 v[190:191], v[190:191], v[56:57], v[52:53] op_sel_hi:[1,0,0] neg_lo:[0,0,1] neg_hi:[0,0,1]
    v_pk_fma_f32 v[126:127], v[126:127], v[56:57], v[52:53] op_sel_hi:[1,0,0] neg_lo:[0,0,1] neg_hi:[0,0,1]
    v_cvt_pk_bf16_f32 v124, v188, v124
    v_cvt_pk_bf16_f32 v125, v189, v125
    v_cvt_pk_bf16_f32 v126, v190, v126
    v_cvt_pk_bf16_f32 v127, v191, v127
    ds_write_b128 v58, v[124:127] offset:57472
    s_add_u32 m0, s43, 12288
    s_add_u32 s44, s56, 786432
    s_and_b32 s44, s44, 4194047
    buffer_load_dwordx4 v40, s[16:19], s44 offen offset:0 lds
    buffer_load_dwordx4 v41, s[16:19], s44 offen offset:1024 lds
    buffer_load_dwordx4 v42, s[16:19], s44 offen offset:2048 lds
    buffer_load_dwordx4 v43, s[16:19], s44 offen offset:3072 lds
    s_add_u32 m0, s43, 16384
    s_add_u32 s44, s56, 1048576
    s_and_b32 s44, s44, 4194047
    buffer_load_dwordx4 v40, s[16:19], s44 offen offset:0 lds
    buffer_load_dwordx4 v41, s[16:19], s44 offen offset:1024 lds
    buffer_load_dwordx4 v42, s[16:19], s44 offen offset:2048 lds
    buffer_load_dwordx4 v43, s[16:19], s44 offen offset:3072 lds
    s_add_u32 m0, s43, 20480
    s_add_u32 s44, s56, 1310720
    s_and_b32 s44, s44, 4194047
    buffer_load_dwordx4 v40, s[16:19], s44 offen offset:0 lds
    buffer_load_dwordx4 v41, s[16:19], s44 offen offset:1024 lds
    buffer_load_dwordx4 v42, s[16:19], s44 offen offset:2048 lds
    buffer_load_dwordx4 v43, s[16:19], s44 offen offset:3072 lds
    s_waitcnt vmcnt(21)
    ds_read_b64_tr_b16 v[160:161], v12 offset:0
    ds_read_b64_tr_b16 v[162:163], v12 offset:2048
    ds_read_b64_tr_b16 v[164:165], v12 offset:8
    ds_read_b64_tr_b16 v[166:167], v12 offset:2056
    ds_read_b64_tr_b16 v[168:169], v13 offset:0
    ds_read_b64_tr_b16 v[170:171], v13 offset:2048
    ds_read_b64_tr_b16 v[172:173], v13 offset:8
    ds_read_b64_tr_b16 v[174:175], v13 offset:2056
    s_waitcnt lgkmcnt(8)
    s_barrier
    ds_read_b128 a[0:3], v6 offset:0
    ds_read_b128 a[4:7], v6 offset:1024
    ds_read_b128 a[8:11], v6 offset:2048
    ds_read_b128 a[12:15], v6 offset:3072
    s_waitcnt lgkmcnt(0)
    v_mfma_f32_16x16x32_bf16 v[64:67], v[160:163], a[0:3], 0
    s_add_u32 m0, s43, 0
    s_add_u32 s44, s56, 1572864
    s_and_b32 s44, s44, 4194047
    v_mfma_f32_16x16x32_bf16 v[72:75], v[160:163], a[4:7], 0
    ds_read_b128 a[16:19], v7 offset:4096
    ds_read_b128 a[20:23], v7 offset:5120
    v_mfma_f32_16x16x32_bf16 v[80:83], v[160:163], a[8:11], 0
    ds_read_b128 a[24:27], v7 offset:6144
    ds_read_b128 a[28:31], v7 offset:7168
    v_mfma_f32_16x16x32_bf16 v[88:91], v[160:163], a[12:15], 0
    buffer_load_dwordx4 v40, s[16:19], s44 offen offset:0 lds
    v_mfma_f32_16x16x32_bf16 v[92:95], v[164:167], a[12:15], 0
    s_waitcnt vmcnt(18)
    ds_read_b64_tr_b16 v[176:177], v12 offset:4096
    v_mfma_f32_16x16x32_bf16 v[84:87], v[164:167], a[8:11], 0
    ds_read_b64_tr_b16 v[178:179], v12 offset:6144
    ds_read_b64_tr_b16 v[180:181], v12 offset:4104
    v_mfma_f32_16x16x32_bf16 v[76:79], v[164:167], a[4:7], 0
    ds_read_b64_tr_b16 v[182:183], v12 offset:6152
    ds_read_b64_tr_b16 v[184:185], v13 offset:4096
    v_mfma_f32_16x16x32_bf16 v[68:71], v[164:167], a[0:3], 0
    buffer_load_dwordx4 v41, s[16:19], s44 offen offset:1024 lds
    v_mfma_f32_16x16x32_bf16 v[96:99], v[168:171], a[0:3], 0
    ds_read_b64_tr_b16 v[186:187], v13 offset:6144
    ds_read_b64_tr_b16 v[188:189], v13 offset:4104
    v_mfma_f32_16x16x32_bf16 v[104:107], v[168:171], a[4:7], 0
    ds_read_b64_tr_b16 v[190:191], v13 offset:6152
    s_and_b32 s46, s40, 1
    v_mfma_f32_16x16x32_bf16 v[112:115], v[168:171], a[8:11], 0
    s_lshl_b32 s46, s46, 12
    s_lshr_b32 s47, s40, 1
    v_mfma_f32_16x16x32_bf16 v[120:123], v[168:171], a[12:15], 0
    buffer_load_dwordx4 v42, s[16:19], s44 offen offset:2048 lds
    v_mfma_f32_16x16x32_bf16 v[124:127], v[172:175], a[12:15], 0
    s_lshl_b32 s47, s47, 7
    s_add_u32 s46, s46, s47
    v_mfma_f32_16x16x32_bf16 v[116:119], v[172:175], a[8:11], 0
    v_add_u32 v28, s46, v28
    v_add_u32 v29, 1024, v28
    v_mfma_f32_16x16x32_bf16 v[108:111], v[172:175], a[4:7], 0
    v_lshrrev_b32 v130, 4, v1
    s_lshl_b32 s46, s40, 3
    v_mfma_f32_16x16x32_bf16 v[100:103], v[172:175], a[0:3], 0
    buffer_load_dwordx4 v43, s[16:19], s44 offen offset:3072 lds
    s_waitcnt lgkmcnt(0)
    v_mfma_f32_16x16x32_bf16 v[64:67], v[176:179], a[16:19], v[64:67]
    s_add_u32 m0, s43, 4096
    s_add_u32 s44, s56, 1835008
    s_and_b32 s44, s44, 4194047
    v_mfma_f32_16x16x32_bf16 v[72:75], v[176:179], a[20:23], v[72:75]
    ds_read_b128 a[32:35], v6 offset:8192
    ds_read_b128 a[36:39], v6 offset:9216
    v_mfma_f32_16x16x32_bf16 v[80:83], v[176:179], a[24:27], v[80:83]
    ds_read_b128 a[40:43], v6 offset:10240
    ds_read_b128 a[44:47], v6 offset:11264
    v_mfma_f32_16x16x32_bf16 v[88:91], v[176:179], a[28:31], v[88:91]
    buffer_load_dwordx4 v40, s[16:19], s44 offen offset:0 lds
    v_mfma_f32_16x16x32_bf16 v[92:95], v[180:183], a[28:31], v[92:95]
    s_waitcnt vmcnt(18)
    ds_read_b64_tr_b16 v[160:161], v12 offset:8192
    v_mfma_f32_16x16x32_bf16 v[84:87], v[180:183], a[24:27], v[84:87]
    ds_read_b64_tr_b16 v[162:163], v12 offset:10240
    ds_read_b64_tr_b16 v[164:165], v12 offset:8200
    v_mfma_f32_16x16x32_bf16 v[76:79], v[180:183], a[20:23], v[76:79]
    ds_read_b64_tr_b16 v[166:167], v12 offset:10248
    ds_read_b64_tr_b16 v[168:169], v13 offset:8192
    v_mfma_f32_16x16x32_bf16 v[68:71], v[180:183], a[16:19], v[68:71]
    buffer_load_dwordx4 v41, s[16:19], s44 offen offset:1024 lds
    v_mfma_f32_16x16x32_bf16 v[96:99], v[184:187], a[16:19], v[96:99]
    ds_read_b64_tr_b16 v[170:171], v13 offset:10240
    ds_read_b64_tr_b16 v[172:173], v13 offset:8200
    v_mfma_f32_16x16x32_bf16 v[104:107], v[184:187], a[20:23], v[104:107]
    ds_read_b64_tr_b16 v[174:175], v13 offset:10248
    s_add_u32 s46, s46, 0
    v_mfma_f32_16x16x32_bf16 v[112:115], v[184:187], a[24:27], v[112:115]
    v_add_u32 v132, s46, v130
    v_xor_b32 v133, v132, v1
    v_mfma_f32_16x16x32_bf16 v[120:123], v[184:187], a[28:31], v[120:123]
    buffer_load_dwordx4 v42, s[16:19], s44 offen offset:2048 lds
    v_mfma_f32_16x16x32_bf16 v[124:127], v[188:191], a[28:31], v[124:127]
    v_and_b32 v133, 15, v133
    v_lshlrev_b32 v133, 4, v133
    v_mfma_f32_16x16x32_bf16 v[116:119], v[188:191], a[24:27], v[116:119]
    v_lshl_add_u32 v26, v132, 8, v133
    s_lshl_b32 s46, s40, 3
    v_mfma_f32_16x16x32_bf16 v[108:111], v[188:191], a[20:23], v[108:111]
    s_add_u32 s46, s46, 4
    v_add_u32 v132, s46, v130
    v_mfma_f32_16x16x32_bf16 v[100:103], v[188:191], a[16:19], v[100:103]
    buffer_load_dwordx4 v43, s[16:19], s44 offen offset:3072 lds
    s_waitcnt lgkmcnt(0)
    v_mfma_f32_16x16x32_bf16 v[64:67], v[160:163], a[32:35], v[64:67]
    s_add_u32 m0, s43, 8192
    s_add_u32 s44, s56, 2097152
    s_and_b32 s44, s44, 4194047
    v_mfma_f32_16x16x32_bf16 v[72:75], v[160:163], a[36:39], v[72:75]
    ds_read_b128 a[48:51], v7 offset:12288
    ds_read_b128 a[52:55], v7 offset:13312
    v_mfma_f32_16x16x32_bf16 v[80:83], v[160:163], a[40:43], v[80:83]
    ds_read_b128 a[56:59], v7 offset:14336
    ds_read_b128 a[60:63], v7 offset:15360
    v_mfma_f32_16x16x32_bf16 v[88:91], v[160:163], a[44:47], v[88:91]
    buffer_load_dwordx4 v40, s[16:19], s44 offen offset:0 lds
    v_mfma_f32_16x16x32_bf16 v[92:95], v[164:167], a[44:47], v[92:95]
    s_waitcnt vmcnt(17)
    ds_read_b64_tr_b16 v[176:177], v12 offset:12288
    v_mfma_f32_16x16x32_bf16 v[84:87], v[164:167], a[40:43], v[84:87]
    ds_read_b64_tr_b16 v[178:179], v12 offset:14336
    ds_read_b64_tr_b16 v[180:181], v12 offset:12296
    v_mfma_f32_16x16x32_bf16 v[76:79], v[164:167], a[36:39], v[76:79]
    ds_read_b64_tr_b16 v[182:183], v12 offset:14344
    ds_read_b64_tr_b16 v[184:185], v13 offset:12288
    v_mfma_f32_16x16x32_bf16 v[68:71], v[164:167], a[32:35], v[68:71]
    buffer_load_dwordx4 v41, s[16:19], s44 offen offset:1024 lds
    v_mfma_f32_16x16x32_bf16 v[96:99], v[168:171], a[32:35], v[96:99]
    ds_read_b64_tr_b16 v[186:187], v13 offset:14336
    ds_read_b64_tr_b16 v[188:189], v13 offset:12296
    v_mfma_f32_16x16x32_bf16 v[104:107], v[168:171], a[36:39], v[104:107]
    ds_read_b64_tr_b16 v[190:191], v13 offset:14344
    v_xor_b32 v133, v132, v1
    v_mfma_f32_16x16x32_bf16 v[112:115], v[168:171], a[40:43], v[112:115]
    v_and_b32 v133, 15, v133
    v_lshlrev_b32 v133, 4, v133
    v_mfma_f32_16x16x32_bf16 v[120:123], v[168:171], a[44:47], v[120:123]
    buffer_load_dwordx4 v42, s[16:19], s44 offen offset:2048 lds
    v_mfma_f32_16x16x32_bf16 v[124:127], v[172:175], a[44:47], v[124:127]
    v_lshl_add_u32 v27, v132, 8, v133
    v_subrev_u32 v27, 1024, v27
    v_mfma_f32_16x16x32_bf16 v[116:119], v[172:175], a[40:43], v[116:119]
    v_and_b32 v131, 15, v1
    v_lshlrev_b32 v132, 8, v131
    v_mfma_f32_16x16x32_bf16 v[108:111], v[172:175], a[36:39], v[108:111]
    v_add_u32 v132, 32768, v132
    v_xor_b32 v131, v131, v130
    v_mfma_f32_16x16x32_bf16 v[100:103], v[172:175], a[32:35], v[100:103]
    buffer_load_dwordx4 v43, s[16:19], s44 offen offset:3072 lds
    s_waitcnt lgkmcnt(0)
    v_mfma_f32_16x16x32_bf16 v[64:67], v[176:179], a[48:51], v[64:67]
    s_add_u32 m0, s43, 12288
    s_add_u32 s44, s56, 2359296
    s_and_b32 s44, s44, 4194047
    v_mfma_f32_16x16x32_bf16 v[72:75], v[176:179], a[52:55], v[72:75]
    ds_read_b128 a[64:67], v6 offset:16384
    ds_read_b128 a[68:71], v6 offset:17408
    v_mfma_f32_16x16x32_bf16 v[80:83], v[176:179], a[56:59], v[80:83]
    ds_read_b128 a[72:75], v6 offset:18432
    ds_read_b128 a[76:79], v6 offset:19456
    v_mfma_f32_16x16x32_bf16 v[88:91], v[176:179], a[60:63], v[88:91]
    buffer_load_dwordx4 v40, s[16:19], s44 offen offset:0 lds
    v_mfma_f32_16x16x32_bf16 v[92:95], v[180:183], a[60:63], v[92:95]
    s_waitcnt vmcnt(17)
    ds_read_b64_tr_b16 v[160:161], v12 offset:16384
    v_mfma_f32_16x16x32_bf16 v[84:87], v[180:183], a[56:59], v[84:87]
    ds_read_b64_tr_b16 v[162:163], v12 offset:18432
    ds_read_b64_tr_b16 v[164:165], v12 offset:16392
    v_mfma_f32_16x16x32_bf16 v[76:79], v[180:183], a[52:55], v[76:79]
    ds_read_b64_tr_b16 v[166:167], v12 offset:18440
    ds_read_b64_tr_b16 v[168:169], v13 offset:16384
    v_mfma_f32_16x16x32_bf16 v[68:71], v[180:183], a[48:51], v[68:71]
    buffer_load_dwordx4 v41, s[16:19], s44 offen offset:1024 lds
    v_mfma_f32_16x16x32_bf16 v[96:99], v[184:187], a[48:51], v[96:99]
    ds_read_b64_tr_b16 v[170:171], v13 offset:18432
    ds_read_b64_tr_b16 v[172:173], v13 offset:16392
    v_mfma_f32_16x16x32_bf16 v[104:107], v[184:187], a[52:55], v[104:107]
    ds_read_b64_tr_b16 v[174:175], v13 offset:18440
    s_bfe_u32 s46, s56, 0x10007
    v_mfma_f32_16x16x32_bf16 v[112:115], v[184:187], a[56:59], v[112:115]
    s_lshl_b32 s46, s46, 3
    v_xor_b32 v131, s46, v131
    v_mfma_f32_16x16x32_bf16 v[120:123], v[184:187], a[60:63], v[120:123]
    buffer_load_dwordx4 v42, s[16:19], s44 offen offset:2048 lds
    v_mfma_f32_16x16x32_bf16 v[124:127], v[188:191], a[60:63], v[124:127]
    v_xor_b32 v133, 0, v131
    v_lshl_add_u32 v18, v133, 4, v132
    v_mfma_f32_16x16x32_bf16 v[116:119], v[188:191], a[56:59], v[116:119]
    v_xor_b32 v133, 4, v131
    v_lshl_add_u32 v19, v133, 4, v132
    v_mfma_f32_16x16x32_bf16 v[108:111], v[188:191], a[52:55], v[108:111]
    v_xor_b32 v133, 8, v131
    v_lshl_add_u32 v20, v133, 4, v132
    v_mfma_f32_16x16x32_bf16 v[100:103], v[188:191], a[48:51], v[100:103]
    buffer_load_dwordx4 v43, s[16:19], s44 offen offset:3072 lds
    s_waitcnt lgkmcnt(0)
    v_mfma_f32_16x16x32_bf16 v[64:67], v[160:163], a[64:67], v[64:67]
    s_add_u32 m0, s43, 16384
    s_add_u32 s44, s56, 2621440
    s_and_b32 s44, s44, 4194047
    v_mfma_f32_16x16x32_bf16 v[72:75], v[160:163], a[68:71], v[72:75]
    ds_read_b128 a[80:83], v7 offset:20480
    ds_read_b128 a[84:87], v7 offset:21504
    v_mfma_f32_16x16x32_bf16 v[80:83], v[160:163], a[72:75], v[80:83]
    ds_read_b128 a[88:91], v7 offset:22528
    ds_read_b128 a[92:95], v7 offset:23552
    v_mfma_f32_16x16x32_bf16 v[88:91], v[160:163], a[76:79], v[88:91]
    buffer_load_dwordx4 v40, s[16:19], s44 offen offset:0 lds
    v_mfma_f32_16x16x32_bf16 v[92:95], v[164:167], a[76:79], v[92:95]
    s_waitcnt vmcnt(17)
    ds_read_b64_tr_b16 v[176:177], v12 offset:20480
    v_mfma_f32_16x16x32_bf16 v[84:87], v[164:167], a[72:75], v[84:87]
    ds_read_b64_tr_b16 v[178:179], v12 offset:22528
    ds_read_b64_tr_b16 v[180:181], v12 offset:20488
    v_mfma_f32_16x16x32_bf16 v[76:79], v[164:167], a[68:71], v[76:79]
    ds_read_b64_tr_b16 v[182:183], v12 offset:22536
    ds_read_b64_tr_b16 v[184:185], v13 offset:20480
    v_mfma_f32_16x16x32_bf16 v[68:71], v[164:167], a[64:67], v[68:71]
    buffer_load_dwordx4 v41, s[16:19], s44 offen offset:1024 lds
    v_mfma_f32_16x16x32_bf16 v[96:99], v[168:171], a[64:67], v[96:99]
    ds_read_b64_tr_b16 v[186:187], v13 offset:22528
    ds_read_b64_tr_b16 v[188:189], v13 offset:20488
    v_mfma_f32_16x16x32_bf16 v[104:107], v[168:171], a[68:71], v[104:107]
    ds_read_b64_tr_b16 v[190:191], v13 offset:22536
    v_xor_b32 v133, 12, v131
    v_mfma_f32_16x16x32_bf16 v[112:115], v[168:171], a[72:75], v[112:115]
    v_lshl_add_u32 v21, v133, 4, v132
    s_lshl_b32 s46, s40, 14
    v_mfma_f32_16x16x32_bf16 v[120:123], v[168:171], a[76:79], v[120:123]
    buffer_load_dwordx4 v42, s[16:19], s44 offen offset:2048 lds
    v_mfma_f32_16x16x32_bf16 v[124:127], v[172:175], a[76:79], v[124:127]
    v_lshlrev_b32 v30, 4, v1
    v_add_u32 v30, s46, v30
    v_mfma_f32_16x16x32_bf16 v[116:119], v[172:175], a[72:75], v[116:119]
    v_lshlrev_b32 v144, 16, v192
    v_mfma_f32_16x16x32_bf16 v[108:111], v[172:175], a[68:71], v[108:111]
    v_mul_f32 v144, 0x3e0293ee, v144
    v_and_b32 v145, s51, v192
    v_mfma_f32_16x16x32_bf16 v[100:103], v[172:175], a[64:67], v[100:103]
    buffer_load_dwordx4 v43, s[16:19], s44 offen offset:3072 lds
    s_waitcnt lgkmcnt(0)
    v_mfma_f32_16x16x32_bf16 v[64:67], v[176:179], a[80:83], v[64:67]
    s_add_u32 m0, s43, 20480
    s_add_u32 s44, s56, 2883584
    s_and_b32 s44, s44, 4194047
    v_mfma_f32_16x16x32_bf16 v[72:75], v[176:179], a[84:87], v[72:75]
    ds_read_b128 a[96:99], v6 offset:24576
    ds_read_b128 a[100:103], v6 offset:25600
    v_mfma_f32_16x16x32_bf16 v[80:83], v[176:179], a[88:91], v[80:83]
    ds_read_b128 a[104:107], v6 offset:26624
    ds_read_b128 a[108:111], v6 offset:27648
    v_mfma_f32_16x16x32_bf16 v[88:91], v[176:179], a[92:95], v[88:91]
    buffer_load_dwordx4 v40, s[16:19], s44 offen offset:0 lds
    v_mfma_f32_16x16x32_bf16 v[92:95], v[180:183], a[92:95], v[92:95]
    s_waitcnt vmcnt(17)
    ds_read_b64_tr_b16 v[160:161], v12 offset:0
    v_mfma_f32_16x16x32_bf16 v[84:87], v[180:183], a[88:91], v[84:87]
    ds_read_b64_tr_b16 v[162:163], v12 offset:2048
    ds_read_b64_tr_b16 v[164:165], v12 offset:8
    v_mfma_f32_16x16x32_bf16 v[76:79], v[180:183], a[84:87], v[76:79]
    ds_read_b64_tr_b16 v[166:167], v12 offset:2056
    ds_read_b64_tr_b16 v[168:169], v13 offset:0
    v_mfma_f32_16x16x32_bf16 v[68:71], v[180:183], a[80:83], v[68:71]
    buffer_load_dwordx4 v41, s[16:19], s44 offen offset:1024 lds
    v_mfma_f32_16x16x32_bf16 v[96:99], v[184:187], a[80:83], v[96:99]
    ds_read_b64_tr_b16 v[170:171], v13 offset:2048
    ds_read_b64_tr_b16 v[172:173], v13 offset:8
    v_mfma_f32_16x16x32_bf16 v[104:107], v[184:187], a[84:87], v[104:107]
    ds_read_b64_tr_b16 v[174:175], v13 offset:2056
    v_mul_f32 v145, 0x3e0293ee, v145
    v_mfma_f32_16x16x32_bf16 v[112:115], v[184:187], a[88:91], v[112:115]
    v_lshlrev_b32 v146, 16, v193
    v_mul_f32 v146, 0x3e0293ee, v146
    v_mfma_f32_16x16x32_bf16 v[120:123], v[184:187], a[92:95], v[120:123]
    buffer_load_dwordx4 v42, s[16:19], s44 offen offset:2048 lds
    v_mfma_f32_16x16x32_bf16 v[124:127], v[188:191], a[92:95], v[124:127]
    v_and_b32 v147, s51, v193
    v_mul_f32 v147, 0x3e0293ee, v147
    v_mfma_f32_16x16x32_bf16 v[116:119], v[188:191], a[88:91], v[116:119]
    v_lshlrev_b32 v148, 16, v194
    v_mul_f32 v148, 0x3e0293ee, v148
    v_mfma_f32_16x16x32_bf16 v[108:111], v[188:191], a[84:87], v[108:111]
    v_and_b32 v149, s51, v194
    v_mul_f32 v149, 0x3e0293ee, v149
    v_mfma_f32_16x16x32_bf16 v[100:103], v[188:191], a[80:83], v[100:103]
    buffer_load_dwordx4 v43, s[16:19], s44 offen offset:3072 lds
    s_waitcnt lgkmcnt(0)
    v_mfma_f32_16x16x32_bf16 v[64:67], v[160:163], a[96:99], v[64:67]
    s_add_u32 m0, s43, 0
    s_add_u32 s44, s56, 3145728
    s_and_b32 s44, s44, 4194047
    v_mfma_f32_16x16x32_bf16 v[72:75], v[160:163], a[100:103], v[72:75]
    ds_read_b128 a[112:115], v7 offset:28672
    ds_read_b128 a[116:119], v7 offset:29696
    v_mfma_f32_16x16x32_bf16 v[80:83], v[160:163], a[104:107], v[80:83]
    ds_read_b128 a[120:123], v7 offset:30720
    ds_read_b128 a[124:127], v7 offset:31744
    v_mfma_f32_16x16x32_bf16 v[88:91], v[160:163], a[108:111], v[88:91]
    buffer_load_dwordx4 v40, s[16:19], s44 offen offset:0 lds
    v_mfma_f32_16x16x32_bf16 v[92:95], v[164:167], a[108:111], v[92:95]
    s_waitcnt vmcnt(17)
    ds_read_b64_tr_b16 v[176:177], v12 offset:4096
    v_mfma_f32_16x16x32_bf16 v[84:87], v[164:167], a[104:107], v[84:87]
    ds_read_b64_tr_b16 v[178:179], v12 offset:6144
    ds_read_b64_tr_b16 v[180:181], v12 offset:4104
    v_mfma_f32_16x16x32_bf16 v[76:79], v[164:167], a[100:103], v[76:79]
    ds_read_b64_tr_b16 v[182:183], v12 offset:6152
    ds_read_b64_tr_b16 v[184:185], v13 offset:4096
    v_mfma_f32_16x16x32_bf16 v[68:71], v[164:167], a[96:99], v[68:71]
    buffer_load_dwordx4 v41, s[16:19], s44 offen offset:1024 lds
    v_mfma_f32_16x16x32_bf16 v[96:99], v[168:171], a[96:99], v[96:99]
    ds_read_b64_tr_b16 v[186:187], v13 offset:6144
    ds_read_b64_tr_b16 v[188:189], v13 offset:4104
    v_mfma_f32_16x16x32_bf16 v[104:107], v[168:171], a[100:103], v[104:107]
    ds_read_b64_tr_b16 v[190:191], v13 offset:6152
    v_lshlrev_b32 v150, 16, v195
    v_mfma_f32_16x16x32_bf16 v[112:115], v[168:171], a[104:107], v[112:115]
    v_mul_f32 v150, 0x3e0293ee, v150
    v_and_b32 v151, s51, v195
    v_mfma_f32_16x16x32_bf16 v[120:123], v[168:171], a[108:111], v[120:123]
    buffer_load_dwordx4 v42, s[16:19], s44 offen offset:2048 lds
    v_mfma_f32_16x16x32_bf16 v[124:127], v[172:175], a[108:111], v[124:127]
    v_mul_f32 v151, 0x3e0293ee, v151
    v_lshlrev_b32 v152, 16, v196
    v_mfma_f32_16x16x32_bf16 v[116:119], v[172:175], a[104:107], v[116:119]
    v_mul_f32 v152, 0x3e0293ee, v152
    v_and_b32 v153, s51, v196
    v_mfma_f32_16x16x32_bf16 v[108:111], v[172:175], a[100:103], v[108:111]
    v_mul_f32 v153, 0x3e0293ee, v153
    v_lshlrev_b32 v154, 16, v197
    v_mfma_f32_16x16x32_bf16 v[100:103], v[172:175], a[96:99], v[100:103]
    buffer_load_dwordx4 v43, s[16:19], s44 offen offset:3072 lds
    s_waitcnt lgkmcnt(0)
    v_mfma_f32_16x16x32_bf16 v[64:67], v[176:179], a[112:115], v[64:67]
    s_add_u32 m0, s43, 4096
    s_add_u32 s44, s56, 3407872
    s_and_b32 s44, s44, 4194047
    v_mfma_f32_16x16x32_bf16 v[72:75], v[176:179], a[116:119], v[72:75]
    ds_read_b128 a[128:131], v6 offset:32768
    ds_read_b128 a[132:135], v6 offset:33792
    v_mfma_f32_16x16x32_bf16 v[80:83], v[176:179], a[120:123], v[80:83]
    ds_read_b128 a[136:139], v6 offset:34816
    ds_read_b128 a[140:143], v6 offset:35840
    v_mfma_f32_16x16x32_bf16 v[88:91], v[176:179], a[124:127], v[88:91]
    buffer_load_dwordx4 v40, s[16:19], s44 offen offset:0 lds
    v_mfma_f32_16x16x32_bf16 v[92:95], v[180:183], a[124:127], v[92:95]
    s_waitcnt vmcnt(17)
    ds_read_b64_tr_b16 v[160:161], v12 offset:8192
    v_mfma_f32_16x16x32_bf16 v[84:87], v[180:183], a[120:123], v[84:87]
    ds_read_b64_tr_b16 v[162:163], v12 offset:10240
    ds_read_b64_tr_b16 v[164:165], v12 offset:8200
    v_mfma_f32_16x16x32_bf16 v[76:79], v[180:183], a[116:119], v[76:79]
    ds_read_b64_tr_b16 v[166:167], v12 offset:10248
    ds_read_b64_tr_b16 v[168:169], v13 offset:8192
    v_mfma_f32_16x16x32_bf16 v[68:71], v[180:183], a[112:115], v[68:71]
    buffer_load_dwordx4 v41, s[16:19], s44 offen offset:1024 lds
    v_mfma_f32_16x16x32_bf16 v[96:99], v[184:187], a[112:115], v[96:99]
    ds_read_b64_tr_b16 v[170:171], v13 offset:10240
    ds_read_b64_tr_b16 v[172:173], v13 offset:8200
    v_mfma_f32_16x16x32_bf16 v[104:107], v[184:187], a[116:119], v[104:107]
    ds_read_b64_tr_b16 v[174:175], v13 offset:10248
    v_mul_f32 v154, 0x3e0293ee, v154
    v_mfma_f32_16x16x32_bf16 v[112:115], v[184:187], a[120:123], v[112:115]
    v_and_b32 v155, s51, v197
    v_mul_f32 v155, 0x3e0293ee, v155
    v_mfma_f32_16x16x32_bf16 v[120:123], v[184:187], a[124:127], v[120:123]
    buffer_load_dwordx4 v42, s[16:19], s44 offen offset:2048 lds
    v_mfma_f32_16x16x32_bf16 v[124:127], v[188:191], a[124:127], v[124:127]
    v_lshlrev_b32 v156, 16, v198
    v_mul_f32 v156, 0x3e0293ee, v156
    v_mfma_f32_16x16x32_bf16 v[116:119], v[188:191], a[120:123], v[116:119]
    v_and_b32 v157, s51, v198
    v_mul_f32 v157, 0x3e0293ee, v157
    v_mfma_f32_16x16x32_bf16 v[108:111], v[188:191], a[116:119], v[108:111]
    v_lshlrev_b32 v158, 16, v199
    v_mul_f32 v158, 0x3e0293ee, v158
    v_mfma_f32_16x16x32_bf16 v[100:103], v[188:191], a[112:115], v[100:103]
    buffer_load_dwordx4 v43, s[16:19], s44 offen offset:3072 lds
    s_waitcnt lgkmcnt(0)
    v_mfma_f32_16x16x32_bf16 v[64:67], v[160:163], a[128:131], v[64:67]
    s_add_u32 m0, s43, 8192
    s_add_u32 s44, s56, 3670016
    s_and_b32 s44, s44, 4194047
    v_mfma_f32_16x16x32_bf16 v[72:75], v[160:163], a[132:135], v[72:75]
    ds_read_b128 a[144:147], v7 offset:36864
    ds_read_b128 a[148:151], v7 offset:37888
    v_mfma_f32_16x16x32_bf16 v[80:83], v[160:163], a[136:139], v[80:83]
    ds_read_b128 a[152:155], v7 offset:38912
    ds_read_b128 a[156:159], v7 offset:39936
    v_mfma_f32_16x16x32_bf16 v[88:91], v[160:163], a[140:143], v[88:91]
    buffer_load_dwordx4 v40, s[16:19], s44 offen offset:0 lds
    v_mfma_f32_16x16x32_bf16 v[92:95], v[164:167], a[140:143], v[92:95]
    s_waitcnt vmcnt(17)
    ds_read_b64_tr_b16 v[176:177], v12 offset:12288
    v_mfma_f32_16x16x32_bf16 v[84:87], v[164:167], a[136:139], v[84:87]
    ds_read_b64_tr_b16 v[178:179], v12 offset:14336
    ds_read_b64_tr_b16 v[180:181], v12 offset:12296
    v_mfma_f32_16x16x32_bf16 v[76:79], v[164:167], a[132:135], v[76:79]
    ds_read_b64_tr_b16 v[182:183], v12 offset:14344
    ds_read_b64_tr_b16 v[184:185], v13 offset:12288
    v_mfma_f32_16x16x32_bf16 v[68:71], v[164:167], a[128:131], v[68:71]
    buffer_load_dwordx4 v41, s[16:19], s44 offen offset:1024 lds
    v_mfma_f32_16x16x32_bf16 v[96:99], v[168:171], a[128:131], v[96:99]
    ds_read_b64_tr_b16 v[186:187], v13 offset:14336
    ds_read_b64_tr_b16 v[188:189], v13 offset:12296
    v_mfma_f32_16x16x32_bf16 v[104:107], v[168:171], a[132:135], v[104:107]
    ds_read_b64_tr_b16 v[190:191], v13 offset:14344
    v_and_b32 v159, s51, v199
    v_mfma_f32_16x16x32_bf16 v[112:115], v[168:171], a[136:139], v[112:115]
    v_mul_f32 v159, 0x3e0293ee, v159
    v_mfma_f32_16x16x32_bf16 v[120:123], v[168:171], a[140:143], v[120:123]
    buffer_load_dwordx4 v42, s[16:19], s44 offen offset:2048 lds
    v_mfma_f32_16x16x32_bf16 v[124:127], v[172:175], a[140:143], v[124:127]
    v_mfma_f32_16x16x32_bf16 v[116:119], v[172:175], a[136:139], v[116:119]
    v_mfma_f32_16x16x32_bf16 v[108:111], v[172:175], a[132:135], v[108:111]
    v_mfma_f32_16x16x32_bf16 v[100:103], v[172:175], a[128:131], v[100:103]
    buffer_load_dwordx4 v43, s[16:19], s44 offen offset:3072 lds
    s_waitcnt lgkmcnt(0)
    v_mfma_f32_16x16x32_bf16 v[64:67], v[176:179], a[144:147], v[64:67]
    s_add_u32 m0, s43, 12288
    s_add_u32 s44, s56, 3932160
    s_and_b32 s44, s44, 4194047
    v_mfma_f32_16x16x32_bf16 v[72:75], v[176:179], a[148:151], v[72:75]
    ds_read_b128 a[160:163], v6 offset:40960
    ds_read_b128 a[164:167], v6 offset:41984
    v_mfma_f32_16x16x32_bf16 v[80:83], v[176:179], a[152:155], v[80:83]
    ds_read_b128 a[168:171], v6 offset:43008
    ds_read_b128 a[172:175], v6 offset:44032
    v_mfma_f32_16x16x32_bf16 v[88:91], v[176:179], a[156:159], v[88:91]
    buffer_load_dwordx4 v40, s[16:19], s44 offen offset:0 lds
    v_mfma_f32_16x16x32_bf16 v[92:95], v[180:183], a[156:159], v[92:95]
    s_waitcnt vmcnt(17)
    ds_read_b64_tr_b16 v[160:161], v12 offset:16384
    v_mfma_f32_16x16x32_bf16 v[84:87], v[180:183], a[152:155], v[84:87]
    ds_read_b64_tr_b16 v[162:163], v12 offset:18432
    ds_read_b64_tr_b16 v[164:165], v12 offset:16392
    v_mfma_f32_16x16x32_bf16 v[76:79], v[180:183], a[148:151], v[76:79]
    ds_read_b64_tr_b16 v[166:167], v12 offset:18440
    ds_read_b64_tr_b16 v[168:169], v13 offset:16384
    v_mfma_f32_16x16x32_bf16 v[68:71], v[180:183], a[144:147], v[68:71]
    buffer_load_dwordx4 v41, s[16:19], s44 offen offset:1024 lds
    v_mfma_f32_16x16x32_bf16 v[96:99], v[184:187], a[144:147], v[96:99]
    ds_read_b64_tr_b16 v[170:171], v13 offset:18432
    ds_read_b64_tr_b16 v[172:173], v13 offset:16392
    v_mfma_f32_16x16x32_bf16 v[104:107], v[184:187], a[148:151], v[104:107]
    ds_read_b64_tr_b16 v[174:175], v13 offset:18440
    v_mfma_f32_16x16x32_bf16 v[112:115], v[184:187], a[152:155], v[112:115]
    v_mfma_f32_16x16x32_bf16 v[120:123], v[184:187], a[156:159], v[120:123]
    buffer_load_dwordx4 v42, s[16:19], s44 offen offset:2048 lds
    v_mfma_f32_16x16x32_bf16 v[124:127], v[188:191], a[156:159], v[124:127]
    v_mfma_f32_16x16x32_bf16 v[116:119], v[188:191], a[152:155], v[116:119]
    v_mfma_f32_16x16x32_bf16 v[108:111], v[188:191], a[148:151], v[108:111]
    v_mfma_f32_16x16x32_bf16 v[100:103], v[188:191], a[144:147], v[100:103]
L_pg0:
    s_cbranch_execz L_pg4
    buffer_load_dwordx4 v43, s[16:19], s44 offen offset:3072 lds
    s_waitcnt lgkmcnt(0)
    v_mfma_f32_16x16x32_bf16 v[64:67], v[160:163], a[160:163], v[64:67]
    s_add_u32 m0, s43, 16384
    s_add_u32 s44, s56, 0
    s_bfe_u32 s44, s44, 589837
    s_mul_i32 s44, s44, 3584
    v_mfma_f32_16x16x32_bf16 v[72:75], v[160:163], a[164:167], v[72:75]
    ds_read_b128 a[176:179], v7 offset:45056
    ds_read_b128 a[180:183], v7 offset:46080
    v_mfma_f32_16x16x32_bf16 v[80:83], v[160:163], a[168:171], v[80:83]
    ds_read_b128 a[184:187], v7 offset:47104
    ds_read_b128 a[188:191], v7 offset:48128
    v_mfma_f32_16x16x32_bf16 v[88:91], v[160:163], a[172:175], v[88:91]
    buffer_load_dwordx4 v44, s[24:27], s44 offen offset:0 lds
    v_mfma_f32_16x16x32_bf16 v[92:95], v[164:167], a[172:175], v[92:95]
    s_waitcnt vmcnt(17)
    ds_read_b64_tr_b16 v[176:177], v12 offset:20480
    v_mfma_f32_16x16x32_bf16 v[84:87], v[164:167], a[168:171], v[84:87]
    ds_read_b64_tr_b16 v[178:179], v12 offset:22528
    ds_read_b64_tr_b16 v[180:181], v12 offset:20488
    v_mfma_f32_16x16x32_bf16 v[76:79], v[164:167], a[164:167], v[76:79]
    ds_read_b64_tr_b16 v[182:183], v12 offset:22536
    ds_read_b64_tr_b16 v[184:185], v13 offset:20480
    v_mfma_f32_16x16x32_bf16 v[68:71], v[164:167], a[160:163], v[68:71]
    buffer_load_dwordx4 v45, s[24:27], s44 offen offset:1024 lds
    v_mfma_f32_16x16x32_bf16 v[96:99], v[168:171], a[160:163], v[96:99]
    ds_read_b64_tr_b16 v[186:187], v13 offset:22528
    ds_read_b64_tr_b16 v[188:189], v13 offset:20488
    v_mfma_f32_16x16x32_bf16 v[104:107], v[168:171], a[164:167], v[104:107]
    ds_read_b64_tr_b16 v[190:191], v13 offset:22536
    v_mfma_f32_16x16x32_bf16 v[112:115], v[168:171], a[168:171], v[112:115]
    v_mfma_f32_16x16x32_bf16 v[120:123], v[168:171], a[172:175], v[120:123]
    buffer_load_dwordx4 v46, s[24:27], s44 offen offset:2048 lds
    v_mfma_f32_16x16x32_bf16 v[124:127], v[172:175], a[172:175], v[124:127]
    v_mfma_f32_16x16x32_bf16 v[116:119], v[172:175], a[168:171], v[116:119]
    v_mfma_f32_16x16x32_bf16 v[108:111], v[172:175], a[164:167], v[108:111]
    v_mfma_f32_16x16x32_bf16 v[100:103], v[172:175], a[160:163], v[100:103]
    buffer_load_dwordx4 v47, s[24:27], s44 offen offset:3072 lds
    s_waitcnt lgkmcnt(0)
    v_mfma_f32_16x16x32_bf16 v[64:67], v[176:179], a[176:179], v[64:67]
    s_add_u32 m0, s43, 20480
    s_add_u32 s44, s56, 262144
    s_bfe_u32 s44, s44, 589837
    s_mul_i32 s44, s44, 3584
    v_mfma_f32_16x16x32_bf16 v[72:75], v[176:179], a[180:183], v[72:75]
    ds_read_b128 a[192:195], v6 offset:49152
    ds_read_b128 a[196:199], v6 offset:50176
    v_mfma_f32_16x16x32_bf16 v[80:83], v[176:179], a[184:187], v[80:83]
    ds_read_b128 a[200:203], v6 offset:51200
    ds_read_b128 a[204:207], v6 offset:52224
    v_mfma_f32_16x16x32_bf16 v[88:91], v[176:179], a[188:191], v[88:91]
    buffer_load_dwordx4 v44, s[24:27], s44 offen offset:0 lds
    v_mfma_f32_16x16x32_bf16 v[92:95], v[180:183], a[188:191], v[92:95]
    s_waitcnt vmcnt(17)
    ds_read_b64_tr_b16 v[160:161], v12 offset:0
    v_mfma_f32_16x16x32_bf16 v[84:87], v[180:183], a[184:187], v[84:87]
    ds_read_b64_tr_b16 v[162:163], v12 offset:2048
    ds_read_b64_tr_b16 v[164:165], v12 offset:8
    v_mfma_f32_16x16x32_bf16 v[76:79], v[180:183], a[180:183], v[76:79]
    ds_read_b64_tr_b16 v[166:167], v12 offset:2056
    ds_read_b64_tr_b16 v[168:169], v13 offset:0
    v_mfma_f32_16x16x32_bf16 v[68:71], v[180:183], a[176:179], v[68:71]
    buffer_load_dwordx4 v45, s[24:27], s44 offen offset:1024 lds
    v_mfma_f32_16x16x32_bf16 v[96:99], v[184:187], a[176:179], v[96:99]
    ds_read_b64_tr_b16 v[170:171], v13 offset:2048
    ds_read_b64_tr_b16 v[172:173], v13 offset:8
    v_mfma_f32_16x16x32_bf16 v[104:107], v[184:187], a[180:183], v[104:107]
    ds_read_b64_tr_b16 v[174:175], v13 offset:2056
    v_mfma_f32_16x16x32_bf16 v[112:115], v[184:187], a[184:187], v[112:115]
    v_mfma_f32_16x16x32_bf16 v[120:123], v[184:187], a[188:191], v[120:123]
    buffer_load_dwordx4 v46, s[24:27], s44 offen offset:2048 lds
    v_mfma_f32_16x16x32_bf16 v[124:127], v[188:191], a[188:191], v[124:127]
    v_mfma_f32_16x16x32_bf16 v[116:119], v[188:191], a[184:187], v[116:119]
    v_mfma_f32_16x16x32_bf16 v[108:111], v[188:191], a[180:183], v[108:111]
    v_mfma_f32_16x16x32_bf16 v[100:103], v[188:191], a[176:179], v[100:103]
    buffer_load_dwordx4 v47, s[24:27], s44 offen offset:3072 lds
    s_waitcnt lgkmcnt(0)
    v_mfma_f32_16x16x32_bf16 v[64:67], v[160:163], a[192:195], v[64:67]
    s_add_u32 m0, s43, 0
    s_add_u32 s44, s56, 524288
    s_bfe_u32 s44, s44, 589837
    s_mul_i32 s44, s44, 3584
    v_mfma_f32_16x16x32_bf16 v[72:75], v[160:163], a[196:199], v[72:75]
    ds_read_b128 a[208:211], v7 offset:53248
    ds_read_b128 a[212:215], v7 offset:54272
    v_mfma_f32_16x16x32_bf16 v[80:83], v[160:163], a[200:203], v[80:83]
    ds_read_b128 a[216:219], v7 offset:55296
    ds_read_b128 a[220:223], v7 offset:56320
    v_mfma_f32_16x16x32_bf16 v[88:91], v[160:163], a[204:207], v[88:91]
    buffer_load_dwordx4 v44, s[24:27], s44 offen offset:0 lds
    v_mfma_f32_16x16x32_bf16 v[92:95], v[164:167], a[204:207], v[92:95]
    s_waitcnt vmcnt(17)
    ds_read_b64_tr_b16 v[176:177], v12 offset:4096
    v_mfma_f32_16x16x32_bf16 v[84:87], v[164:167], a[200:203], v[84:87]
    ds_read_b64_tr_b16 v[178:179], v12 offset:6144
    ds_read_b64_tr_b16 v[180:181], v12 offset:4104
    v_mfma_f32_16x16x32_bf16 v[76:79], v[164:167], a[196:199], v[76:79]
    ds_read_b64_tr_b16 v[182:183], v12 offset:6152
    ds_read_b64_tr_b16 v[184:185], v13 offset:4096
    v_mfma_f32_16x16x32_bf16 v[68:71], v[164:167], a[192:195], v[68:71]
    buffer_load_dwordx4 v45, s[24:27], s44 offen offset:1024 lds
    v_mfma_f32_16x16x32_bf16 v[96:99], v[168:171], a[192:195], v[96:99]
    ds_read_b64_tr_b16 v[186:187], v13 offset:6144
    ds_read_b64_tr_b16 v[188:189], v13 offset:4104
    v_mfma_f32_16x16x32_bf16 v[104:107], v[168:171], a[196:199], v[104:107]
    ds_read_b64_tr_b16 v[190:191], v13 offset:6152
    v_mfma_f32_16x16x32_bf16 v[112:115], v[168:171], a[200:203], v[112:115]
    v_mfma_f32_16x16x32_bf16 v[120:123], v[168:171], a[204:207], v[120:123]
    buffer_load_dwordx4 v46, s[24:27], s44 offen offset:2048 lds
    v_mfma_f32_16x16x32_bf16 v[124:127], v[172:175], a[204:207], v[124:127]
    v_mfma_f32_16x16x32_bf16 v[116:119], v[172:175], a[200:203], v[116:119]
    v_mfma_f32_16x16x32_bf16 v[108:111], v[172:175], a[196:199], v[108:111]
    v_mfma_f32_16x16x32_bf16 v[100:103], v[172:175], a[192:195], v[100:103]
    buffer_load_dwordx4 v47, s[24:27], s44 offen offset:3072 lds
    s_waitcnt lgkmcnt(0)
    v_mfma_f32_16x16x32_bf16 v[64:67], v[176:179], a[208:211], v[64:67]
    s_add_u32 m0, s43, 4096
    s_add_u32 s44, s56, 786432
    s_bfe_u32 s44, s44, 589837
    s_mul_i32 s44, s44, 3584
    v_mfma_f32_16x16x32_bf16 v[72:75], v[176:179], a[212:215], v[72:75]
    ds_read_b128 a[224:227], v6 offset:57344
    ds_read_b128 a[228:231], v6 offset:58368
    v_mfma_f32_16x16x32_bf16 v[80:83], v[176:179], a[216:219], v[80:83]
    ds_read_b128 a[232:235], v6 offset:59392
    ds_read_b128 a[236:239], v6 offset:60416
    v_mfma_f32_16x16x32_bf16 v[88:91], v[176:179], a[220:223], v[88:91]
    buffer_load_dwordx4 v44, s[24:27], s44 offen offset:0 lds
    v_mfma_f32_16x16x32_bf16 v[92:95], v[180:183], a[220:223], v[92:95]
    s_waitcnt vmcnt(17)
    ds_read_b64_tr_b16 v[160:161], v12 offset:8192
    v_mfma_f32_16x16x32_bf16 v[84:87], v[180:183], a[216:219], v[84:87]
    ds_read_b64_tr_b16 v[162:163], v12 offset:10240
    ds_read_b64_tr_b16 v[164:165], v12 offset:8200
    v_mfma_f32_16x16x32_bf16 v[76:79], v[180:183], a[212:215], v[76:79]
    ds_read_b64_tr_b16 v[166:167], v12 offset:10248
    ds_read_b64_tr_b16 v[168:169], v13 offset:8192
    v_mfma_f32_16x16x32_bf16 v[68:71], v[180:183], a[208:211], v[68:71]
    buffer_load_dwordx4 v45, s[24:27], s44 offen offset:1024 lds
    v_mfma_f32_16x16x32_bf16 v[96:99], v[184:187], a[208:211], v[96:99]
    ds_read_b64_tr_b16 v[170:171], v13 offset:10240
    ds_read_b64_tr_b16 v[172:173], v13 offset:8200
    v_mfma_f32_16x16x32_bf16 v[104:107], v[184:187], a[212:215], v[104:107]
    ds_read_b64_tr_b16 v[174:175], v13 offset:10248
    v_mfma_f32_16x16x32_bf16 v[112:115], v[184:187], a[216:219], v[112:115]
    v_mfma_f32_16x16x32_bf16 v[120:123], v[184:187], a[220:223], v[120:123]
    buffer_load_dwordx4 v46, s[24:27], s44 offen offset:2048 lds
    v_mfma_f32_16x16x32_bf16 v[124:127], v[188:191], a[220:223], v[124:127]
    v_mfma_f32_16x16x32_bf16 v[116:119], v[188:191], a[216:219], v[116:119]
    v_mfma_f32_16x16x32_bf16 v[108:111], v[188:191], a[212:215], v[108:111]
    v_mfma_f32_16x16x32_bf16 v[100:103], v[188:191], a[208:211], v[100:103]
    buffer_load_dwordx4 v47, s[24:27], s44 offen offset:3072 lds
    s_waitcnt lgkmcnt(0)
    v_mfma_f32_16x16x32_bf16 v[64:67], v[160:163], a[224:227], v[64:67]
    s_add_u32 m0, s43, 8192
    s_add_u32 s44, s56, 1048576
    s_bfe_u32 s44, s44, 589837
    s_mul_i32 s44, s44, 3584
    v_mfma_f32_16x16x32_bf16 v[72:75], v[160:163], a[228:231], v[72:75]
    ds_read_b128 a[240:243], v7 offset:61440
    ds_read_b128 a[244:247], v7 offset:62464
    v_mfma_f32_16x16x32_bf16 v[80:83], v[160:163], a[232:235], v[80:83]
    ds_read_b128 a[248:251], v7 offset:63488
    ds_read_b128 a[252:255], v7 offset:64512
    v_mfma_f32_16x16x32_bf16 v[88:91], v[160:163], a[236:239], v[88:91]
    buffer_load_dwordx4 v44, s[24:27], s44 offen offset:0 lds
    v_mfma_f32_16x16x32_bf16 v[92:95], v[164:167], a[236:239], v[92:95]
    s_waitcnt vmcnt(17)
    ds_read_b64_tr_b16 v[176:177], v12 offset:12288
    v_mfma_f32_16x16x32_bf16 v[84:87], v[164:167], a[232:235], v[84:87]
    ds_read_b64_tr_b16 v[178:179], v12 offset:14336
    ds_read_b64_tr_b16 v[180:181], v12 offset:12296
    v_mfma_f32_16x16x32_bf16 v[76:79], v[164:167], a[228:231], v[76:79]
    ds_read_b64_tr_b16 v[182:183], v12 offset:14344
    ds_read_b64_tr_b16 v[184:185], v13 offset:12288
    v_mfma_f32_16x16x32_bf16 v[68:71], v[164:167], a[224:227], v[68:71]
    buffer_load_dwordx4 v45, s[24:27], s44 offen offset:1024 lds
    v_mfma_f32_16x16x32_bf16 v[96:99], v[168:171], a[224:227], v[96:99]
    ds_read_b64_tr_b16 v[186:187], v13 offset:14336
    ds_read_b64_tr_b16 v[188:189], v13 offset:12296
    v_mfma_f32_16x16x32_bf16 v[104:107], v[168:171], a[228:231], v[104:107]
    ds_read_b64_tr_b16 v[190:191], v13 offset:14344
    v_mfma_f32_16x16x32_bf16 v[112:115], v[168:171], a[232:235], v[112:115]
    v_mfma_f32_16x16x32_bf16 v[120:123], v[168:171], a[236:239], v[120:123]
    buffer_load_dwordx4 v46, s[24:27], s44 offen offset:2048 lds
    v_mfma_f32_16x16x32_bf16 v[124:127], v[172:175], a[236:239], v[124:127]
    v_mfma_f32_16x16x32_bf16 v[116:119], v[172:175], a[232:235], v[116:119]
    v_mfma_f32_16x16x32_bf16 v[108:111], v[172:175], a[228:231], v[108:111]
    v_mfma_f32_16x16x32_bf16 v[100:103], v[172:175], a[224:227], v[100:103]
    buffer_load_dwordx4 v47, s[24:27], s44 offen offset:3072 lds
    s_waitcnt lgkmcnt(0)
    v_mfma_f32_16x16x32_bf16 v[64:67], v[176:179], a[240:243], v[64:67]
    s_add_u32 m0, s43, 12288
    s_add_u32 s44, s56, 1310720
    s_bfe_u32 s44, s44, 589837
    s_mul_i32 s44, s44, 3584
    v_mfma_f32_16x16x32_bf16 v[72:75], v[176:179], a[244:247], v[72:75]
    s_waitcnt vmcnt(16)
    v_mfma_f32_16x16x32_bf16 v[80:83], v[176:179], a[248:251], v[80:83]
    ds_read_b64_tr_b16 v[160:161], v2 offset:16384
    v_mfma_f32_16x16x32_bf16 v[88:91], v[176:179], a[252:255], v[88:91]
    buffer_load_dwordx4 v44, s[24:27], s44 offen offset:0 lds
    v_mfma_f32_16x16x32_bf16 v[92:95], v[180:183], a[252:255], v[92:95]
    ds_read_b64_tr_b16 v[162:163], v2 offset:18432
    v_mfma_f32_16x16x32_bf16 v[84:87], v[180:183], a[248:251], v[84:87]
    ds_read_b64_tr_b16 v[164:165], v3 offset:16384
    v_mfma_f32_16x16x32_bf16 v[76:79], v[180:183], a[244:247], v[76:79]
    ds_read_b64_tr_b16 v[166:167], v3 offset:18432
    v_mfma_f32_16x16x32_bf16 v[68:71], v[180:183], a[240:243], v[68:71]
    buffer_load_dwordx4 v45, s[24:27], s44 offen offset:1024 lds
    v_mfma_f32_16x16x32_bf16 v[96:99], v[184:187], a[240:243], v[96:99]
    ds_read_b64_tr_b16 v[168:169], v4 offset:16384
    v_mfma_f32_16x16x32_bf16 v[104:107], v[184:187], a[244:247], v[104:107]
    ds_read_b64_tr_b16 v[170:171], v4 offset:18432
    v_mfma_f32_16x16x32_bf16 v[112:115], v[184:187], a[248:251], v[112:115]
    ds_read_b64_tr_b16 v[172:173], v5 offset:16384
    v_mfma_f32_16x16x32_bf16 v[120:123], v[184:187], a[252:255], v[120:123]
    buffer_load_dwordx4 v46, s[24:27], s44 offen offset:2048 lds
    v_mfma_f32_16x16x32_bf16 v[124:127], v[188:191], a[252:255], v[124:127]
    ds_read_b64_tr_b16 v[174:175], v5 offset:18432
    v_mfma_f32_16x16x32_bf16 v[116:119], v[188:191], a[248:251], v[116:119]
    v_mfma_f32_16x16x32_bf16 v[108:111], v[188:191], a[244:247], v[108:111]
    v_mfma_f32_16x16x32_bf16 v[100:103], v[188:191], a[240:243], v[100:103]
    buffer_load_dwordx4 v47, s[24:27], s44 offen offset:3072 lds
    s_nop 1
    s_waitcnt lgkmcnt(0)
    v_mfma_f32_16x16x32_bf16 v[192:195], v[160:163], a[0:3], v[144:147]
    s_add_u32 m0, s43, 16384
    s_add_u32 s44, s56, 1572864
    s_bfe_u32 s44, s44, 589837
    s_mul_i32 s44, s44, 3584
    v_mfma_f32_16x16x32_bf16 v[200:203], v[160:163], a[4:7], v[144:147]
    s_waitcnt vmcnt(16)
    v_mfma_f32_16x16x32_bf16 v[208:211], v[160:163], a[8:11], v[144:147]
    ds_read_b64_tr_b16 v[176:177], v2 offset:20480
    v_mfma_f32_16x16x32_bf16 v[216:219], v[160:163], a[12:15], v[144:147]
    buffer_load_dwordx4 v44, s[24:27], s44 offen offset:0 lds
    v_mfma_f32_16x16x32_bf16 v[220:223], v[164:167], a[12:15], v[148:151]
    ds_read_b64_tr_b16 v[178:179], v2 offset:22528
    v_mfma_f32_16x16x32_bf16 v[212:215], v[164:167], a[8:11], v[148:151]
    ds_read_b64_tr_b16 v[180:181], v3 offset:20480
    v_mfma_f32_16x16x32_bf16 v[204:207], v[164:167], a[4:7], v[148:151]
    ds_read_b64_tr_b16 v[182:183], v3 offset:22528
    v_mfma_f32_16x16x32_bf16 v[196:199], v[164:167], a[0:3], v[148:151]
    buffer_load_dwordx4 v45, s[24:27], s44 offen offset:1024 lds
    v_mfma_f32_16x16x32_bf16 v[224:227], v[168:171], a[0:3], v[152:155]
    ds_read_b64_tr_b16 v[184:185], v4 offset:20480
    v_mfma_f32_16x16x32_bf16 v[232:235], v[168:171], a[4:7], v[152:155]
    ds_read_b64_tr_b16 v[186:187], v4 offset:22528
    v_mfma_f32_16x16x32_bf16 v[240:243], v[168:171], a[8:11], v[152:155]
    ds_read_b64_tr_b16 v[188:189], v5 offset:20480
    v_mfma_f32_16x16x32_bf16 v[248:251], v[168:171], a[12:15], v[152:155]
    buffer_load_dwordx4 v46, s[24:27], s44 offen offset:2048 lds
    v_mfma_f32_16x16x32_bf16 v[252:255], v[172:175], a[12:15], v[156:159]
    ds_read_b64_tr_b16 v[190:191], v5 offset:22528
    v_mfma_f32_16x16x32_bf16 v[244:247], v[172:175], a[8:11], v[156:159]
    v_mfma_f32_16x16x32_bf16 v[236:239], v[172:175], a[4:7], v[156:159]
    v_mfma_f32_16x16x32_bf16 v[228:231], v[172:175], a[0:3], v[156:159]
    buffer_load_dwordx4 v47, s[24:27], s44 offen offset:3072 lds
    s_barrier
    s_waitcnt lgkmcnt(0)
    v_mfma_f32_16x16x32_bf16 v[192:195], v[176:179], a[16:19], v[192:195]
    s_add_u32 m0, s43, 20480
    s_add_u32 s44, s56, 1835008
    s_bfe_u32 s44, s44, 589837
    s_mul_i32 s44, s44, 3584
    v_mfma_f32_16x16x32_bf16 v[200:203], v[176:179], a[20:23], v[200:203]
    s_waitcnt vmcnt(16)
    v_cvt_pk_bf16_f32 v64, v64, v65
    v_mfma_f32_16x16x32_bf16 v[208:211], v[176:179], a[24:27], v[208:211]
    ds_read_b64_tr_b16 v[160:161], v2 offset:0
    v_cvt_pk_bf16_f32 v65, v66, v67
    v_mfma_f32_16x16x32_bf16 v[216:219], v[176:179], a[28:31], v[216:219]
    buffer_load_dwordx4 v44, s[24:27], s44 offen offset:0 lds
    v_mfma_f32_16x16x32_bf16 v[220:223], v[180:183], a[28:31], v[220:223]
    ds_read_b64_tr_b16 v[162:163], v2 offset:2048
    v_cvt_pk_bf16_f32 v66, v68, v69
    v_mfma_f32_16x16x32_bf16 v[212:215], v[180:183], a[24:27], v[212:215]
    ds_read_b64_tr_b16 v[164:165], v3 offset:0
    v_cvt_pk_bf16_f32 v67, v70, v71
    v_mfma_f32_16x16x32_bf16 v[204:207], v[180:183], a[20:23], v[204:207]
    ds_read_b64_tr_b16 v[166:167], v3 offset:2048
    v_cvt_pk_bf16_f32 v68, v72, v73
    v_mfma_f32_16x16x32_bf16 v[196:199], v[180:183], a[16:19], v[196:199]
    buffer_load_dwordx4 v45, s[24:27], s44 offen offset:1024 lds
    v_mfma_f32_16x16x32_bf16 v[224:227], v[184:187], a[16:19], v[224:227]
    ds_read_b64_tr_b16 v[168:169], v4 offset:0
    v_cvt_pk_bf16_f32 v69, v74, v75
    v_mfma_f32_16x16x32_bf16 v[232:235], v[184:187], a[20:23], v[232:235]
    ds_read_b64_tr_b16 v[170:171], v4 offset:2048
    v_cvt_pk_bf16_f32 v70, v76, v77
    v_mfma_f32_16x16x32_bf16 v[240:243], v[184:187], a[24:27], v[240:243]
    ds_read_b64_tr_b16 v[172:173], v5 offset:0
    v_cvt_pk_bf16_f32 v71, v78, v79
    v_mfma_f32_16x16x32_bf16 v[248:251], v[184:187], a[28:31], v[248:251]
    buffer_load_dwordx4 v46, s[24:27], s44 offen offset:2048 lds
    v_mfma_f32_16x16x32_bf16 v[252:255], v[188:191], a[28:31], v[252:255]
    ds_read_b64_tr_b16 v[174:175], v5 offset:2048
    v_cvt_pk_bf16_f32 v72, v80, v81
    v_mfma_f32_16x16x32_bf16 v[244:247], v[188:191], a[24:27], v[244:247]
    v_cvt_pk_bf16_f32 v73, v82, v83
    v_cvt_pk_bf16_f32 v74, v84, v85
    v_mfma_f32_16x16x32_bf16 v[236:239], v[188:191], a[20:23], v[236:239]
    v_cvt_pk_bf16_f32 v75, v86, v87
    v_cvt_pk_bf16_f32 v76, v88, v89
    v_mfma_f32_16x16x32_bf16 v[228:231], v[188:191], a[16:19], v[228:231]
    buffer_load_dwordx4 v47, s[24:27], s44 offen offset:3072 lds
    s_waitcnt lgkmcnt(0)
    v_mfma_f32_16x16x32_bf16 v[192:195], v[160:163], a[32:35], v[192:195]
    s_add_u32 m0, s43, 0
    s_add_u32 s44, s56, 2097152
    s_bfe_u32 s44, s44, 589837
    s_mul_i32 s44, s44, 3584
    v_mfma_f32_16x16x32_bf16 v[200:203], v[160:163], a[36:39], v[200:203]
    s_waitcnt vmcnt(16)
    v_cvt_pk_bf16_f32 v77, v90, v91
    v_mfma_f32_16x16x32_bf16 v[208:211], v[160:163], a[40:43], v[208:211]
    ds_read_b64_tr_b16 v[176:177], v2 offset:4096
    v_cvt_pk_bf16_f32 v78, v92, v93
    v_mfma_f32_16x16x32_bf16 v[216:219], v[160:163], a[44:47], v[216:219]
    buffer_load_dwordx4 v44, s[24:27], s44 offen offset:0 lds
    v_mfma_f32_16x16x32_bf16 v[220:223], v[164:167], a[44:47], v[220:223]
    ds_read_b64_tr_b16 v[178:179], v2 offset:6144
    v_cvt_pk_bf16_f32 v79, v94, v95
    v_mfma_f32_16x16x32_bf16 v[212:215], v[164:167], a[40:43], v[212:215]
    ds_read_b64_tr_b16 v[180:181], v3 offset:4096
    v_cvt_pk_bf16_f32 v80, v96, v97
    v_mfma_f32_16x16x32_bf16 v[204:207], v[164:167], a[36:39], v[204:207]
    ds_read_b64_tr_b16 v[182:183], v3 offset:6144
    v_cvt_pk_bf16_f32 v81, v98, v99
    v_mfma_f32_16x16x32_bf16 v[196:199], v[164:167], a[32:35], v[196:199]
    buffer_load_dwordx4 v45, s[24:27], s44 offen offset:1024 lds
    v_mfma_f32_16x16x32_bf16 v[224:227], v[168:171], a[32:35], v[224:227]
    ds_read_b64_tr_b16 v[184:185], v4 offset:4096
    v_cvt_pk_bf16_f32 v82, v100, v101
    v_mfma_f32_16x16x32_bf16 v[232:235], v[168:171], a[36:39], v[232:235]
    ds_read_b64_tr_b16 v[186:187], v4 offset:6144
    v_cvt_pk_bf16_f32 v83, v102, v103
    v_mfma_f32_16x16x32_bf16 v[240:243], v[168:171], a[40:43], v[240:243]
    ds_read_b64_tr_b16 v[188:189], v5 offset:4096
    v_cvt_pk_bf16_f32 v84, v104, v105
    v_mfma_f32_16x16x32_bf16 v[248:251], v[168:171], a[44:47], v[248:251]
    buffer_load_dwordx4 v46, s[24:27], s44 offen offset:2048 lds
    v_mfma_f32_16x16x32_bf16 v[252:255], v[172:175], a[44:47], v[252:255]
    ds_read_b64_tr_b16 v[190:191], v5 offset:6144
    v_cvt_pk_bf16_f32 v85, v106, v107
    v_mfma_f32_16x16x32_bf16 v[244:247], v[172:175], a[40:43], v[244:247]
    v_cvt_pk_bf16_f32 v86, v108, v109
    v_cvt_pk_bf16_f32 v87, v110, v111
    v_mfma_f32_16x16x32_bf16 v[236:239], v[172:175], a[36:39], v[236:239]
    v_cvt_pk_bf16_f32 v88, v112, v113
    v_cvt_pk_bf16_f32 v89, v114, v115
    v_mfma_f32_16x16x32_bf16 v[228:231], v[172:175], a[32:35], v[228:231]
    buffer_load_dwordx4 v47, s[24:27], s44 offen offset:3072 lds
    s_waitcnt lgkmcnt(0)
    v_mfma_f32_16x16x32_bf16 v[192:195], v[176:179], a[48:51], v[192:195]
    s_add_u32 m0, s43, 4096
    s_add_u32 s44, s56, 2359296
    s_bfe_u32 s44, s44, 589837
    s_mul_i32 s44, s44, 3584
    v_mfma_f32_16x16x32_bf16 v[200:203], v[176:179], a[52:55], v[200:203]
    s_waitcnt vmcnt(16)
    v_cvt_pk_bf16_f32 v90, v116, v117
    v_mfma_f32_16x16x32_bf16 v[208:211], v[176:179], a[56:59], v[208:211]
    ds_read_b64_tr_b16 v[160:161], v2 offset:8192
    v_cvt_pk_bf16_f32 v91, v118, v119
    v_mfma_f32_16x16x32_bf16 v[216:219], v[176:179], a[60:63], v[216:219]
    buffer_load_dwordx4 v44, s[24:27], s44 offen offset:0 lds
    v_mfma_f32_16x16x32_bf16 v[220:223], v[180:183], a[60:63], v[220:223]
    ds_read_b64_tr_b16 v[162:163], v2 offset:10240
    v_cvt_pk_bf16_f32 v92, v120, v121
    v_mfma_f32_16x16x32_bf16 v[212:215], v[180:183], a[56:59], v[212:215]
    ds_read_b64_tr_b16 v[164:165], v3 offset:8192
    v_cvt_pk_bf16_f32 v93, v122, v123
    v_mfma_f32_16x16x32_bf16 v[204:207], v[180:183], a[52:55], v[204:207]
    ds_read_b64_tr_b16 v[166:167], v3 offset:10240
    v_cvt_pk_bf16_f32 v94, v124, v125
    v_mfma_f32_16x16x32_bf16 v[196:199], v[180:183], a[48:51], v[196:199]
    buffer_load_dwordx4 v45, s[24:27], s44 offen offset:1024 lds
    v_mfma_f32_16x16x32_bf16 v[224:227], v[184:187], a[48:51], v[224:227]
    ds_read_b64_tr_b16 v[168:169], v4 offset:8192
    v_cvt_pk_bf16_f32 v95, v126, v127
    v_mfma_f32_16x16x32_bf16 v[232:235], v[184:187], a[52:55], v[232:235]
    ds_read_b64_tr_b16 v[170:171], v4 offset:10240
    s_and_b32 s46, s41, 1
    v_mfma_f32_16x16x32_bf16 v[240:243], v[184:187], a[56:59], v[240:243]
    ds_read_b64_tr_b16 v[172:173], v5 offset:8192
    s_lshl_b32 s47, s46, 12
    v_mfma_f32_16x16x32_bf16 v[248:251], v[184:187], a[60:63], v[248:251]
    buffer_load_dwordx4 v46, s[24:27], s44 offen offset:2048 lds
    v_mfma_f32_16x16x32_bf16 v[252:255], v[188:191], a[60:63], v[252:255]
    ds_read_b64_tr_b16 v[174:175], v5 offset:10240
    s_lshl_b32 s46, s46, 6
    v_mfma_f32_16x16x32_bf16 v[244:247], v[188:191], a[56:59], v[244:247]
    v_xor_b32 v8, s46, v6
    v_add_u32 v8, s47, v8
    v_mfma_f32_16x16x32_bf16 v[236:239], v[188:191], a[52:55], v[236:239]
    v_xor_b32 v9, s46, v7
    v_add_u32 v9, s47, v9
    v_mfma_f32_16x16x32_bf16 v[228:231], v[188:191], a[48:51], v[228:231]
    buffer_load_dwordx4 v47, s[24:27], s44 offen offset:3072 lds
    s_waitcnt lgkmcnt(0)
    v_mfma_f32_16x16x32_bf16 v[192:195], v[160:163], a[64:67], v[192:195]
    s_add_u32 m0, s43, 8192
    s_add_u32 s44, s56, 2621440
    s_bfe_u32 s44, s44, 589837
    s_mul_i32 s44, s44, 3584
    v_mfma_f32_16x16x32_bf16 v[200:203], v[160:163], a[68:71], v[200:203]
    s_waitcnt vmcnt(16)
    s_lshl_b32 s46, s40, 8
    v_mfma_f32_16x16x32_bf16 v[208:211], v[160:163], a[72:75], v[208:211]
    ds_read_b64_tr_b16 v[176:177], v2 offset:12288
    s_lshl_b32 s47, s41, 2
    v_mfma_f32_16x16x32_bf16 v[216:219], v[160:163], a[76:79], v[216:219]
    buffer_load_dwordx4 v44, s[24:27], s44 offen offset:0 lds
    v_mfma_f32_16x16x32_bf16 v[220:223], v[164:167], a[76:79], v[220:223]
    ds_read_b64_tr_b16 v[178:179], v2 offset:14336
    s_add_u32 s46, s46, s47
    v_mfma_f32_16x16x32_bf16 v[212:215], v[164:167], a[72:75], v[212:215]
    ds_read_b64_tr_b16 v[180:181], v3 offset:12288
    v_min_u32 v10, 1, v1
    v_mfma_f32_16x16x32_bf16 v[204:207], v[164:167], a[68:71], v[204:207]
    ds_read_b64_tr_b16 v[182:183], v3 offset:14336
    v_lshlrev_b32 v10, 30, v10
    v_mfma_f32_16x16x32_bf16 v[196:199], v[164:167], a[64:67], v[196:199]
    buffer_load_dwordx4 v45, s[24:27], s44 offen offset:1024 lds
    v_mfma_f32_16x16x32_bf16 v[224:227], v[168:171], a[64:67], v[224:227]
    ds_read_b64_tr_b16 v[184:185], v4 offset:12288
    v_add_u32 v10, s46, v10
    v_mfma_f32_16x16x32_bf16 v[232:235], v[168:171], a[68:71], v[232:235]
    ds_read_b64_tr_b16 v[186:187], v4 offset:14336
    s_lshl_b32 s46, s40, 8
    v_mfma_f32_16x16x32_bf16 v[240:243], v[168:171], a[72:75], v[240:243]
    ds_read_b64_tr_b16 v[188:189], v5 offset:12288
    v_and_b32 v11, 7, v1
    v_mfma_f32_16x16x32_bf16 v[248:251], v[168:171], a[76:79], v[248:251]
    buffer_load_dwordx4 v46, s[24:27], s44 offen offset:2048 lds
    v_mfma_f32_16x16x32_bf16 v[252:255], v[172:175], a[76:79], v[252:255]
    ds_read_b64_tr_b16 v[190:191], v5 offset:14336
    v_lshlrev_b32 v11, 2, v11
    v_mfma_f32_16x16x32_bf16 v[244:247], v[172:175], a[72:75], v[244:247]
    v_add_u32 v11, s46, v11
    v_add_u32 v31, 8192, v30
    v_mfma_f32_16x16x32_bf16 v[236:239], v[172:175], a[68:71], v[236:239]
    v_mov_b32 v36, 0x3f803f80
    v_mov_b32 v37, 0x3f803f80
    v_mfma_f32_16x16x32_bf16 v[228:231], v[172:175], a[64:67], v[228:231]
    buffer_load_dwordx4 v47, s[24:27], s44 offen offset:3072 lds
    s_mul_i32 s53, s42, 7168
    buffer_load_dword v49, v63, s[28:31], s53 offen
    s_lshl_b32 s53, s42, 12
    buffer_load_dword v49, v62, s[8:11], s53 offen
    s_lshl_b32 s53, s42, 12
    buffer_load_dword v49, v62, s[12:15], s53 offen
    s_waitcnt lgkmcnt(0)
    v_mfma_f32_16x16x32_bf16 v[192:195], v[176:179], a[80:83], v[192:195]
    s_add_u32 m0, s43, 12288
    s_add_u32 s44, s56, 2883584
    s_bfe_u32 s44, s44, 589837
    s_mul_i32 s44, s44, 3584
    v_mfma_f32_16x16x32_bf16 v[200:203], v[176:179], a[84:87], v[200:203]
    s_waitcnt vmcnt(19)
    v_mov_b32 v38, 0x3f803f80
    v_mfma_f32_16x16x32_bf16 v[208:211], v[176:179], a[88:91], v[208:211]
    ds_read_b64_tr_b16 v[160:161], v2 offset:16384
    v_mov_b32 v39, 0x3f803f80
    v_mfma_f32_16x16x32_bf16 v[216:219], v[176:179], a[92:95], v[216:219]
    buffer_load_dwordx4 v44, s[24:27], s44 offen offset:0 lds
    v_mfma_f32_16x16x32_bf16 v[220:223], v[180:183], a[92:95], v[220:223]
    ds_read_b64_tr_b16 v[162:163], v2 offset:18432
    s_mul_i32 s46, s42, 1083392
    v_mfma_f32_16x16x32_bf16 v[212:215], v[180:183], a[88:91], v[212:215]
    ds_read_b64_tr_b16 v[164:165], v3 offset:16384
    v_mfma_f32_16x16x32_bf16 v[204:207], v[180:183], a[84:87], v[204:207]
    ds_read_b64_tr_b16 v[166:167], v3 offset:18432
    v_mfma_f32_16x16x32_bf16 v[196:199], v[180:183], a[80:83], v[196:199]
    buffer_load_dwordx4 v45, s[24:27], s44 offen offset:1024 lds
    v_mfma_f32_16x16x32_bf16 v[224:227], v[184:187], a[80:83], v[224:227]
    ds_read_b64_tr_b16 v[168:169], v4 offset:16384
    v_mfma_f32_16x16x32_bf16 v[232:235], v[184:187], a[84:87], v[232:235]
    ds_read_b64_tr_b16 v[170:171], v4 offset:18432
    v_mfma_f32_16x16x32_bf16 v[240:243], v[184:187], a[88:91], v[240:243]
    ds_read_b64_tr_b16 v[172:173], v5 offset:16384
    v_mfma_f32_16x16x32_bf16 v[248:251], v[184:187], a[92:95], v[248:251]
    buffer_load_dwordx4 v46, s[24:27], s44 offen offset:2048 lds
    v_mfma_f32_16x16x32_bf16 v[252:255], v[188:191], a[92:95], v[252:255]
    ds_read_b64_tr_b16 v[174:175], v5 offset:18432
    v_mfma_f32_16x16x32_bf16 v[244:247], v[188:191], a[88:91], v[244:247]
    s_add_u32 s36, s58, s46
    s_addc_u32 s37, s59, 0
    v_mfma_f32_16x16x32_bf16 v[236:239], v[188:191], a[84:87], v[236:239]
    s_mov_b32 s38, 1083392
    s_mov_b32 s39, 0x00020000
    v_mfma_f32_16x16x32_bf16 v[228:231], v[188:191], a[80:83], v[228:231]
    buffer_load_dwordx4 v47, s[24:27], s44 offen offset:3072 lds
    s_waitcnt lgkmcnt(0)
    v_mfma_f32_16x16x32_bf16 v[192:195], v[160:163], a[96:99], v[192:195]
    s_add_u32 m0, s43, 16384
    s_add_u32 s44, s56, 3145728
    s_bfe_u32 s44, s44, 589837
    s_mul_i32 s44, s44, 3584
    v_mfma_f32_16x16x32_bf16 v[200:203], v[160:163], a[100:103], v[200:203]
    s_waitcnt vmcnt(19)
    s_mul_i32 s47, s41, 135424
    v_mfma_f32_16x16x32_bf16 v[208:211], v[160:163], a[104:107], v[208:211]
    ds_read_b64_tr_b16 v[176:177], v2 offset:20480
    s_add_u32 s46, s46, s47
    v_mfma_f32_16x16x32_bf16 v[216:219], v[160:163], a[108:111], v[216:219]
    buffer_load_dwordx4 v44, s[24:27], s44 offen offset:0 lds
    v_mfma_f32_16x16x32_bf16 v[220:223], v[164:167], a[108:111], v[220:223]
    ds_read_b64_tr_b16 v[178:179], v2 offset:22528
    v_mfma_f32_16x16x32_bf16 v[212:215], v[164:167], a[104:107], v[212:215]
    ds_read_b64_tr_b16 v[180:181], v3 offset:20480
    v_mfma_f32_16x16x32_bf16 v[204:207], v[164:167], a[100:103], v[204:207]
    ds_read_b64_tr_b16 v[182:183], v3 offset:22528
    v_mfma_f32_16x16x32_bf16 v[196:199], v[164:167], a[96:99], v[196:199]
    buffer_load_dwordx4 v45, s[24:27], s44 offen offset:1024 lds
    v_mfma_f32_16x16x32_bf16 v[224:227], v[168:171], a[96:99], v[224:227]
    ds_read_b64_tr_b16 v[184:185], v4 offset:20480
    v_mfma_f32_16x16x32_bf16 v[232:235], v[168:171], a[100:103], v[232:235]
    ds_read_b64_tr_b16 v[186:187], v4 offset:22528
    v_mfma_f32_16x16x32_bf16 v[240:243], v[168:171], a[104:107], v[240:243]
    ds_read_b64_tr_b16 v[188:189], v5 offset:20480
    v_mfma_f32_16x16x32_bf16 v[248:251], v[168:171], a[108:111], v[248:251]
    buffer_load_dwordx4 v46, s[24:27], s44 offen offset:2048 lds
    v_mfma_f32_16x16x32_bf16 v[252:255], v[172:175], a[108:111], v[252:255]
    ds_read_b64_tr_b16 v[190:191], v5 offset:22528
    v_mfma_f32_16x16x32_bf16 v[244:247], v[172:175], a[104:107], v[244:247]
    s_add_u32 s88, s58, s46
    s_addc_u32 s89, s59, 0
    v_mfma_f32_16x16x32_bf16 v[236:239], v[172:175], a[100:103], v[236:239]
    s_mov_b32 s90, 131072
    s_mov_b32 s91, 0x00020000
    v_mfma_f32_16x16x32_bf16 v[228:231], v[172:175], a[96:99], v[228:231]
    buffer_load_dwordx4 v47, s[24:27], s44 offen offset:3072 lds
    s_waitcnt lgkmcnt(0)
    v_mfma_f32_16x16x32_bf16 v[192:195], v[176:179], a[112:115], v[192:195]
    s_add_u32 m0, s43, 20480
L_pg1:
    s_cbranch_execz L_pg5
    s_add_u32 s44, s56, 3407872
    s_bfe_u32 s44, s44, 589837
    s_mul_i32 s44, s44, 3584
    v_mfma_f32_16x16x32_bf16 v[200:203], v[176:179], a[116:119], v[200:203]
    s_waitcnt vmcnt(19)
    s_lshr_b32 s47, s41, 2
    v_mfma_f32_16x16x32_bf16 v[208:211], v[176:179], a[120:123], v[208:211]
    ds_read_b64_tr_b16 v[160:161], v2 offset:0
    s_lshl_b32 s47, s47, 6
    v_mfma_f32_16x16x32_bf16 v[216:219], v[176:179], a[124:127], v[216:219]
    buffer_load_dwordx4 v44, s[24:27], s44 offen offset:0 lds
    v_mfma_f32_16x16x32_bf16 v[220:223], v[180:183], a[124:127], v[220:223]
    ds_read_b64_tr_b16 v[162:163], v2 offset:2048
    s_lshl_b32 s46, s40, 8
    v_mfma_f32_16x16x32_bf16 v[212:215], v[180:183], a[120:123], v[212:215]
    ds_read_b64_tr_b16 v[164:165], v3 offset:0
    s_add_u32 s47, s47, s46
    v_mfma_f32_16x16x32_bf16 v[204:207], v[180:183], a[116:119], v[204:207]
    ds_read_b64_tr_b16 v[166:167], v3 offset:2048
    v_mfma_f32_16x16x32_bf16 v[196:199], v[180:183], a[112:115], v[196:199]
    buffer_load_dwordx4 v45, s[24:27], s44 offen offset:1024 lds
    v_mfma_f32_16x16x32_bf16 v[224:227], v[184:187], a[112:115], v[224:227]
    ds_read_b64_tr_b16 v[168:169], v4 offset:0
    v_mfma_f32_16x16x32_bf16 v[232:235], v[184:187], a[116:119], v[232:235]
    ds_read_b64_tr_b16 v[170:171], v4 offset:2048
    v_mfma_f32_16x16x32_bf16 v[240:243], v[184:187], a[120:123], v[240:243]
    ds_read_b64_tr_b16 v[172:173], v5 offset:0
    v_mfma_f32_16x16x32_bf16 v[248:251], v[184:187], a[124:127], v[248:251]
    buffer_load_dwordx4 v46, s[24:27], s44 offen offset:2048 lds
    v_mfma_f32_16x16x32_bf16 v[252:255], v[188:191], a[124:127], v[252:255]
    ds_read_b64_tr_b16 v[174:175], v5 offset:2048
    v_mfma_f32_16x16x32_bf16 v[244:247], v[188:191], a[120:123], v[244:247]
    s_add_u32 s92, s94, s47
    s_addc_u32 s93, s95, 0
    v_mfma_f32_16x16x32_bf16 v[236:239], v[188:191], a[116:119], v[236:239]
    s_sub_u32 s94, 1024, s47
    s_mov_b32 s95, 0x00020000
    v_mfma_f32_16x16x32_bf16 v[228:231], v[188:191], a[112:115], v[228:231]
    buffer_load_dwordx4 v47, s[24:27], s44 offen offset:3072 lds
    s_waitcnt lgkmcnt(0)
    v_mfma_f32_16x16x32_bf16 v[192:195], v[160:163], a[128:131], v[192:195]
    s_add_u32 m0, s43, 0
    s_add_u32 s44, s56, 3670016
    s_bfe_u32 s44, s44, 589837
    s_mul_i32 s44, s44, 3584
    v_mfma_f32_16x16x32_bf16 v[200:203], v[160:163], a[132:135], v[200:203]
    s_waitcnt vmcnt(19)
    s_and_b32 s46, s41, 3
    v_mfma_f32_16x16x32_bf16 v[208:211], v[160:163], a[136:139], v[208:211]
    ds_read_b64_tr_b16 v[176:177], v2 offset:4096
    s_lshl_b32 s46, s46, 14
    v_mfma_f32_16x16x32_bf16 v[216:219], v[160:163], a[140:143], v[216:219]
    buffer_load_dwordx4 v44, s[24:27], s44 offen offset:0 lds
    v_mfma_f32_16x16x32_bf16 v[220:223], v[164:167], a[140:143], v[220:223]
    ds_read_b64_tr_b16 v[178:179], v2 offset:6144
    s_add_u32 s49, s46, s47
    v_mfma_f32_16x16x32_bf16 v[212:215], v[164:167], a[136:139], v[212:215]
    ds_read_b64_tr_b16 v[180:181], v3 offset:4096
    s_lshl_b32 s46, s42, 16
    v_mfma_f32_16x16x32_bf16 v[204:207], v[164:167], a[132:135], v[204:207]
    ds_read_b64_tr_b16 v[182:183], v3 offset:6144
    v_mfma_f32_16x16x32_bf16 v[196:199], v[164:167], a[128:131], v[196:199]
    buffer_load_dwordx4 v45, s[24:27], s44 offen offset:1024 lds
    v_mfma_f32_16x16x32_bf16 v[224:227], v[168:171], a[128:131], v[224:227]
    ds_read_b64_tr_b16 v[184:185], v4 offset:4096
    v_mfma_f32_16x16x32_bf16 v[232:235], v[168:171], a[132:135], v[232:235]
    ds_read_b64_tr_b16 v[186:187], v4 offset:6144
    v_mfma_f32_16x16x32_bf16 v[240:243], v[168:171], a[136:139], v[240:243]
    ds_read_b64_tr_b16 v[188:189], v5 offset:4096
    v_mfma_f32_16x16x32_bf16 v[248:251], v[168:171], a[140:143], v[248:251]
    buffer_load_dwordx4 v46, s[24:27], s44 offen offset:2048 lds
    v_mfma_f32_16x16x32_bf16 v[252:255], v[172:175], a[140:143], v[252:255]
    ds_read_b64_tr_b16 v[190:191], v5 offset:6144
    v_mfma_f32_16x16x32_bf16 v[244:247], v[172:175], a[136:139], v[244:247]
    s_add_u32 s96, s96, s46
    s_addc_u32 s97, s97, 0
    v_mfma_f32_16x16x32_bf16 v[236:239], v[172:175], a[132:135], v[236:239]
    s_mov_b32 s98, 65536
    s_mov_b32 s99, 0x00020000
    v_mfma_f32_16x16x32_bf16 v[228:231], v[172:175], a[128:131], v[228:231]
    buffer_load_dwordx4 v47, s[24:27], s44 offen offset:3072 lds
    s_waitcnt lgkmcnt(0)
    v_mfma_f32_16x16x32_bf16 v[192:195], v[176:179], a[144:147], v[192:195]
    s_add_u32 m0, s43, 4096
    s_add_u32 s44, s56, 3932160
    s_bfe_u32 s44, s44, 589837
    s_mul_i32 s44, s44, 3584
    v_mfma_f32_16x16x32_bf16 v[200:203], v[176:179], a[148:151], v[200:203]
    s_waitcnt vmcnt(19)
    v_mfma_f32_16x16x32_bf16 v[208:211], v[176:179], a[152:155], v[208:211]
    ds_read_b64_tr_b16 v[160:161], v2 offset:8192
    v_mfma_f32_16x16x32_bf16 v[216:219], v[176:179], a[156:159], v[216:219]
    buffer_load_dwordx4 v44, s[24:27], s44 offen offset:0 lds
    v_mfma_f32_16x16x32_bf16 v[220:223], v[180:183], a[156:159], v[220:223]
    ds_read_b64_tr_b16 v[162:163], v2 offset:10240
    v_mfma_f32_16x16x32_bf16 v[212:215], v[180:183], a[152:155], v[212:215]
    ds_read_b64_tr_b16 v[164:165], v3 offset:8192
    v_mfma_f32_16x16x32_bf16 v[204:207], v[180:183], a[148:151], v[204:207]
    ds_read_b64_tr_b16 v[166:167], v3 offset:10240
    v_mfma_f32_16x16x32_bf16 v[196:199], v[180:183], a[144:147], v[196:199]
    buffer_load_dwordx4 v45, s[24:27], s44 offen offset:1024 lds
    v_mfma_f32_16x16x32_bf16 v[224:227], v[184:187], a[144:147], v[224:227]
    ds_read_b64_tr_b16 v[168:169], v4 offset:8192
    v_mfma_f32_16x16x32_bf16 v[232:235], v[184:187], a[148:151], v[232:235]
    ds_read_b64_tr_b16 v[170:171], v4 offset:10240
    v_mfma_f32_16x16x32_bf16 v[240:243], v[184:187], a[152:155], v[240:243]
    ds_read_b64_tr_b16 v[172:173], v5 offset:8192
    v_mfma_f32_16x16x32_bf16 v[248:251], v[184:187], a[156:159], v[248:251]
    buffer_load_dwordx4 v46, s[24:27], s44 offen offset:2048 lds
    v_mfma_f32_16x16x32_bf16 v[252:255], v[188:191], a[156:159], v[252:255]
    ds_read_b64_tr_b16 v[174:175], v5 offset:10240
    v_mfma_f32_16x16x32_bf16 v[244:247], v[188:191], a[152:155], v[244:247]
    v_mfma_f32_16x16x32_bf16 v[236:239], v[188:191], a[148:151], v[236:239]
    v_mfma_f32_16x16x32_bf16 v[228:231], v[188:191], a[144:147], v[228:231]
    buffer_load_dwordx4 v47, s[24:27], s44 offen offset:3072 lds
    s_waitcnt lgkmcnt(0)
    v_mfma_f32_16x16x32_bf16 v[192:195], v[160:163], a[160:163], v[192:195]
    s_add_u32 m0, s43, 8192
    s_add_u32 s44, s56, 128
    s_and_b32 s44, s44, 4194047
    v_mfma_f32_16x16x32_bf16 v[200:203], v[160:163], a[164:167], v[200:203]
    s_waitcnt vmcnt(16)
    v_mfma_f32_16x16x32_bf16 v[208:211], v[160:163], a[168:171], v[208:211]
    ds_read_b64_tr_b16 v[176:177], v2 offset:12288
    v_mfma_f32_16x16x32_bf16 v[216:219], v[160:163], a[172:175], v[216:219]
    buffer_load_dwordx4 v40, s[16:19], s44 offen offset:0 lds
    v_mfma_f32_16x16x32_bf16 v[220:223], v[164:167], a[172:175], v[220:223]
    ds_read_b64_tr_b16 v[178:179], v2 offset:14336
    v_mfma_f32_16x16x32_bf16 v[212:215], v[164:167], a[168:171], v[212:215]
    ds_read_b64_tr_b16 v[180:181], v3 offset:12288
    v_mfma_f32_16x16x32_bf16 v[204:207], v[164:167], a[164:167], v[204:207]
    ds_read_b64_tr_b16 v[182:183], v3 offset:14336
    v_mfma_f32_16x16x32_bf16 v[196:199], v[164:167], a[160:163], v[196:199]
    buffer_load_dwordx4 v41, s[16:19], s44 offen offset:1024 lds
    v_mfma_f32_16x16x32_bf16 v[224:227], v[168:171], a[160:163], v[224:227]
    ds_read_b64_tr_b16 v[184:185], v4 offset:12288
    v_mfma_f32_16x16x32_bf16 v[232:235], v[168:171], a[164:167], v[232:235]
    ds_read_b64_tr_b16 v[186:187], v4 offset:14336
    v_mfma_f32_16x16x32_bf16 v[240:243], v[168:171], a[168:171], v[240:243]
    ds_read_b64_tr_b16 v[188:189], v5 offset:12288
    v_mfma_f32_16x16x32_bf16 v[248:251], v[168:171], a[172:175], v[248:251]
    buffer_load_dwordx4 v42, s[16:19], s44 offen offset:2048 lds
    v_mfma_f32_16x16x32_bf16 v[252:255], v[172:175], a[172:175], v[252:255]
    ds_read_b64_tr_b16 v[190:191], v5 offset:14336
    v_mfma_f32_16x16x32_bf16 v[244:247], v[172:175], a[168:171], v[244:247]
    v_mfma_f32_16x16x32_bf16 v[236:239], v[172:175], a[164:167], v[236:239]
    v_mfma_f32_16x16x32_bf16 v[228:231], v[172:175], a[160:163], v[228:231]
    buffer_load_dwordx4 v43, s[16:19], s44 offen offset:3072 lds
    s_waitcnt lgkmcnt(0)
    v_mfma_f32_16x16x32_bf16 v[192:195], v[176:179], a[176:179], v[192:195]
    s_add_u32 m0, s43, 12288
    s_add_u32 s44, s56, 262272
    s_and_b32 s44, s44, 4194047
    v_mfma_f32_16x16x32_bf16 v[200:203], v[176:179], a[180:183], v[200:203]
    s_waitcnt vmcnt(16)
    v_mfma_f32_16x16x32_bf16 v[208:211], v[176:179], a[184:187], v[208:211]
    ds_read_b64_tr_b16 v[160:161], v2 offset:16384
    v_mfma_f32_16x16x32_bf16 v[216:219], v[176:179], a[188:191], v[216:219]
    buffer_load_dwordx4 v40, s[16:19], s44 offen offset:0 lds
    v_mfma_f32_16x16x32_bf16 v[220:223], v[180:183], a[188:191], v[220:223]
    ds_read_b64_tr_b16 v[162:163], v2 offset:18432
    v_mfma_f32_16x16x32_bf16 v[212:215], v[180:183], a[184:187], v[212:215]
    ds_read_b64_tr_b16 v[164:165], v3 offset:16384
    v_mfma_f32_16x16x32_bf16 v[204:207], v[180:183], a[180:183], v[204:207]
    ds_read_b64_tr_b16 v[166:167], v3 offset:18432
    v_mfma_f32_16x16x32_bf16 v[196:199], v[180:183], a[176:179], v[196:199]
    buffer_load_dwordx4 v41, s[16:19], s44 offen offset:1024 lds
    v_mfma_f32_16x16x32_bf16 v[224:227], v[184:187], a[176:179], v[224:227]
    ds_read_b64_tr_b16 v[168:169], v4 offset:16384
    v_mfma_f32_16x16x32_bf16 v[232:235], v[184:187], a[180:183], v[232:235]
    ds_read_b64_tr_b16 v[170:171], v4 offset:18432
    v_mfma_f32_16x16x32_bf16 v[240:243], v[184:187], a[184:187], v[240:243]
    ds_read_b64_tr_b16 v[172:173], v5 offset:16384
    v_mfma_f32_16x16x32_bf16 v[248:251], v[184:187], a[188:191], v[248:251]
    buffer_load_dwordx4 v42, s[16:19], s44 offen offset:2048 lds
    v_mfma_f32_16x16x32_bf16 v[252:255], v[188:191], a[188:191], v[252:255]
    ds_read_b64_tr_b16 v[174:175], v5 offset:18432
    v_mfma_f32_16x16x32_bf16 v[244:247], v[188:191], a[184:187], v[244:247]
    v_mfma_f32_16x16x32_bf16 v[236:239], v[188:191], a[180:183], v[236:239]
    v_mfma_f32_16x16x32_bf16 v[228:231], v[188:191], a[176:179], v[228:231]
    buffer_load_dwordx4 v43, s[16:19], s44 offen offset:3072 lds
    s_waitcnt lgkmcnt(0)
    v_mfma_f32_16x16x32_bf16 v[192:195], v[160:163], a[192:195], v[192:195]
    s_add_u32 m0, s43, 16384
    s_add_u32 s44, s56, 524416
    s_and_b32 s44, s44, 4194047
    v_mfma_f32_16x16x32_bf16 v[200:203], v[160:163], a[196:199], v[200:203]
    s_waitcnt vmcnt(16)
    v_mfma_f32_16x16x32_bf16 v[208:211], v[160:163], a[200:203], v[208:211]
    ds_read_b64_tr_b16 v[176:177], v2 offset:20480
    v_mfma_f32_16x16x32_bf16 v[216:219], v[160:163], a[204:207], v[216:219]
    buffer_load_dwordx4 v40, s[16:19], s44 offen offset:0 lds
    v_mfma_f32_16x16x32_bf16 v[220:223], v[164:167], a[204:207], v[220:223]
    ds_read_b64_tr_b16 v[178:179], v2 offset:22528
    v_mfma_f32_16x16x32_bf16 v[212:215], v[164:167], a[200:203], v[212:215]
    ds_read_b64_tr_b16 v[180:181], v3 offset:20480
    v_mfma_f32_16x16x32_bf16 v[204:207], v[164:167], a[196:199], v[204:207]
    ds_read_b64_tr_b16 v[182:183], v3 offset:22528
    v_mfma_f32_16x16x32_bf16 v[196:199], v[164:167], a[192:195], v[196:199]
    buffer_load_dwordx4 v41, s[16:19], s44 offen offset:1024 lds
    v_mfma_f32_16x16x32_bf16 v[224:227], v[168:171], a[192:195], v[224:227]
    ds_read_b64_tr_b16 v[184:185], v4 offset:20480
    v_mfma_f32_16x16x32_bf16 v[232:235], v[168:171], a[196:199], v[232:235]
    ds_read_b64_tr_b16 v[186:187], v4 offset:22528
    v_mfma_f32_16x16x32_bf16 v[240:243], v[168:171], a[200:203], v[240:243]
    ds_read_b64_tr_b16 v[188:189], v5 offset:20480
    v_mfma_f32_16x16x32_bf16 v[248:251], v[168:171], a[204:207], v[248:251]
    buffer_load_dwordx4 v42, s[16:19], s44 offen offset:2048 lds
    v_mfma_f32_16x16x32_bf16 v[252:255], v[172:175], a[204:207], v[252:255]
    ds_read_b64_tr_b16 v[190:191], v5 offset:22528
    v_mfma_f32_16x16x32_bf16 v[244:247], v[172:175], a[200:203], v[244:247]
    v_mfma_f32_16x16x32_bf16 v[236:239], v[172:175], a[196:199], v[236:239]
    v_mfma_f32_16x16x32_bf16 v[228:231], v[172:175], a[192:195], v[228:231]
    buffer_load_dwordx4 v43, s[16:19], s44 offen offset:3072 lds
    s_waitcnt lgkmcnt(0)
    v_mfma_f32_16x16x32_bf16 v[192:195], v[176:179], a[208:211], v[192:195]
    s_add_u32 m0, s43, 20480
    s_add_u32 s44, s56, 786560
    s_and_b32 s44, s44, 4194047
    v_mfma_f32_16x16x32_bf16 v[200:203], v[176:179], a[212:215], v[200:203]
    s_waitcnt vmcnt(16)
    v_mfma_f32_16x16x32_bf16 v[208:211], v[176:179], a[216:219], v[208:211]
    ds_read_b64_tr_b16 v[160:161], v2 offset:0
    v_mfma_f32_16x16x32_bf16 v[216:219], v[176:179], a[220:223], v[216:219]
    buffer_load_dwordx4 v40, s[16:19], s44 offen offset:0 lds
    v_mfma_f32_16x16x32_bf16 v[220:223], v[180:183], a[220:223], v[220:223]
    ds_read_b64_tr_b16 v[162:163], v2 offset:2048
    v_mfma_f32_16x16x32_bf16 v[212:215], v[180:183], a[216:219], v[212:215]
    ds_read_b64_tr_b16 v[164:165], v3 offset:0
    v_mfma_f32_16x16x32_bf16 v[204:207], v[180:183], a[212:215], v[204:207]
    ds_read_b64_tr_b16 v[166:167], v3 offset:2048
    v_mfma_f32_16x16x32_bf16 v[196:199], v[180:183], a[208:211], v[196:199]
    buffer_load_dwordx4 v41, s[16:19], s44 offen offset:1024 lds
    v_mfma_f32_16x16x32_bf16 v[224:227], v[184:187], a[208:211], v[224:227]
    ds_read_b64_tr_b16 v[168:169], v4 offset:0
    v_mfma_f32_16x16x32_bf16 v[232:235], v[184:187], a[212:215], v[232:235]
    ds_read_b64_tr_b16 v[170:171], v4 offset:2048
    v_mfma_f32_16x16x32_bf16 v[240:243], v[184:187], a[216:219], v[240:243]
    ds_read_b64_tr_b16 v[172:173], v5 offset:0
    v_mfma_f32_16x16x32_bf16 v[248:251], v[184:187], a[220:223], v[248:251]
    buffer_load_dwordx4 v42, s[16:19], s44 offen offset:2048 lds
    v_mfma_f32_16x16x32_bf16 v[252:255], v[188:191], a[220:223], v[252:255]
    ds_read_b64_tr_b16 v[174:175], v5 offset:2048
    v_mfma_f32_16x16x32_bf16 v[244:247], v[188:191], a[216:219], v[244:247]
    v_mfma_f32_16x16x32_bf16 v[236:239], v[188:191], a[212:215], v[236:239]
    v_mfma_f32_16x16x32_bf16 v[228:231], v[188:191], a[208:211], v[228:231]
    buffer_load_dwordx4 v43, s[16:19], s44 offen offset:3072 lds
    s_waitcnt lgkmcnt(0)
    v_mfma_f32_16x16x32_bf16 v[192:195], v[160:163], a[224:227], v[192:195]
    s_add_u32 m0, s43, 0
    s_add_u32 s44, s56, 1048704
    s_and_b32 s44, s44, 4194047
    v_mfma_f32_16x16x32_bf16 v[200:203], v[160:163], a[228:231], v[200:203]
    s_waitcnt vmcnt(16)
    v_mfma_f32_16x16x32_bf16 v[208:211], v[160:163], a[232:235], v[208:211]
    ds_read_b64_tr_b16 v[176:177], v2 offset:4096
    v_mfma_f32_16x16x32_bf16 v[216:219], v[160:163], a[236:239], v[216:219]
    buffer_load_dwordx4 v40, s[16:19], s44 offen offset:0 lds
    v_mfma_f32_16x16x32_bf16 v[220:223], v[164:167], a[236:239], v[220:223]
    ds_read_b64_tr_b16 v[178:179], v2 offset:6144
    v_mfma_f32_16x16x32_bf16 v[212:215], v[164:167], a[232:235], v[212:215]
    ds_read_b64_tr_b16 v[180:181], v3 offset:4096
    v_mfma_f32_16x16x32_bf16 v[204:207], v[164:167], a[228:231], v[204:207]
    ds_read_b64_tr_b16 v[182:183], v3 offset:6144
    v_mfma_f32_16x16x32_bf16 v[196:199], v[164:167], a[224:227], v[196:199]
    buffer_load_dwordx4 v41, s[16:19], s44 offen offset:1024 lds
    v_mfma_f32_16x16x32_bf16 v[224:227], v[168:171], a[224:227], v[224:227]
    ds_read_b64_tr_b16 v[184:185], v4 offset:4096
    v_mfma_f32_16x16x32_bf16 v[232:235], v[168:171], a[228:231], v[232:235]
    ds_read_b64_tr_b16 v[186:187], v4 offset:6144
    v_mfma_f32_16x16x32_bf16 v[240:243], v[168:171], a[232:235], v[240:243]
    ds_read_b64_tr_b16 v[188:189], v5 offset:4096
    v_mfma_f32_16x16x32_bf16 v[248:251], v[168:171], a[236:239], v[248:251]
    buffer_load_dwordx4 v42, s[16:19], s44 offen offset:2048 lds
    v_mfma_f32_16x16x32_bf16 v[252:255], v[172:175], a[236:239], v[252:255]
    ds_read_b64_tr_b16 v[190:191], v5 offset:6144
    v_mfma_f32_16x16x32_bf16 v[244:247], v[172:175], a[232:235], v[244:247]
    v_mfma_f32_16x16x32_bf16 v[236:239], v[172:175], a[228:231], v[236:239]
    v_mfma_f32_16x16x32_bf16 v[228:231], v[172:175], a[224:227], v[228:231]
    buffer_load_dwordx4 v43, s[16:19], s44 offen offset:3072 lds
    s_waitcnt lgkmcnt(0)
    v_mfma_f32_16x16x32_bf16 v[192:195], v[176:179], a[240:243], v[192:195]
    s_add_u32 m0, s43, 4096
    s_add_u32 s44, s56, 1310848
    s_and_b32 s44, s44, 4194047
    v_mfma_f32_16x16x32_bf16 v[200:203], v[176:179], a[244:247], v[200:203]
    s_waitcnt vmcnt(16)
    v_mfma_f32_16x16x32_bf16 v[208:211], v[176:179], a[248:251], v[208:211]
    ds_read_b64_tr_b16 v[160:161], v12 offset:8192
    v_mfma_f32_16x16x32_bf16 v[216:219], v[176:179], a[252:255], v[216:219]
    buffer_load_dwordx4 v40, s[16:19], s44 offen offset:0 lds
    v_mfma_f32_16x16x32_bf16 v[220:223], v[180:183], a[252:255], v[220:223]
    ds_read_b64_tr_b16 v[162:163], v12 offset:10240
    v_mfma_f32_16x16x32_bf16 v[212:215], v[180:183], a[248:251], v[212:215]
    ds_read_b64_tr_b16 v[164:165], v12 offset:8200
    v_mfma_f32_16x16x32_bf16 v[204:207], v[180:183], a[244:247], v[204:207]
    ds_read_b64_tr_b16 v[166:167], v12 offset:10248
    v_mfma_f32_16x16x32_bf16 v[196:199], v[180:183], a[240:243], v[196:199]
    buffer_load_dwordx4 v41, s[16:19], s44 offen offset:1024 lds
    v_mfma_f32_16x16x32_bf16 v[224:227], v[184:187], a[240:243], v[224:227]
    ds_read_b64_tr_b16 v[168:169], v13 offset:8192
    v_mfma_f32_16x16x32_bf16 v[232:235], v[184:187], a[244:247], v[232:235]
    ds_read_b64_tr_b16 v[170:171], v13 offset:10240
    v_mfma_f32_16x16x32_bf16 v[240:243], v[184:187], a[248:251], v[240:243]
    ds_read_b64_tr_b16 v[172:173], v13 offset:8200
    v_mfma_f32_16x16x32_bf16 v[248:251], v[184:187], a[252:255], v[248:251]
    buffer_load_dwordx4 v42, s[16:19], s44 offen offset:2048 lds
    v_mfma_f32_16x16x32_bf16 v[252:255], v[188:191], a[252:255], v[252:255]
    ds_read_b64_tr_b16 v[174:175], v13 offset:10248
    v_mfma_f32_16x16x32_bf16 v[244:247], v[188:191], a[248:251], v[244:247]
    v_mfma_f32_16x16x32_bf16 v[236:239], v[188:191], a[244:247], v[236:239]
    v_mfma_f32_16x16x32_bf16 v[228:231], v[188:191], a[240:243], v[228:231]
    buffer_load_dwordx4 v43, s[16:19], s44 offen offset:3072 lds
    s_waitcnt lgkmcnt(0)
    v_mfma_f32_16x16x32_bf16 v[96:99], v[160:163], a[0:3], 0
    s_add_u32 m0, s43, 8192
    s_add_u32 s44, s56, 1572992
    s_and_b32 s44, s44, 4194047
    v_mfma_f32_16x16x32_bf16 v[104:107], v[160:163], a[4:7], 0
    s_waitcnt vmcnt(16)
    v_mfma_f32_16x16x32_bf16 v[112:115], v[160:163], a[8:11], 0
    ds_read_b64_tr_b16 v[176:177], v12 offset:12288
    v_mfma_f32_16x16x32_bf16 v[120:123], v[160:163], a[12:15], 0
    buffer_load_dwordx4 v40, s[16:19], s44 offen offset:0 lds
    v_mfma_f32_16x16x32_bf16 v[124:127], v[164:167], a[12:15], 0
    ds_read_b64_tr_b16 v[178:179], v12 offset:14336
    v_mfma_f32_16x16x32_bf16 v[116:119], v[164:167], a[8:11], 0
    ds_read_b64_tr_b16 v[180:181], v12 offset:12296
    v_mfma_f32_16x16x32_bf16 v[108:111], v[164:167], a[4:7], 0
    ds_read_b64_tr_b16 v[182:183], v12 offset:14344
    v_mfma_f32_16x16x32_bf16 v[100:103], v[164:167], a[0:3], 0
    buffer_load_dwordx4 v41, s[16:19], s44 offen offset:1024 lds
    v_mfma_f32_16x16x32_bf16 v[128:131], v[168:171], a[0:3], 0
    ds_read_b64_tr_b16 v[184:185], v13 offset:12288
    v_mfma_f32_16x16x32_bf16 v[136:139], v[168:171], a[4:7], 0
    ds_read_b64_tr_b16 v[186:187], v13 offset:14336
    v_mfma_f32_16x16x32_bf16 v[144:147], v[168:171], a[8:11], 0
    ds_read_b64_tr_b16 v[188:189], v13 offset:12296
    v_mfma_f32_16x16x32_bf16 v[152:155], v[168:171], a[12:15], 0
    buffer_load_dwordx4 v42, s[16:19], s44 offen offset:2048 lds
    v_mfma_f32_16x16x32_bf16 v[156:159], v[172:175], a[12:15], 0
    ds_read_b64_tr_b16 v[190:191], v13 offset:14344
    v_mfma_f32_16x16x32_bf16 v[148:151], v[172:175], a[8:11], 0
    v_mfma_f32_16x16x32_bf16 v[140:143], v[172:175], a[4:7], 0
    v_mfma_f32_16x16x32_bf16 v[132:135], v[172:175], a[0:3], 0
    buffer_load_dwordx4 v43, s[16:19], s44 offen offset:3072 lds
    s_waitcnt lgkmcnt(0)
    v_mfma_f32_16x16x32_bf16 v[96:99], v[176:179], a[16:19], v[96:99]
    s_add_u32 m0, s43, 12288
    s_add_u32 s44, s56, 1835136
    s_and_b32 s44, s44, 4194047
    v_mfma_f32_16x16x32_bf16 v[104:107], v[176:179], a[20:23], v[104:107]
    s_waitcnt vmcnt(16)
    s_lshr_b32 s46, s41, 2
    v_mfma_f32_16x16x32_bf16 v[112:115], v[176:179], a[24:27], v[112:115]
    ds_read_b64_tr_b16 v[160:161], v12 offset:16384
    s_lshl_b32 s46, s46, 6
    v_mfma_f32_16x16x32_bf16 v[120:123], v[176:179], a[28:31], v[120:123]
    buffer_load_dwordx4 v40, s[16:19], s44 offen offset:0 lds
    v_mfma_f32_16x16x32_bf16 v[124:127], v[180:183], a[28:31], v[124:127]
    ds_read_b64_tr_b16 v[162:163], v12 offset:18432
    v_xor_b32 v2, s46, v2
    v_mfma_f32_16x16x32_bf16 v[116:119], v[180:183], a[24:27], v[116:119]
    ds_read_b64_tr_b16 v[164:165], v12 offset:16392
    v_xor_b32 v3, s46, v3
    v_mfma_f32_16x16x32_bf16 v[108:111], v[180:183], a[20:23], v[108:111]
    ds_read_b64_tr_b16 v[166:167], v12 offset:18440
    v_xor_b32 v4, s46, v4
    v_mfma_f32_16x16x32_bf16 v[100:103], v[180:183], a[16:19], v[100:103]
    buffer_load_dwordx4 v41, s[16:19], s44 offen offset:1024 lds
    v_mfma_f32_16x16x32_bf16 v[128:131], v[184:187], a[16:19], v[128:131]
    ds_read_b64_tr_b16 v[168:169], v13 offset:16384
    v_xor_b32 v5, s46, v5
    v_mfma_f32_16x16x32_bf16 v[136:139], v[184:187], a[20:23], v[136:139]
    ds_read_b64_tr_b16 v[170:171], v13 offset:18432
    v_max_f32 v192, 0, v192
    v_mfma_f32_16x16x32_bf16 v[144:147], v[184:187], a[24:27], v[144:147]
    ds_read_b64_tr_b16 v[172:173], v13 offset:16392
    v_max_f32 v193, 0, v193
    v_mfma_f32_16x16x32_bf16 v[152:155], v[184:187], a[28:31], v[152:155]
    buffer_load_dwordx4 v42, s[16:19], s44 offen offset:2048 lds
    v_mfma_f32_16x16x32_bf16 v[156:159], v[188:191], a[28:31], v[156:159]
    ds_read_b64_tr_b16 v[174:175], v13 offset:18440
    v_max_f32 v194, 0, v194
    v_mfma_f32_16x16x32_bf16 v[148:151], v[188:191], a[24:27], v[148:151]
    v_max_f32 v195, 0, v195
    v_max_f32 v196, 0, v196
    v_mfma_f32_16x16x32_bf16 v[140:143], v[188:191], a[20:23], v[140:143]
    v_max_f32 v197, 0, v197
    v_max_f32 v198, 0, v198
    v_mfma_f32_16x16x32_bf16 v[132:135], v[188:191], a[16:19], v[132:135]
    buffer_load_dwordx4 v43, s[16:19], s44 offen offset:3072 lds
    s_waitcnt lgkmcnt(0)
    v_mfma_f32_16x16x32_bf16 v[96:99], v[160:163], a[32:35], v[96:99]
    s_add_u32 m0, s43, 16384
    s_add_u32 s44, s56, 2097280
    s_and_b32 s44, s44, 4194047
    v_mfma_f32_16x16x32_bf16 v[104:107], v[160:163], a[36:39], v[104:107]
    s_waitcnt vmcnt(16)
    v_max_f32 v199, 0, v199
    v_mfma_f32_16x16x32_bf16 v[112:115], v[160:163], a[40:43], v[112:115]
    ds_read_b64_tr_b16 v[176:177], v12 offset:20480
    v_mul_f32 v192, v192, v192
    v_mfma_f32_16x16x32_bf16 v[120:123], v[160:163], a[44:47], v[120:123]
    buffer_load_dwordx4 v40, s[16:19], s44 offen offset:0 lds
    v_mfma_f32_16x16x32_bf16 v[124:127], v[164:167], a[44:47], v[124:127]
    ds_read_b64_tr_b16 v[178:179], v12 offset:22528
    v_mul_f32 v193, v193, v193
    v_mfma_f32_16x16x32_bf16 v[116:119], v[164:167], a[40:43], v[116:119]
    ds_read_b64_tr_b16 v[180:181], v12 offset:20488
    v_mul_f32 v194, v194, v194
    v_mfma_f32_16x16x32_bf16 v[108:111], v[164:167], a[36:39], v[108:111]
    ds_read_b64_tr_b16 v[182:183], v12 offset:22536
    v_mul_f32 v195, v195, v195
    v_mfma_f32_16x16x32_bf16 v[100:103], v[164:167], a[32:35], v[100:103]
    buffer_load_dwordx4 v41, s[16:19], s44 offen offset:1024 lds
    v_mfma_f32_16x16x32_bf16 v[128:131], v[168:171], a[32:35], v[128:131]
    ds_read_b64_tr_b16 v[184:185], v13 offset:20480
    v_mul_f32 v196, v196, v196
    v_mfma_f32_16x16x32_bf16 v[136:139], v[168:171], a[36:39], v[136:139]
    ds_read_b64_tr_b16 v[186:187], v13 offset:22528
    v_mul_f32 v197, v197, v197
    v_mfma_f32_16x16x32_bf16 v[144:147], v[168:171], a[40:43], v[144:147]
    ds_read_b64_tr_b16 v[188:189], v13 offset:20488
    v_mul_f32 v198, v198, v198
    v_mfma_f32_16x16x32_bf16 v[152:155], v[168:171], a[44:47], v[152:155]
    buffer_load_dwordx4 v42, s[16:19], s44 offen offset:2048 lds
    v_mfma_f32_16x16x32_bf16 v[156:159], v[172:175], a[44:47], v[156:159]
    ds_read_b64_tr_b16 v[190:191], v13 offset:22536
    v_mul_f32 v199, v199, v199
    v_mfma_f32_16x16x32_bf16 v[148:151], v[172:175], a[40:43], v[148:151]
    v_cvt_pk_bf16_f32 v192, v192, v193
    v_cvt_pk_bf16_f32 v193, v194, v195
    v_mfma_f32_16x16x32_bf16 v[140:143], v[172:175], a[36:39], v[140:143]
    v_cvt_pk_bf16_f32 v194, v196, v197
    v_cvt_pk_bf16_f32 v195, v198, v199
    v_mfma_f32_16x16x32_bf16 v[132:135], v[172:175], a[32:35], v[132:135]
    buffer_load_dwordx4 v43, s[16:19], s44 offen offset:3072 lds
    s_waitcnt lgkmcnt(0)
    v_mfma_f32_16x16x32_bf16 v[96:99], v[176:179], a[48:51], v[96:99]
    s_add_u32 m0, s43, 20480
    s_add_u32 s44, s56, 2359424
    s_and_b32 s44, s44, 4194047
    v_mfma_f32_16x16x32_bf16 v[104:107], v[176:179], a[52:55], v[104:107]
    s_waitcnt vmcnt(16)
    v_max_f32 v200, 0, v200
    v_mfma_f32_16x16x32_bf16 v[112:115], v[176:179], a[56:59], v[112:115]
    ds_read_b64_tr_b16 v[160:161], v12 offset:0
    v_max_f32 v201, 0, v201
    v_mfma_f32_16x16x32_bf16 v[120:123], v[176:179], a[60:63], v[120:123]
    buffer_load_dwordx4 v40, s[16:19], s44 offen offset:0 lds
    v_mfma_f32_16x16x32_bf16 v[124:127], v[180:183], a[60:63], v[124:127]
    ds_read_b64_tr_b16 v[162:163], v12 offset:2048
    v_max_f32 v202, 0, v202
    v_mfma_f32_16x16x32_bf16 v[116:119], v[180:183], a[56:59], v[116:119]
    ds_read_b64_tr_b16 v[164:165], v12 offset:8
    v_max_f32 v203, 0, v203
    v_mfma_f32_16x16x32_bf16 v[108:111], v[180:183], a[52:55], v[108:111]
    ds_read_b64_tr_b16 v[166:167], v12 offset:2056
    v_max_f32 v204, 0, v204
    v_mfma_f32_16x16x32_bf16 v[100:103], v[180:183], a[48:51], v[100:103]
    buffer_load_dwordx4 v41, s[16:19], s44 offen offset:1024 lds
    v_mfma_f32_16x16x32_bf16 v[128:131], v[184:187], a[48:51], v[128:131]
    ds_read_b64_tr_b16 v[168:169], v13 offset:0
    v_max_f32 v205, 0, v205
    v_mfma_f32_16x16x32_bf16 v[136:139], v[184:187], a[52:55], v[136:139]
    ds_read_b64_tr_b16 v[170:171], v13 offset:2048
    v_max_f32 v206, 0, v206
    v_mfma_f32_16x16x32_bf16 v[144:147], v[184:187], a[56:59], v[144:147]
    ds_read_b64_tr_b16 v[172:173], v13 offset:8
    v_max_f32 v207, 0, v207
    v_mfma_f32_16x16x32_bf16 v[152:155], v[184:187], a[60:63], v[152:155]
    buffer_load_dwordx4 v42, s[16:19], s44 offen offset:2048 lds
    v_mfma_f32_16x16x32_bf16 v[156:159], v[188:191], a[60:63], v[156:159]
    ds_read_b64_tr_b16 v[174:175], v13 offset:2056
    v_mul_f32 v200, v200, v200
    v_mfma_f32_16x16x32_bf16 v[148:151], v[188:191], a[56:59], v[148:151]
    v_mul_f32 v201, v201, v201
    v_mul_f32 v202, v202, v202
    v_mfma_f32_16x16x32_bf16 v[140:143], v[188:191], a[52:55], v[140:143]
    v_mul_f32 v203, v203, v203
    v_mul_f32 v204, v204, v204
    v_mfma_f32_16x16x32_bf16 v[132:135], v[188:191], a[48:51], v[132:135]
    buffer_load_dwordx4 v43, s[16:19], s44 offen offset:3072 lds
    s_waitcnt lgkmcnt(0)
    v_mfma_f32_16x16x32_bf16 v[96:99], v[160:163], a[64:67], v[96:99]
    s_add_u32 m0, s43, 0
    s_add_u32 s44, s56, 2621568
    s_and_b32 s44, s44, 4194047
    v_mfma_f32_16x16x32_bf16 v[104:107], v[160:163], a[68:71], v[104:107]
    s_waitcnt vmcnt(16)
    v_mul_f32 v205, v205, v205
    v_mfma_f32_16x16x32_bf16 v[112:115], v[160:163], a[72:75], v[112:115]
    ds_read_b64_tr_b16 v[176:177], v12 offset:4096
    v_mul_f32 v206, v206, v206
    v_mfma_f32_16x16x32_bf16 v[120:123], v[160:163], a[76:79], v[120:123]
    buffer_load_dwordx4 v40, s[16:19], s44 offen offset:0 lds
    v_mfma_f32_16x16x32_bf16 v[124:127], v[164:167], a[76:79], v[124:127]
    ds_read_b64_tr_b16 v[178:179], v12 offset:6144
    v_mul_f32 v207, v207, v207
    v_mfma_f32_16x16x32_bf16 v[116:119], v[164:167], a[72:75], v[116:119]
    ds_read_b64_tr_b16 v[180:181], v12 offset:4104
    v_cvt_pk_bf16_f32 v196, v200, v201
    v_mfma_f32_16x16x32_bf16 v[108:111], v[164:167], a[68:71], v[108:111]
    ds_read_b64_tr_b16 v[182:183], v12 offset:6152
    v_cvt_pk_bf16_f32 v197, v202, v203
    v_mfma_f32_16x16x32_bf16 v[100:103], v[164:167], a[64:67], v[100:103]
    buffer_load_dwordx4 v41, s[16:19], s44 offen offset:1024 lds
    v_mfma_f32_16x16x32_bf16 v[128:131], v[168:171], a[64:67], v[128:131]
    ds_read_b64_tr_b16 v[184:185], v13 offset:4096
    v_cvt_pk_bf16_f32 v198, v204, v205
    v_mfma_f32_16x16x32_bf16 v[136:139], v[168:171], a[68:71], v[136:139]
    ds_read_b64_tr_b16 v[186:187], v13 offset:6144
    v_cvt_pk_bf16_f32 v199, v206, v207
    v_mfma_f32_16x16x32_bf16 v[144:147], v[168:171], a[72:75], v[144:147]
    ds_read_b64_tr_b16 v[188:189], v13 offset:4104
    v_max_f32 v208, 0, v208
    v_mfma_f32_16x16x32_bf16 v[152:155], v[168:171], a[76:79], v[152:155]
    buffer_load_dwordx4 v42, s[16:19], s44 offen offset:2048 lds
    v_mfma_f32_16x16x32_bf16 v[156:159], v[172:175], a[76:79], v[156:159]
    ds_read_b64_tr_b16 v[190:191], v13 offset:6152
    v_max_f32 v209, 0, v209
    v_mfma_f32_16x16x32_bf16 v[148:151], v[172:175], a[72:75], v[148:151]
    v_max_f32 v210, 0, v210
    v_max_f32 v211, 0, v211
    v_mfma_f32_16x16x32_bf16 v[140:143], v[172:175], a[68:71], v[140:143]
    v_max_f32 v212, 0, v212
    v_max_f32 v213, 0, v213
    v_mfma_f32_16x16x32_bf16 v[132:135], v[172:175], a[64:67], v[132:135]
    buffer_load_dwordx4 v43, s[16:19], s44 offen offset:3072 lds
    s_add_u32 m0, s50, 32768
    s_mov_b32 s48, 0
    buffer_load_dwordx4 v26, s[8:11], s48 offen lds
    buffer_load_dwordx4 v27, s[8:11], s48 offen offset:1024 lds
    s_waitcnt lgkmcnt(0)
    v_mfma_f32_16x16x32_bf16 v[96:99], v[176:179], a[80:83], v[96:99]
    s_add_u32 m0, s43, 4096
    s_add_u32 s44, s56, 2883712
    s_and_b32 s44, s44, 4194047
    v_mfma_f32_16x16x32_bf16 v[104:107], v[176:179], a[84:87], v[104:107]
    s_waitcnt vmcnt(18)
    v_max_f32 v214, 0, v214
    v_mfma_f32_16x16x32_bf16 v[112:115], v[176:179], a[88:91], v[112:115]
    ds_read_b64_tr_b16 v[160:161], v12 offset:8192
    v_max_f32 v215, 0, v215
    v_mfma_f32_16x16x32_bf16 v[120:123], v[176:179], a[92:95], v[120:123]
    buffer_load_dwordx4 v40, s[16:19], s44 offen offset:0 lds
    v_mfma_f32_16x16x32_bf16 v[124:127], v[180:183], a[92:95], v[124:127]
    ds_read_b64_tr_b16 v[162:163], v12 offset:10240
    v_mul_f32 v208, v208, v208
    v_mfma_f32_16x16x32_bf16 v[116:119], v[180:183], a[88:91], v[116:119]
    ds_read_b64_tr_b16 v[164:165], v12 offset:8200
    v_mul_f32 v209, v209, v209
    v_mfma_f32_16x16x32_bf16 v[108:111], v[180:183], a[84:87], v[108:111]
    ds_read_b64_tr_b16 v[166:167], v12 offset:10248
    v_mul_f32 v210, v210, v210
    v_mfma_f32_16x16x32_bf16 v[100:103], v[180:183], a[80:83], v[100:103]
    buffer_load_dwordx4 v41, s[16:19], s44 offen offset:1024 lds
    v_mfma_f32_16x16x32_bf16 v[128:131], v[184:187], a[80:83], v[128:131]
L_pg2:
    s_cbranch_execz L_pg6
    ds_read_b64_tr_b16 v[168:169], v13 offset:8192
    v_mul_f32 v211, v211, v211
    v_mfma_f32_16x16x32_bf16 v[136:139], v[184:187], a[84:87], v[136:139]
    ds_read_b64_tr_b16 v[170:171], v13 offset:10240
    v_mul_f32 v212, v212, v212
    v_mfma_f32_16x16x32_bf16 v[144:147], v[184:187], a[88:91], v[144:147]
    ds_read_b64_tr_b16 v[172:173], v13 offset:8200
    v_mul_f32 v213, v213, v213
    v_mfma_f32_16x16x32_bf16 v[152:155], v[184:187], a[92:95], v[152:155]
    buffer_load_dwordx4 v42, s[16:19], s44 offen offset:2048 lds
    v_mfma_f32_16x16x32_bf16 v[156:159], v[188:191], a[92:95], v[156:159]
    ds_read_b64_tr_b16 v[174:175], v13 offset:10248
    v_mul_f32 v214, v214, v214
    v_mfma_f32_16x16x32_bf16 v[148:151], v[188:191], a[88:91], v[148:151]
    v_mul_f32 v215, v215, v215
    v_cvt_pk_bf16_f32 v200, v208, v209
    v_mfma_f32_16x16x32_bf16 v[140:143], v[188:191], a[84:87], v[140:143]
    v_cvt_pk_bf16_f32 v201, v210, v211
    v_cvt_pk_bf16_f32 v202, v212, v213
    v_mfma_f32_16x16x32_bf16 v[132:135], v[188:191], a[80:83], v[132:135]
    buffer_load_dwordx4 v43, s[16:19], s44 offen offset:3072 lds
    s_waitcnt lgkmcnt(0)
    v_mfma_f32_16x16x32_bf16 v[96:99], v[160:163], a[96:99], v[96:99]
    s_add_u32 m0, s43, 8192
    s_add_u32 s44, s56, 3145856
    s_and_b32 s44, s44, 4194047
    v_mfma_f32_16x16x32_bf16 v[104:107], v[160:163], a[100:103], v[104:107]
    s_waitcnt vmcnt(18)
    v_cvt_pk_bf16_f32 v203, v214, v215
    v_mfma_f32_16x16x32_bf16 v[112:115], v[160:163], a[104:107], v[112:115]
    ds_read_b64_tr_b16 v[176:177], v12 offset:12288
    v_max_f32 v216, 0, v216
    v_mfma_f32_16x16x32_bf16 v[120:123], v[160:163], a[108:111], v[120:123]
    buffer_load_dwordx4 v40, s[16:19], s44 offen offset:0 lds
    v_mfma_f32_16x16x32_bf16 v[124:127], v[164:167], a[108:111], v[124:127]
    ds_read_b64_tr_b16 v[178:179], v12 offset:14336
    v_max_f32 v217, 0, v217
    v_mfma_f32_16x16x32_bf16 v[116:119], v[164:167], a[104:107], v[116:119]
    ds_read_b64_tr_b16 v[180:181], v12 offset:12296
    v_max_f32 v218, 0, v218
    v_mfma_f32_16x16x32_bf16 v[108:111], v[164:167], a[100:103], v[108:111]
    ds_read_b64_tr_b16 v[182:183], v12 offset:14344
    v_max_f32 v219, 0, v219
    v_mfma_f32_16x16x32_bf16 v[100:103], v[164:167], a[96:99], v[100:103]
    buffer_load_dwordx4 v41, s[16:19], s44 offen offset:1024 lds
    v_mfma_f32_16x16x32_bf16 v[128:131], v[168:171], a[96:99], v[128:131]
    ds_read_b64_tr_b16 v[184:185], v13 offset:12288
    v_max_f32 v220, 0, v220
    v_mfma_f32_16x16x32_bf16 v[136:139], v[168:171], a[100:103], v[136:139]
    ds_read_b64_tr_b16 v[186:187], v13 offset:14336
    v_max_f32 v221, 0, v221
    v_mfma_f32_16x16x32_bf16 v[144:147], v[168:171], a[104:107], v[144:147]
    ds_read_b64_tr_b16 v[188:189], v13 offset:12296
    v_max_f32 v222, 0, v222
    v_mfma_f32_16x16x32_bf16 v[152:155], v[168:171], a[108:111], v[152:155]
    buffer_load_dwordx4 v42, s[16:19], s44 offen offset:2048 lds
    v_mfma_f32_16x16x32_bf16 v[156:159], v[172:175], a[108:111], v[156:159]
    ds_read_b64_tr_b16 v[190:191], v13 offset:14344
    v_max_f32 v223, 0, v223
    v_mfma_f32_16x16x32_bf16 v[148:151], v[172:175], a[104:107], v[148:151]
    v_mul_f32 v216, v216, v216
    v_mul_f32 v217, v217, v217
    v_mfma_f32_16x16x32_bf16 v[140:143], v[172:175], a[100:103], v[140:143]
    v_mul_f32 v218, v218, v218
    v_mul_f32 v219, v219, v219
    v_mfma_f32_16x16x32_bf16 v[132:135], v[172:175], a[96:99], v[132:135]
    buffer_load_dwordx4 v43, s[16:19], s44 offen offset:3072 lds
    s_add_u32 m0, s50, 40960
    s_mov_b32 s48, 8192
    buffer_load_dwordx4 v26, s[8:11], s48 offen lds
    buffer_load_dwordx4 v27, s[8:11], s48 offen offset:1024 lds
    s_waitcnt lgkmcnt(0)
    v_mfma_f32_16x16x32_bf16 v[96:99], v[176:179], a[112:115], v[96:99]
    s_add_u32 m0, s43, 12288
    s_add_u32 s44, s56, 3408000
    s_and_b32 s44, s44, 4194047
    v_mfma_f32_16x16x32_bf16 v[104:107], v[176:179], a[116:119], v[104:107]
    s_waitcnt vmcnt(20)
    v_mul_f32 v220, v220, v220
    v_mfma_f32_16x16x32_bf16 v[112:115], v[176:179], a[120:123], v[112:115]
    ds_read_b64_tr_b16 v[160:161], v12 offset:16384
    v_mul_f32 v221, v221, v221
    v_mfma_f32_16x16x32_bf16 v[120:123], v[176:179], a[124:127], v[120:123]
    buffer_load_dwordx4 v40, s[16:19], s44 offen offset:0 lds
    v_mfma_f32_16x16x32_bf16 v[124:127], v[180:183], a[124:127], v[124:127]
    ds_read_b64_tr_b16 v[162:163], v12 offset:18432
    v_mul_f32 v222, v222, v222
    v_mfma_f32_16x16x32_bf16 v[116:119], v[180:183], a[120:123], v[116:119]
    ds_read_b64_tr_b16 v[164:165], v12 offset:16392
    v_mul_f32 v223, v223, v223
    v_mfma_f32_16x16x32_bf16 v[108:111], v[180:183], a[116:119], v[108:111]
    ds_read_b64_tr_b16 v[166:167], v12 offset:18440
    v_cvt_pk_bf16_f32 v204, v216, v217
    v_mfma_f32_16x16x32_bf16 v[100:103], v[180:183], a[112:115], v[100:103]
    buffer_load_dwordx4 v41, s[16:19], s44 offen offset:1024 lds
    v_mfma_f32_16x16x32_bf16 v[128:131], v[184:187], a[112:115], v[128:131]
    ds_read_b64_tr_b16 v[168:169], v13 offset:16384
    v_cvt_pk_bf16_f32 v205, v218, v219
    v_mfma_f32_16x16x32_bf16 v[136:139], v[184:187], a[116:119], v[136:139]
    ds_read_b64_tr_b16 v[170:171], v13 offset:18432
    v_cvt_pk_bf16_f32 v206, v220, v221
    v_mfma_f32_16x16x32_bf16 v[144:147], v[184:187], a[120:123], v[144:147]
    ds_read_b64_tr_b16 v[172:173], v13 offset:16392
    v_cvt_pk_bf16_f32 v207, v222, v223
    v_mfma_f32_16x16x32_bf16 v[152:155], v[184:187], a[124:127], v[152:155]
    buffer_load_dwordx4 v42, s[16:19], s44 offen offset:2048 lds
    v_mfma_f32_16x16x32_bf16 v[156:159], v[188:191], a[124:127], v[156:159]
    ds_read_b64_tr_b16 v[174:175], v13 offset:18440
    v_max_f32 v224, 0, v224
    v_mfma_f32_16x16x32_bf16 v[148:151], v[188:191], a[120:123], v[148:151]
    v_max_f32 v225, 0, v225
    v_max_f32 v226, 0, v226
    v_mfma_f32_16x16x32_bf16 v[140:143], v[188:191], a[116:119], v[140:143]
    v_max_f32 v227, 0, v227
    v_max_f32 v228, 0, v228
    v_mfma_f32_16x16x32_bf16 v[132:135], v[188:191], a[112:115], v[132:135]
    buffer_load_dwordx4 v43, s[16:19], s44 offen offset:3072 lds
    s_waitcnt lgkmcnt(0)
    v_mfma_f32_16x16x32_bf16 v[96:99], v[160:163], a[128:131], v[96:99]
    s_add_u32 m0, s43, 16384
    s_add_u32 s44, s56, 3670144
    s_and_b32 s44, s44, 4194047
    v_mfma_f32_16x16x32_bf16 v[104:107], v[160:163], a[132:135], v[104:107]
    s_waitcnt vmcnt(20)
    v_max_f32 v229, 0, v229
    v_mfma_f32_16x16x32_bf16 v[112:115], v[160:163], a[136:139], v[112:115]
    ds_read_b64_tr_b16 v[176:177], v12 offset:20480
    v_max_f32 v230, 0, v230
    v_mfma_f32_16x16x32_bf16 v[120:123], v[160:163], a[140:143], v[120:123]
    buffer_load_dwordx4 v40, s[16:19], s44 offen offset:0 lds
    v_mfma_f32_16x16x32_bf16 v[124:127], v[164:167], a[140:143], v[124:127]
    ds_read_b64_tr_b16 v[178:179], v12 offset:22528
    v_max_f32 v231, 0, v231
    v_mfma_f32_16x16x32_bf16 v[116:119], v[164:167], a[136:139], v[116:119]
    ds_read_b64_tr_b16 v[180:181], v12 offset:20488
    v_mul_f32 v224, v224, v224
    v_mfma_f32_16x16x32_bf16 v[108:111], v[164:167], a[132:135], v[108:111]
    ds_read_b64_tr_b16 v[182:183], v12 offset:22536
    v_mul_f32 v225, v225, v225
    v_mfma_f32_16x16x32_bf16 v[100:103], v[164:167], a[128:131], v[100:103]
    buffer_load_dwordx4 v41, s[16:19], s44 offen offset:1024 lds
    v_mfma_f32_16x16x32_bf16 v[128:131], v[168:171], a[128:131], v[128:131]
    ds_read_b64_tr_b16 v[184:185], v13 offset:20480
    v_mul_f32 v226, v226, v226
    v_mfma_f32_16x16x32_bf16 v[136:139], v[168:171], a[132:135], v[136:139]
    ds_read_b64_tr_b16 v[186:187], v13 offset:22528
    v_mul_f32 v227, v227, v227
    v_mfma_f32_16x16x32_bf16 v[144:147], v[168:171], a[136:139], v[144:147]
    ds_read_b64_tr_b16 v[188:189], v13 offset:20488
    v_mul_f32 v228, v228, v228
    v_mfma_f32_16x16x32_bf16 v[152:155], v[168:171], a[140:143], v[152:155]
    buffer_load_dwordx4 v42, s[16:19], s44 offen offset:2048 lds
    v_mfma_f32_16x16x32_bf16 v[156:159], v[172:175], a[140:143], v[156:159]
    ds_read_b64_tr_b16 v[190:191], v13 offset:22536
    v_mul_f32 v229, v229, v229
    v_mfma_f32_16x16x32_bf16 v[148:151], v[172:175], a[136:139], v[148:151]
    v_mul_f32 v230, v230, v230
    v_mul_f32 v231, v231, v231
    v_mfma_f32_16x16x32_bf16 v[140:143], v[172:175], a[132:135], v[140:143]
    v_cvt_pk_bf16_f32 v208, v224, v225
    v_cvt_pk_bf16_f32 v209, v226, v227
    v_mfma_f32_16x16x32_bf16 v[132:135], v[172:175], a[128:131], v[132:135]
    buffer_load_dwordx4 v43, s[16:19], s44 offen offset:3072 lds
    s_waitcnt lgkmcnt(0)
    v_mfma_f32_16x16x32_bf16 v[96:99], v[176:179], a[144:147], v[96:99]
    s_add_u32 m0, s43, 20480
    s_add_u32 s44, s56, 3932288
    s_and_b32 s44, s44, 4194047
    v_mfma_f32_16x16x32_bf16 v[104:107], v[176:179], a[148:151], v[104:107]
    s_waitcnt vmcnt(20)
    v_cvt_pk_bf16_f32 v210, v228, v229
    v_mfma_f32_16x16x32_bf16 v[112:115], v[176:179], a[152:155], v[112:115]
    ds_read_b64_tr_b16 v[160:161], v12 offset:0
    v_cvt_pk_bf16_f32 v211, v230, v231
    v_mfma_f32_16x16x32_bf16 v[120:123], v[176:179], a[156:159], v[120:123]
    buffer_load_dwordx4 v40, s[16:19], s44 offen offset:0 lds
    v_mfma_f32_16x16x32_bf16 v[124:127], v[180:183], a[156:159], v[124:127]
    ds_read_b64_tr_b16 v[162:163], v12 offset:2048
    v_max_f32 v232, 0, v232
    v_mfma_f32_16x16x32_bf16 v[116:119], v[180:183], a[152:155], v[116:119]
    ds_read_b64_tr_b16 v[164:165], v12 offset:8
    v_max_f32 v233, 0, v233
    v_mfma_f32_16x16x32_bf16 v[108:111], v[180:183], a[148:151], v[108:111]
    ds_read_b64_tr_b16 v[166:167], v12 offset:2056
    v_max_f32 v234, 0, v234
    v_mfma_f32_16x16x32_bf16 v[100:103], v[180:183], a[144:147], v[100:103]
    buffer_load_dwordx4 v41, s[16:19], s44 offen offset:1024 lds
    v_mfma_f32_16x16x32_bf16 v[128:131], v[184:187], a[144:147], v[128:131]
    ds_read_b64_tr_b16 v[168:169], v13 offset:0
    v_max_f32 v235, 0, v235
    v_mfma_f32_16x16x32_bf16 v[136:139], v[184:187], a[148:151], v[136:139]
    ds_read_b64_tr_b16 v[170:171], v13 offset:2048
    v_max_f32 v236, 0, v236
    v_mfma_f32_16x16x32_bf16 v[144:147], v[184:187], a[152:155], v[144:147]
    ds_read_b64_tr_b16 v[172:173], v13 offset:8
    v_max_f32 v237, 0, v237
    v_mfma_f32_16x16x32_bf16 v[152:155], v[184:187], a[156:159], v[152:155]
    buffer_load_dwordx4 v42, s[16:19], s44 offen offset:2048 lds
    v_mfma_f32_16x16x32_bf16 v[156:159], v[188:191], a[156:159], v[156:159]
    ds_read_b64_tr_b16 v[174:175], v13 offset:2056
    v_max_f32 v238, 0, v238
    v_mfma_f32_16x16x32_bf16 v[148:151], v[188:191], a[152:155], v[148:151]
    v_max_f32 v239, 0, v239
    v_mul_f32 v232, v232, v232
    v_mfma_f32_16x16x32_bf16 v[140:143], v[188:191], a[148:151], v[140:143]
    v_mul_f32 v233, v233, v233
    v_mul_f32 v234, v234, v234
    v_mfma_f32_16x16x32_bf16 v[132:135], v[188:191], a[144:147], v[132:135]
    buffer_load_dwordx4 v43, s[16:19], s44 offen offset:3072 lds
    s_waitcnt lgkmcnt(0)
    v_mfma_f32_16x16x32_bf16 v[96:99], v[160:163], a[160:163], v[96:99]
    s_add_u32 m0, s43, 0
    s_mov_b32 s44, 0
    v_mfma_f32_16x16x32_bf16 v[104:107], v[160:163], a[164:167], v[104:107]
    s_waitcnt vmcnt(18)
    v_mul_f32 v235, v235, v235
    v_mfma_f32_16x16x32_bf16 v[112:115], v[160:163], a[168:171], v[112:115]
    ds_read_b64_tr_b16 v[176:177], v12 offset:4096
    v_mul_f32 v236, v236, v236
    v_mfma_f32_16x16x32_bf16 v[120:123], v[160:163], a[172:175], v[120:123]
    buffer_load_dwordx4 v14, s[28:31], s44 offen offset:0 lds
    v_mfma_f32_16x16x32_bf16 v[124:127], v[164:167], a[172:175], v[124:127]
    ds_read_b64_tr_b16 v[178:179], v12 offset:6144
    v_mul_f32 v237, v237, v237
    v_mfma_f32_16x16x32_bf16 v[116:119], v[164:167], a[168:171], v[116:119]
    ds_read_b64_tr_b16 v[180:181], v12 offset:4104
    v_mul_f32 v238, v238, v238
    v_mfma_f32_16x16x32_bf16 v[108:111], v[164:167], a[164:167], v[108:111]
    ds_read_b64_tr_b16 v[182:183], v12 offset:6152
    v_mul_f32 v239, v239, v239
    v_mfma_f32_16x16x32_bf16 v[100:103], v[164:167], a[160:163], v[100:103]
    buffer_load_dwordx4 v15, s[28:31], s44 offen offset:1024 lds
    v_mfma_f32_16x16x32_bf16 v[128:131], v[168:171], a[160:163], v[128:131]
    ds_read_b64_tr_b16 v[184:185], v13 offset:4096
    v_cvt_pk_bf16_f32 v212, v232, v233
    v_mfma_f32_16x16x32_bf16 v[136:139], v[168:171], a[164:167], v[136:139]
    ds_read_b64_tr_b16 v[186:187], v13 offset:6144
    v_cvt_pk_bf16_f32 v213, v234, v235
    v_mfma_f32_16x16x32_bf16 v[144:147], v[168:171], a[168:171], v[144:147]
    ds_read_b64_tr_b16 v[188:189], v13 offset:4104
    v_cvt_pk_bf16_f32 v214, v236, v237
    v_mfma_f32_16x16x32_bf16 v[152:155], v[168:171], a[172:175], v[152:155]
    buffer_load_dwordx4 v16, s[28:31], s44 offen offset:2048 lds
    v_mfma_f32_16x16x32_bf16 v[156:159], v[172:175], a[172:175], v[156:159]
    ds_read_b64_tr_b16 v[190:191], v13 offset:6152
    v_cvt_pk_bf16_f32 v215, v238, v239
    v_mfma_f32_16x16x32_bf16 v[148:151], v[172:175], a[168:171], v[148:151]
    v_max_f32 v240, 0, v240
    v_max_f32 v241, 0, v241
    v_mfma_f32_16x16x32_bf16 v[140:143], v[172:175], a[164:167], v[140:143]
    v_max_f32 v242, 0, v242
    v_max_f32 v243, 0, v243
    v_mfma_f32_16x16x32_bf16 v[132:135], v[172:175], a[160:163], v[132:135]
    buffer_load_dwordx4 v17, s[28:31], s44 offen offset:3072 lds
    s_waitcnt lgkmcnt(0)
    v_mfma_f32_16x16x32_bf16 v[96:99], v[176:179], a[176:179], v[96:99]
    s_add_u32 m0, s43, 4096
    s_mov_b32 s44, 32768
    v_mfma_f32_16x16x32_bf16 v[104:107], v[176:179], a[180:183], v[104:107]
    s_waitcnt vmcnt(18)
    v_max_f32 v244, 0, v244
    v_mfma_f32_16x16x32_bf16 v[112:115], v[176:179], a[184:187], v[112:115]
    ds_read_b64_tr_b16 v[160:161], v12 offset:8192
    v_max_f32 v245, 0, v245
    v_mfma_f32_16x16x32_bf16 v[120:123], v[176:179], a[188:191], v[120:123]
    buffer_load_dwordx4 v14, s[28:31], s44 offen offset:0 lds
    v_mfma_f32_16x16x32_bf16 v[124:127], v[180:183], a[188:191], v[124:127]
    ds_read_b64_tr_b16 v[162:163], v12 offset:10240
    v_max_f32 v246, 0, v246
    v_mfma_f32_16x16x32_bf16 v[116:119], v[180:183], a[184:187], v[116:119]
    ds_read_b64_tr_b16 v[164:165], v12 offset:8200
    v_max_f32 v247, 0, v247
    v_mfma_f32_16x16x32_bf16 v[108:111], v[180:183], a[180:183], v[108:111]
    ds_read_b64_tr_b16 v[166:167], v12 offset:10248
    v_mul_f32 v240, v240, v240
    v_mfma_f32_16x16x32_bf16 v[100:103], v[180:183], a[176:179], v[100:103]
    buffer_load_dwordx4 v15, s[28:31], s44 offen offset:1024 lds
    v_mfma_f32_16x16x32_bf16 v[128:131], v[184:187], a[176:179], v[128:131]
    ds_read_b64_tr_b16 v[168:169], v13 offset:8192
    v_mul_f32 v241, v241, v241
    v_mfma_f32_16x16x32_bf16 v[136:139], v[184:187], a[180:183], v[136:139]
    ds_read_b64_tr_b16 v[170:171], v13 offset:10240
    v_mul_f32 v242, v242, v242
    v_mfma_f32_16x16x32_bf16 v[144:147], v[184:187], a[184:187], v[144:147]
    ds_read_b64_tr_b16 v[172:173], v13 offset:8200
    v_mul_f32 v243, v243, v243
    v_mfma_f32_16x16x32_bf16 v[152:155], v[184:187], a[188:191], v[152:155]
    buffer_load_dwordx4 v16, s[28:31], s44 offen offset:2048 lds
    v_mfma_f32_16x16x32_bf16 v[156:159], v[188:191], a[188:191], v[156:159]
    ds_read_b64_tr_b16 v[174:175], v13 offset:10248
    v_mul_f32 v244, v244, v244
    v_mfma_f32_16x16x32_bf16 v[148:151], v[188:191], a[184:187], v[148:151]
    v_mul_f32 v245, v245, v245
    v_mul_f32 v246, v246, v246
    v_mfma_f32_16x16x32_bf16 v[140:143], v[188:191], a[180:183], v[140:143]
    v_mul_f32 v247, v247, v247
    v_cvt_pk_bf16_f32 v216, v240, v241
    v_mfma_f32_16x16x32_bf16 v[132:135], v[188:191], a[176:179], v[132:135]
    buffer_load_dwordx4 v17, s[28:31], s44 offen offset:3072 lds
    s_waitcnt lgkmcnt(0)
    v_mfma_f32_16x16x32_bf16 v[96:99], v[160:163], a[192:195], v[96:99]
    s_add_u32 m0, s43, 8192
    s_mov_b32 s44, 65536
    v_mfma_f32_16x16x32_bf16 v[104:107], v[160:163], a[196:199], v[104:107]
    s_waitcnt vmcnt(16)
    v_cvt_pk_bf16_f32 v217, v242, v243
    v_mfma_f32_16x16x32_bf16 v[112:115], v[160:163], a[200:203], v[112:115]
    ds_read_b64_tr_b16 v[176:177], v12 offset:12288
    v_cvt_pk_bf16_f32 v218, v244, v245
    v_mfma_f32_16x16x32_bf16 v[120:123], v[160:163], a[204:207], v[120:123]
    buffer_load_dwordx4 v14, s[28:31], s44 offen offset:0 lds
    v_mfma_f32_16x16x32_bf16 v[124:127], v[164:167], a[204:207], v[124:127]
    ds_read_b64_tr_b16 v[178:179], v12 offset:14336
    v_cvt_pk_bf16_f32 v219, v246, v247
    v_mfma_f32_16x16x32_bf16 v[116:119], v[164:167], a[200:203], v[116:119]
    ds_read_b64_tr_b16 v[180:181], v12 offset:12296
    v_max_f32 v248, 0, v248
    v_mfma_f32_16x16x32_bf16 v[108:111], v[164:167], a[196:199], v[108:111]
    ds_read_b64_tr_b16 v[182:183], v12 offset:14344
    v_max_f32 v249, 0, v249
    v_mfma_f32_16x16x32_bf16 v[100:103], v[164:167], a[192:195], v[100:103]
    buffer_load_dwordx4 v15, s[28:31], s44 offen offset:1024 lds
    v_mfma_f32_16x16x32_bf16 v[128:131], v[168:171], a[192:195], v[128:131]
    ds_read_b64_tr_b16 v[184:185], v13 offset:12288
    v_max_f32 v250, 0, v250
    v_mfma_f32_16x16x32_bf16 v[136:139], v[168:171], a[196:199], v[136:139]
    ds_read_b64_tr_b16 v[186:187], v13 offset:14336
    v_max_f32 v251, 0, v251
    v_mfma_f32_16x16x32_bf16 v[144:147], v[168:171], a[200:203], v[144:147]
    ds_read_b64_tr_b16 v[188:189], v13 offset:12296
    v_max_f32 v252, 0, v252
    v_mfma_f32_16x16x32_bf16 v[152:155], v[168:171], a[204:207], v[152:155]
    buffer_load_dwordx4 v16, s[28:31], s44 offen offset:2048 lds
    v_mfma_f32_16x16x32_bf16 v[156:159], v[172:175], a[204:207], v[156:159]
    ds_read_b64_tr_b16 v[190:191], v13 offset:14344
    v_max_f32 v253, 0, v253
    v_mfma_f32_16x16x32_bf16 v[148:151], v[172:175], a[200:203], v[148:151]
    v_max_f32 v254, 0, v254
    v_max_f32 v255, 0, v255
    v_mfma_f32_16x16x32_bf16 v[140:143], v[172:175], a[196:199], v[140:143]
    v_mul_f32 v248, v248, v248
    v_mul_f32 v249, v249, v249
    v_mfma_f32_16x16x32_bf16 v[132:135], v[172:175], a[192:195], v[132:135]
    buffer_load_dwordx4 v17, s[28:31], s44 offen offset:3072 lds
    s_barrier
    s_waitcnt lgkmcnt(0)
    v_mfma_f32_16x16x32_bf16 v[96:99], v[176:179], a[208:211], v[96:99]
    s_add_u32 m0, s43, 12288
    s_mov_b32 s44, 98304
    v_mfma_f32_16x16x32_bf16 v[104:107], v[176:179], a[212:215], v[104:107]
    s_waitcnt vmcnt(16)
    ds_read_b128 a[160:163], v18 offset:0
    v_mfma_f32_16x16x32_bf16 v[112:115], v[176:179], a[216:219], v[112:115]
    ds_read_b64_tr_b16 v[160:161], v12 offset:16384
    ds_read_b128 a[164:167], v18 offset:4096
    v_mfma_f32_16x16x32_bf16 v[120:123], v[176:179], a[220:223], v[120:123]
    buffer_load_dwordx4 v14, s[28:31], s44 offen offset:0 lds
    v_mfma_f32_16x16x32_bf16 v[124:127], v[180:183], a[220:223], v[124:127]
    ds_read_b64_tr_b16 v[162:163], v12 offset:18432
    ds_read_b128 a[168:171], v19 offset:0
    v_mfma_f32_16x16x32_bf16 v[116:119], v[180:183], a[216:219], v[116:119]
    ds_read_b64_tr_b16 v[164:165], v12 offset:16392
    ds_read_b128 a[172:175], v19 offset:4096
    v_mfma_f32_16x16x32_bf16 v[108:111], v[180:183], a[212:215], v[108:111]
    ds_read_b64_tr_b16 v[166:167], v12 offset:18440
    ds_read_b128 a[176:179], v20 offset:0
    v_mfma_f32_16x16x32_bf16 v[100:103], v[180:183], a[208:211], v[100:103]
    buffer_load_dwordx4 v15, s[28:31], s44 offen offset:1024 lds
    v_mfma_f32_16x16x32_bf16 v[128:131], v[184:187], a[208:211], v[128:131]
    ds_read_b64_tr_b16 v[168:169], v13 offset:16384
    ds_read_b128 a[180:183], v20 offset:4096
    v_mfma_f32_16x16x32_bf16 v[136:139], v[184:187], a[212:215], v[136:139]
    ds_read_b64_tr_b16 v[170:171], v13 offset:18432
    ds_read_b128 a[184:187], v21 offset:0
    v_mfma_f32_16x16x32_bf16 v[144:147], v[184:187], a[216:219], v[144:147]
    ds_read_b64_tr_b16 v[172:173], v13 offset:16392
    ds_read_b128 a[188:191], v21 offset:4096
    v_mfma_f32_16x16x32_bf16 v[152:155], v[184:187], a[220:223], v[152:155]
    buffer_load_dwordx4 v16, s[28:31], s44 offen offset:2048 lds
    v_mfma_f32_16x16x32_bf16 v[156:159], v[188:191], a[220:223], v[156:159]
    ds_read_b64_tr_b16 v[174:175], v13 offset:18440
    v_mul_f32 v250, v250, v250
    v_mfma_f32_16x16x32_bf16 v[148:151], v[188:191], a[216:219], v[148:151]
    v_mul_f32 v251, v251, v251
    v_mul_f32 v252, v252, v252
    v_mfma_f32_16x16x32_bf16 v[140:143], v[188:191], a[212:215], v[140:143]
    v_mul_f32 v253, v253, v253
    v_mul_f32 v254, v254, v254
    v_mfma_f32_16x16x32_bf16 v[132:135], v[188:191], a[208:211], v[132:135]
    buffer_load_dwordx4 v17, s[28:31], s44 offen offset:3072 lds
    s_waitcnt lgkmcnt(0)
    v_mfma_f32_16x16x32_bf16 v[96:99], v[160:163], a[224:227], v[96:99]
    s_add_u32 m0, s43, 16384
    s_mov_b32 s44, 131072
    v_mfma_f32_16x16x32_bf16 v[104:107], v[160:163], a[228:231], v[104:107]
    s_waitcnt vmcnt(16)
    v_mul_f32 v255, v255, v255
    v_mfma_f32_16x16x32_bf16 v[112:115], v[160:163], a[232:235], v[112:115]
    ds_read_b64_tr_b16 v[176:177], v12 offset:20480
    v_cvt_pk_bf16_f32 v220, v248, v249
    v_mfma_f32_16x16x32_bf16 v[120:123], v[160:163], a[236:239], v[120:123]
    buffer_load_dwordx4 v14, s[28:31], s44 offen offset:0 lds
    v_mfma_f32_16x16x32_bf16 v[124:127], v[164:167], a[236:239], v[124:127]
    ds_read_b64_tr_b16 v[178:179], v12 offset:22528
    v_cvt_pk_bf16_f32 v221, v250, v251
    v_mfma_f32_16x16x32_bf16 v[116:119], v[164:167], a[232:235], v[116:119]
    ds_read_b64_tr_b16 v[180:181], v12 offset:20488
    v_cvt_pk_bf16_f32 v222, v252, v253
    v_mfma_f32_16x16x32_bf16 v[108:111], v[164:167], a[228:231], v[108:111]
    ds_read_b64_tr_b16 v[182:183], v12 offset:22536
    v_cvt_pk_bf16_f32 v223, v254, v255
    v_mfma_f32_16x16x32_bf16 v[100:103], v[164:167], a[224:227], v[100:103]
    buffer_load_dwordx4 v15, s[28:31], s44 offen offset:1024 lds
    v_mfma_f32_16x16x32_bf16 v[128:131], v[168:171], a[224:227], v[128:131]
    ds_read_b64_tr_b16 v[184:185], v13 offset:20480
    s_and_b32 s46, s41, 3
    v_mfma_f32_16x16x32_bf16 v[136:139], v[168:171], a[228:231], v[136:139]
    ds_read_b64_tr_b16 v[186:187], v13 offset:22528
    s_lshl_b32 s46, s46, 10
    v_mfma_f32_16x16x32_bf16 v[144:147], v[168:171], a[232:235], v[144:147]
    ds_read_b64_tr_b16 v[188:189], v13 offset:20488
    s_lshl_b32 s47, s40, 13
    v_mfma_f32_16x16x32_bf16 v[152:155], v[168:171], a[236:239], v[152:155]
    buffer_load_dwordx4 v16, s[28:31], s44 offen offset:2048 lds
    v_mfma_f32_16x16x32_bf16 v[156:159], v[172:175], a[236:239], v[156:159]
    ds_read_b64_tr_b16 v[190:191], v13 offset:22536
    s_add_u32 s46, s46, s47
    v_mfma_f32_16x16x32_bf16 v[148:151], v[172:175], a[232:235], v[148:151]
    v_add_u32 v40, s46, v6
    v_xor_b32 v41, 1024, v40
    v_mfma_f32_16x16x32_bf16 v[140:143], v[172:175], a[228:231], v[140:143]
    v_xor_b32 v42, 2048, v40
    v_xor_b32 v43, 3072, v40
    v_mfma_f32_16x16x32_bf16 v[132:135], v[172:175], a[224:227], v[132:135]
    buffer_load_dwordx4 v17, s[28:31], s44 offen offset:3072 lds
    s_waitcnt lgkmcnt(0)
    v_mfma_f32_16x16x32_bf16 v[96:99], v[176:179], a[240:243], v[96:99]
    s_add_u32 m0, s43, 20480
    s_mov_b32 s44, 163840
    v_mfma_f32_16x16x32_bf16 v[104:107], v[176:179], a[244:247], v[104:107]
    s_waitcnt vmcnt(16)
    v_add_u32 v44, s46, v7
    v_mfma_f32_16x16x32_bf16 v[112:115], v[176:179], a[248:251], v[112:115]
    ds_read_b64_tr_b16 a[112:113], v2 offset:0
    v_xor_b32 v45, 1024, v44
    v_mfma_f32_16x16x32_bf16 v[120:123], v[176:179], a[252:255], v[120:123]
    buffer_load_dwordx4 v14, s[28:31], s44 offen offset:0 lds
    v_mfma_f32_16x16x32_bf16 v[124:127], v[180:183], a[252:255], v[124:127]
    ds_read_b64_tr_b16 a[114:115], v2 offset:2048
    v_xor_b32 v46, 2048, v44
    v_mfma_f32_16x16x32_bf16 v[116:119], v[180:183], a[248:251], v[116:119]
    ds_read_b64_tr_b16 a[116:117], v3 offset:0
    v_xor_b32 v47, 3072, v44
    v_mfma_f32_16x16x32_bf16 v[108:111], v[180:183], a[244:247], v[108:111]
    ds_read_b64_tr_b16 a[118:119], v3 offset:2048
    v_mfma_f32_16x16x32_bf16 v[100:103], v[180:183], a[240:243], v[100:103]
    buffer_load_dwordx4 v15, s[28:31], s44 offen offset:1024 lds
    v_mfma_f32_16x16x32_bf16 v[128:131], v[184:187], a[240:243], v[128:131]
    ds_read_b64_tr_b16 a[120:121], v4 offset:0
    v_mfma_f32_16x16x32_bf16 v[136:139], v[184:187], a[244:247], v[136:139]
    ds_read_b64_tr_b16 a[122:123], v4 offset:2048
    v_mfma_f32_16x16x32_bf16 v[144:147], v[184:187], a[248:251], v[144:147]
    ds_read_b64_tr_b16 a[124:125], v5 offset:0
    v_mfma_f32_16x16x32_bf16 v[152:155], v[184:187], a[252:255], v[152:155]
    buffer_load_dwordx4 v16, s[28:31], s44 offen offset:2048 lds
    v_mfma_f32_16x16x32_bf16 v[156:159], v[188:191], a[252:255], v[156:159]
    ds_read_b64_tr_b16 a[126:127], v5 offset:2048
    v_mfma_f32_16x16x32_bf16 v[148:151], v[188:191], a[248:251], v[148:151]
    v_mfma_f32_16x16x32_bf16 v[140:143], v[188:191], a[244:247], v[140:143]
    v_mfma_f32_16x16x32_bf16 v[132:135], v[188:191], a[240:243], v[132:135]
    buffer_load_dwordx4 v17, s[28:31], s44 offen offset:3072 lds
    v_mfma_f32_16x16x32_bf16 v[160:163], a[160:163], v[64:67], 0
    v_mfma_f32_16x16x32_bf16 v[168:171], a[160:163], v[68:71], 0
    v_mfma_f32_16x16x32_bf16 v[164:167], a[164:167], v[64:67], 0
    v_cvt_pk_bf16_f32 v96, v96, v97
    v_cvt_pk_bf16_f32 v97, v98, v99
    v_cvt_pk_bf16_f32 v98, v100, v101
    v_mfma_f32_16x16x32_bf16 v[172:175], a[164:167], v[68:71], 0
    v_cvt_pk_bf16_f32 v99, v102, v103
    v_cvt_pk_bf16_f32 v100, v104, v105
    v_cvt_pk_bf16_f32 v101, v106, v107
    v_mfma_f32_16x16x32_bf16 v[160:163], a[168:171], v[80:83], v[160:163]
    v_cvt_pk_bf16_f32 v102, v108, v109
    v_cvt_pk_bf16_f32 v103, v110, v111
    v_cvt_pk_bf16_f32 v104, v112, v113
    v_mfma_f32_16x16x32_bf16 v[168:171], a[168:171], v[84:87], v[168:171]
    v_cvt_pk_bf16_f32 v105, v114, v115
    v_cvt_pk_bf16_f32 v106, v116, v117
    v_cvt_pk_bf16_f32 v107, v118, v119
    v_mfma_f32_16x16x32_bf16 v[164:167], a[172:175], v[80:83], v[164:167]
    v_cvt_pk_bf16_f32 v108, v120, v121
    v_cvt_pk_bf16_f32 v109, v122, v123
    v_cvt_pk_bf16_f32 v110, v124, v125
    v_mfma_f32_16x16x32_bf16 v[172:175], a[172:175], v[84:87], v[172:175]
    v_cvt_pk_bf16_f32 v111, v126, v127
    v_cvt_pk_bf16_f32 v112, v128, v129
    v_cvt_pk_bf16_f32 v113, v130, v131
    v_mfma_f32_16x16x32_bf16 v[176:179], a[160:163], v[72:75], 0
    v_cvt_pk_bf16_f32 v114, v132, v133
    v_cvt_pk_bf16_f32 v115, v134, v135
    v_cvt_pk_bf16_f32 v116, v136, v137
    v_mfma_f32_16x16x32_bf16 v[184:187], a[160:163], v[76:79], 0
    v_cvt_pk_bf16_f32 v117, v138, v139
    v_cvt_pk_bf16_f32 v118, v140, v141
    v_cvt_pk_bf16_f32 v119, v142, v143
    v_mfma_f32_16x16x32_bf16 v[180:183], a[164:167], v[72:75], 0
    v_cvt_pk_bf16_f32 v120, v144, v145
    v_cvt_pk_bf16_f32 v121, v146, v147
    v_cvt_pk_bf16_f32 v122, v148, v149
    v_mfma_f32_16x16x32_bf16 v[188:191], a[164:167], v[76:79], 0
    v_cvt_pk_bf16_f32 v123, v150, v151
    v_cvt_pk_bf16_f32 v124, v152, v153
    v_cvt_pk_bf16_f32 v125, v154, v155
    v_mfma_f32_16x16x32_bf16 v[176:179], a[168:171], v[88:91], v[176:179]
    ds_write_b128 v40, v[192:195] offset:0
    v_cvt_pk_bf16_f32 v126, v156, v157
    v_cvt_pk_bf16_f32 v127, v158, v159
    v_mfma_f32_16x16x32_bf16 v[184:187], a[168:171], v[92:95], v[184:187]
    v_mfma_f32_16x16x32_bf16 v[180:183], a[172:175], v[88:91], v[180:183]
    ds_write_b128 v41, v[196:199] offset:0
    v_mfma_f32_16x16x32_bf16 v[188:191], a[172:175], v[92:95], v[188:191]
    v_mfma_f32_16x16x32_bf16 v[160:163], a[176:179], v[96:99], v[160:163]
    ds_write_b128 v42, v[200:203] offset:0
    v_mfma_f32_16x16x32_bf16 v[168:171], a[176:179], v[100:103], v[168:171]
    v_mfma_f32_16x16x32_bf16 v[164:167], a[180:183], v[96:99], v[164:167]
    ds_write_b128 v43, v[204:207] offset:0
    v_mfma_f32_16x16x32_bf16 v[172:175], a[180:183], v[100:103], v[172:175]
    v_mfma_f32_16x16x32_bf16 v[160:163], a[184:187], v[112:115], v[160:163]
    ds_write_b128 v44, v[208:211] offset:4096
    v_mfma_f32_16x16x32_bf16 v[168:171], a[184:187], v[116:119], v[168:171]
    v_mfma_f32_16x16x32_bf16 v[164:167], a[188:191], v[112:115], v[164:167]
    ds_write_b128 v45, v[212:215] offset:4096
    v_mfma_f32_16x16x32_bf16 v[172:175], a[188:191], v[116:119], v[172:175]
    v_mfma_f32_16x16x32_bf16 v[176:179], a[176:179], v[104:107], v[176:179]
    ds_write_b128 v46, v[216:219] offset:4096
    v_mfma_f32_16x16x32_bf16 v[184:187], a[176:179], v[108:111], v[184:187]
    v_mfma_f32_16x16x32_bf16 v[180:183], a[180:183], v[104:107], v[180:183]
    ds_write_b128 v47, v[220:223] offset:4096
    v_mfma_f32_16x16x32_bf16 v[188:191], a[180:183], v[108:111], v[188:191]
    v_mfma_f32_16x16x32_bf16 v[176:179], a[184:187], v[120:123], v[176:179]
    v_mfma_f32_16x16x32_bf16 v[184:187], a[184:187], v[124:127], v[184:187]
    v_mfma_f32_16x16x32_bf16 v[180:183], a[188:191], v[120:123], v[180:183]
    s_waitcnt lgkmcnt(0)
    s_barrier
    ds_read_b128 a[0:3], v8 offset:0
    ds_read_b128 a[4:7], v8 offset:1024
    ds_read_b128 a[8:11], v8 offset:2048
    ds_read_b128 a[12:15], v8 offset:3072
    v_mfma_f32_16x16x32_bf16 v[188:191], a[188:191], v[124:127], v[188:191]
    s_cmp_lg_u32 s54, 0
    s_cbranch_scc1 L_maxpass
L_maxret:
    s_waitcnt lgkmcnt(0)
    v_mfma_f32_16x16x32_bf16 v[128:131], a[112:115], a[0:3], 0
    s_add_u32 m0, s43, 0
    s_mov_b32 s44, 196608
    ds_read_b128 a[160:163], v18 offset:8192
    v_mfma_f32_16x16x32_bf16 v[136:139], a[112:115], a[4:7], 0
    ds_read_b128 a[16:19], v9 offset:4096
    ds_read_b128 a[20:23], v9 offset:5120
    ds_read_b128 a[164:167], v18 offset:12288
    v_mfma_f32_16x16x32_bf16 v[144:147], a[112:115], a[8:11], 0
    ds_read_b128 a[24:27], v9 offset:6144
    ds_read_b128 a[28:31], v9 offset:7168
    ds_read_b128 a[168:171], v19 offset:8192
    v_mfma_f32_16x16x32_bf16 v[152:155], a[112:115], a[12:15], 0
    buffer_load_dwordx4 v14, s[28:31], s44 offen offset:0 lds
    ds_read_b128 a[172:175], v19 offset:12288
    v_mfma_f32_16x16x32_bf16 v[156:159], a[116:119], a[12:15], 0
    s_waitcnt vmcnt(17)
    ds_read_b64_tr_b16 a[128:129], v2 offset:4096
    ds_read_b128 a[176:179], v20 offset:8192
    v_mfma_f32_16x16x32_bf16 v[148:151], a[116:119], a[8:11], 0
L_pg3:
    s_cbranch_execz L_pg7
    ds_read_b64_tr_b16 a[130:131], v2 offset:6144
    ds_read_b64_tr_b16 a[132:133], v3 offset:4096
    ds_read_b128 a[180:183], v20 offset:12288
    v_mfma_f32_16x16x32_bf16 v[140:143], a[116:119], a[4:7], 0
    ds_read_b64_tr_b16 a[134:135], v3 offset:6144
    ds_read_b64_tr_b16 a[136:137], v4 offset:4096
    ds_read_b128 a[184:187], v21 offset:8192
    v_mfma_f32_16x16x32_bf16 v[132:135], a[116:119], a[0:3], 0
    buffer_load_dwordx4 v15, s[28:31], s44 offen offset:1024 lds
    ds_read_b128 a[188:191], v21 offset:12288
    v_mfma_f32_16x16x32_bf16 v[192:195], a[120:123], a[0:3], 0
    ds_read_b64_tr_b16 a[138:139], v4 offset:6144
    ds_read_b64_tr_b16 a[140:141], v5 offset:4096
    v_max3_f32 v50, v160, v161, v162
    v_mfma_f32_16x16x32_bf16 v[200:203], a[120:123], a[4:7], 0
    ds_read_b64_tr_b16 a[142:143], v5 offset:6144
    v_max3_f32 v50, v50, v163, v164
    v_max3_f32 v50, v50, v165, v166
    v_mfma_f32_16x16x32_bf16 v[208:211], a[120:123], a[8:11], 0
    v_max_f32 v50, v50, v167
    v_mov_b32 v51, v50
    v_mfma_f32_16x16x32_bf16 v[216:219], a[120:123], a[12:15], 0
    buffer_load_dwordx4 v16, s[28:31], s44 offen offset:2048 lds
    v_mfma_f32_16x16x32_bf16 v[220:223], a[124:127], a[12:15], 0
    s_nop 1
    v_permlane32_swap_b32 v50, v51
    v_mfma_f32_16x16x32_bf16 v[212:215], a[124:127], a[8:11], 0
    s_nop 0
    v_max_f32 v50, v50, v51
    v_mov_b32 v51, v50
    v_mfma_f32_16x16x32_bf16 v[204:207], a[124:127], a[4:7], 0
    s_nop 1
    v_permlane16_swap_b32 v50, v51
    v_mfma_f32_16x16x32_bf16 v[196:199], a[124:127], a[0:3], 0
    buffer_load_dwordx4 v17, s[28:31], s44 offen offset:3072 lds
    s_nop 0
    s_waitcnt lgkmcnt(0)
    v_mfma_f32_16x16x32_bf16 v[128:131], a[128:131], a[16:19], v[128:131]
    s_add_u32 m0, s43, 4096
    s_mov_b32 s44, 128
    v_mov_b32 v40, 0xff81ff81
    v_mfma_f32_16x16x32_bf16 v[136:139], a[128:131], a[20:23], v[136:139]
    ds_read_b128 a[32:35], v8 offset:8192
    ds_read_b128 a[36:39], v8 offset:9216
    v_mov_b32 v41, 0xff81ff81
    v_mfma_f32_16x16x32_bf16 v[144:147], a[128:131], a[24:27], v[144:147]
    ds_read_b128 a[40:43], v8 offset:10240
    ds_read_b128 a[44:47], v8 offset:11264
    v_mov_b32 v42, 0xff81ff81
    v_mfma_f32_16x16x32_bf16 v[152:155], a[128:131], a[28:31], v[152:155]
    buffer_load_dwordx4 v14, s[28:31], s44 offen offset:0 lds
    v_mov_b32 v43, 0xff81ff81
    v_mfma_f32_16x16x32_bf16 v[156:159], a[132:135], a[28:31], v[156:159]
    s_waitcnt vmcnt(17)
    ds_read_b64_tr_b16 a[112:113], v2 offset:8192
    v_add_u32 v12, 65536, v30
    v_mfma_f32_16x16x32_bf16 v[148:151], a[132:135], a[24:27], v[148:151]
    ds_read_b64_tr_b16 a[114:115], v2 offset:10240
    ds_read_b64_tr_b16 a[116:117], v3 offset:8192
    v_add_u32 v13, 65536, v31
    v_mfma_f32_16x16x32_bf16 v[140:143], a[132:135], a[20:23], v[140:143]
    ds_read_b64_tr_b16 a[118:119], v3 offset:10240
    ds_read_b64_tr_b16 a[120:121], v4 offset:8192
    s_mov_b32 s56, 4096
    v_mfma_f32_16x16x32_bf16 v[132:135], a[132:135], a[16:19], v[132:135]
    buffer_load_dwordx4 v15, s[28:31], s44 offen offset:1024 lds
    s_xor_b32 s16, s41, 0
    v_mfma_f32_16x16x32_bf16 v[192:195], a[136:139], a[16:19], v[192:195]
    ds_read_b64_tr_b16 a[122:123], v4 offset:10240
    ds_read_b64_tr_b16 a[124:125], v5 offset:8192
    s_mul_i32 s16, s16, 135424
    v_mfma_f32_16x16x32_bf16 v[200:203], a[136:139], a[20:23], v[200:203]
    ds_read_b64_tr_b16 a[126:127], v5 offset:10240
    s_add_u32 s16, s16, 0
    s_xor_b32 s17, s41, 1
    v_mfma_f32_16x16x32_bf16 v[208:211], a[136:139], a[24:27], v[208:211]
    s_mul_i32 s17, s17, 135424
    s_add_u32 s17, s17, 1024
    s_xor_b32 s18, s41, 2
    v_mfma_f32_16x16x32_bf16 v[216:219], a[136:139], a[28:31], v[216:219]
    buffer_load_dwordx4 v16, s[28:31], s44 offen offset:2048 lds
    s_mul_i32 s18, s18, 135424
    v_mfma_f32_16x16x32_bf16 v[220:223], a[140:143], a[28:31], v[220:223]
    s_add_u32 s18, s18, 2048
    s_xor_b32 s19, s41, 3
    s_mul_i32 s19, s19, 135424
    v_mfma_f32_16x16x32_bf16 v[212:215], a[140:143], a[24:27], v[212:215]
    s_add_u32 s19, s19, 3072
    s_xor_b32 s24, s41, 4
    s_mul_i32 s24, s24, 135424
    v_mfma_f32_16x16x32_bf16 v[204:207], a[140:143], a[20:23], v[204:207]
    s_add_u32 s24, s24, 4096
    s_xor_b32 s25, s41, 5
    s_mul_i32 s25, s25, 135424
    v_mfma_f32_16x16x32_bf16 v[196:199], a[140:143], a[16:19], v[196:199]
    buffer_load_dwordx4 v17, s[28:31], s44 offen offset:3072 lds
    s_add_u32 s25, s25, 5120
    s_waitcnt lgkmcnt(0)
    v_mfma_f32_16x16x32_bf16 v[128:131], a[112:115], a[32:35], v[128:131]
    s_add_u32 m0, s43, 8192
    s_mov_b32 s44, 32896
    s_xor_b32 s26, s41, 6
    v_mfma_f32_16x16x32_bf16 v[136:139], a[112:115], a[36:39], v[136:139]
    ds_read_b128 a[48:51], v9 offset:12288
    ds_read_b128 a[52:55], v9 offset:13312
    s_mul_i32 s26, s26, 135424
    v_mfma_f32_16x16x32_bf16 v[144:147], a[112:115], a[40:43], v[144:147]
    ds_read_b128 a[56:59], v9 offset:14336
    ds_read_b128 a[60:63], v9 offset:15360
    s_add_u32 s26, s26, 6144
    v_mfma_f32_16x16x32_bf16 v[152:155], a[112:115], a[44:47], v[152:155]
    buffer_load_dwordx4 v14, s[28:31], s44 offen offset:0 lds
    s_xor_b32 s27, s41, 7
    v_mfma_f32_16x16x32_bf16 v[156:159], a[116:119], a[44:47], v[156:159]
    s_waitcnt vmcnt(17)
    ds_read_b64_tr_b16 a[128:129], v2 offset:12288
    s_mul_i32 s27, s27, 135424
    v_mfma_f32_16x16x32_bf16 v[148:151], a[116:119], a[40:43], v[148:151]
    ds_read_b64_tr_b16 a[130:131], v2 offset:14336
    ds_read_b64_tr_b16 a[132:133], v3 offset:12288
    s_add_u32 s27, s27, 7168
    v_mfma_f32_16x16x32_bf16 v[140:143], a[116:119], a[36:39], v[140:143]
    ds_read_b64_tr_b16 a[134:135], v3 offset:14336
    ds_read_b64_tr_b16 a[136:137], v4 offset:12288
    v_max_f32 v50, v50, v51
    v_mfma_f32_16x16x32_bf16 v[132:135], a[116:119], a[32:35], v[132:135]
    buffer_load_dwordx4 v15, s[28:31], s44 offen offset:1024 lds
    v_mfma_f32_16x16x32_bf16 v[192:195], a[120:123], a[32:35], v[192:195]
    ds_read_b64_tr_b16 a[138:139], v4 offset:14336
    ds_read_b64_tr_b16 a[140:141], v5 offset:12288
    v_mfma_f32_16x16x32_bf16 v[200:203], a[120:123], a[36:39], v[200:203]
    ds_read_b64_tr_b16 a[142:143], v5 offset:14336
    s_cmp_lg_u32 s54, 0
    s_cselect_b64 vcc, -1, 0
    v_mfma_f32_16x16x32_bf16 v[208:211], a[120:123], a[40:43], v[208:211]
    s_nop 0
    v_cndmask_b32 v50, v50, v32, vcc
    v_sub_f32 v224, 0, v50
    v_mfma_f32_16x16x32_bf16 v[216:219], a[120:123], a[44:47], v[216:219]
    buffer_load_dwordx4 v16, s[28:31], s44 offen offset:2048 lds
    v_sub_f32 v225, 0, v50
    v_mfma_f32_16x16x32_bf16 v[220:223], a[124:127], a[44:47], v[220:223]
    v_sub_f32 v226, 0, v50
    v_sub_f32 v227, 0, v50
    v_sub_f32 v160, v160, v50
    v_mfma_f32_16x16x32_bf16 v[212:215], a[124:127], a[40:43], v[212:215]
    v_sub_f32 v161, v161, v50
    v_sub_f32 v162, v162, v50
    v_sub_f32 v163, v163, v50
    v_mfma_f32_16x16x32_bf16 v[204:207], a[124:127], a[36:39], v[204:207]
    v_sub_f32 v164, v164, v50
    v_sub_f32 v165, v165, v50
    v_sub_f32 v166, v166, v50
    v_mfma_f32_16x16x32_bf16 v[196:199], a[124:127], a[32:35], v[196:199]
    buffer_load_dwordx4 v17, s[28:31], s44 offen offset:3072 lds
    v_sub_f32 v167, v167, v50
    s_waitcnt lgkmcnt(0)
    v_mfma_f32_16x16x32_bf16 v[128:131], a[128:131], a[48:51], v[128:131]
    s_add_u32 m0, s43, 12288
    s_mov_b32 s44, 65664
    v_max3_f32 v50, v168, v169, v170
    v_mfma_f32_16x16x32_bf16 v[136:139], a[128:131], a[52:55], v[136:139]
    ds_read_b128 a[64:67], v8 offset:16384
    ds_read_b128 a[68:71], v8 offset:17408
    v_max3_f32 v50, v50, v171, v172
    v_mfma_f32_16x16x32_bf16 v[144:147], a[128:131], a[56:59], v[144:147]
    ds_read_b128 a[72:75], v8 offset:18432
    ds_read_b128 a[76:79], v8 offset:19456
    v_max3_f32 v50, v50, v173, v174
    v_mfma_f32_16x16x32_bf16 v[152:155], a[128:131], a[60:63], v[152:155]
    buffer_load_dwordx4 v14, s[28:31], s44 offen offset:0 lds
    v_max_f32 v50, v50, v175
    v_mfma_f32_16x16x32_bf16 v[156:159], a[132:135], a[60:63], v[156:159]
    s_waitcnt vmcnt(17)
    ds_read_b64_tr_b16 a[112:113], v2 offset:16384
    v_mov_b32 v51, v50
    v_mfma_f32_16x16x32_bf16 v[148:151], a[132:135], a[56:59], v[148:151]
    ds_read_b64_tr_b16 a[114:115], v2 offset:18432
    ds_read_b64_tr_b16 a[116:117], v3 offset:16384
    v_mfma_f32_16x16x32_bf16 v[140:143], a[132:135], a[52:55], v[140:143]
    ds_read_b64_tr_b16 a[118:119], v3 offset:18432
    ds_read_b64_tr_b16 a[120:121], v4 offset:16384
    v_mfma_f32_16x16x32_bf16 v[132:135], a[132:135], a[48:51], v[132:135]
    buffer_load_dwordx4 v15, s[28:31], s44 offen offset:1024 lds
    v_mfma_f32_16x16x32_bf16 v[192:195], a[136:139], a[48:51], v[192:195]
    ds_read_b64_tr_b16 a[122:123], v4 offset:18432
    ds_read_b64_tr_b16 a[124:125], v5 offset:16384
    v_mfma_f32_16x16x32_bf16 v[200:203], a[136:139], a[52:55], v[200:203]
    ds_read_b64_tr_b16 a[126:127], v5 offset:18432
    s_nop 1
    v_mfma_f32_16x16x32_bf16 v[208:211], a[136:139], a[56:59], v[208:211]
    v_permlane32_swap_b32 v50, v51
    s_nop 0
    v_max_f32 v50, v50, v51
    v_mfma_f32_16x16x32_bf16 v[216:219], a[136:139], a[60:63], v[216:219]
    buffer_load_dwordx4 v16, s[28:31], s44 offen offset:2048 lds
    v_mov_b32 v51, v50
    v_mfma_f32_16x16x32_bf16 v[220:223], a[140:143], a[60:63], v[220:223]
    s_nop 1
    v_permlane16_swap_b32 v50, v51
    v_mfma_f32_16x16x32_bf16 v[212:215], a[140:143], a[56:59], v[212:215]
    s_nop 0
    v_max_f32 v50, v50, v51
    v_mfma_f32_16x16x32_bf16 v[204:207], a[140:143], a[52:55], v[204:207]
    s_cmp_lg_u32 s54, 0
    s_cselect_b64 vcc, -1, 0
    s_nop 0
    v_mfma_f32_16x16x32_bf16 v[196:199], a[140:143], a[48:51], v[196:199]
    buffer_load_dwordx4 v17, s[28:31], s44 offen offset:3072 lds
    v_cndmask_b32 v50, v50, v33, vcc
    s_waitcnt lgkmcnt(0)
    v_mfma_f32_16x16x32_bf16 v[128:131], a[112:115], a[64:67], v[128:131]
    s_add_u32 m0, s43, 16384
    s_mov_b32 s44, 98432
    v_sub_f32 v228, 0, v50
    v_mfma_f32_16x16x32_bf16 v[136:139], a[112:115], a[68:71], v[136:139]
    ds_read_b128 a[80:83], v9 offset:20480
    ds_read_b128 a[84:87], v9 offset:21504
    v_sub_f32 v229, 0, v50
    v_mfma_f32_16x16x32_bf16 v[144:147], a[112:115], a[72:75], v[144:147]
    ds_read_b128 a[88:91], v9 offset:22528
    ds_read_b128 a[92:95], v9 offset:23552
    v_sub_f32 v230, 0, v50
    v_mfma_f32_16x16x32_bf16 v[152:155], a[112:115], a[76:79], v[152:155]
    buffer_load_dwordx4 v14, s[28:31], s44 offen offset:0 lds
    v_sub_f32 v231, 0, v50
    v_mfma_f32_16x16x32_bf16 v[156:159], a[116:119], a[76:79], v[156:159]
    s_waitcnt vmcnt(17)
    ds_read_b64_tr_b16 a[128:129], v2 offset:20480
    v_sub_f32 v168, v168, v50
    v_mfma_f32_16x16x32_bf16 v[148:151], a[116:119], a[72:75], v[148:151]
    ds_read_b64_tr_b16 a[130:131], v2 offset:22528
    ds_read_b64_tr_b16 a[132:133], v3 offset:20480
    v_sub_f32 v169, v169, v50
    v_mfma_f32_16x16x32_bf16 v[140:143], a[116:119], a[68:71], v[140:143]
    ds_read_b64_tr_b16 a[134:135], v3 offset:22528
    ds_read_b64_tr_b16 a[136:137], v4 offset:20480
    v_sub_f32 v170, v170, v50
    v_mfma_f32_16x16x32_bf16 v[132:135], a[116:119], a[64:67], v[132:135]
    buffer_load_dwordx4 v15, s[28:31], s44 offen offset:1024 lds
    v_sub_f32 v171, v171, v50
    v_mfma_f32_16x16x32_bf16 v[192:195], a[120:123], a[64:67], v[192:195]
    ds_read_b64_tr_b16 a[138:139], v4 offset:22528
    ds_read_b64_tr_b16 a[140:141], v5 offset:20480
    v_sub_f32 v172, v172, v50
    v_mfma_f32_16x16x32_bf16 v[200:203], a[120:123], a[68:71], v[200:203]
    ds_read_b64_tr_b16 a[142:143], v5 offset:22528
    v_sub_f32 v173, v173, v50
    v_sub_f32 v174, v174, v50
    v_mfma_f32_16x16x32_bf16 v[208:211], a[120:123], a[72:75], v[208:211]
    v_sub_f32 v175, v175, v50
    v_max3_f32 v50, v176, v177, v178
    v_max3_f32 v50, v50, v179, v180
    v_mfma_f32_16x16x32_bf16 v[216:219], a[120:123], a[76:79], v[216:219]
    buffer_load_dwordx4 v16, s[28:31], s44 offen offset:2048 lds
    v_max3_f32 v50, v50, v181, v182
    v_mfma_f32_16x16x32_bf16 v[220:223], a[124:127], a[76:79], v[220:223]
    v_max_f32 v50, v50, v183
    v_mov_b32 v51, v50
    v_mfma_f32_16x16x32_bf16 v[212:215], a[124:127], a[72:75], v[212:215]
    s_nop 1
    v_permlane32_swap_b32 v50, v51
    v_mfma_f32_16x16x32_bf16 v[204:207], a[124:127], a[68:71], v[204:207]
    s_nop 0
    v_max_f32 v50, v50, v51
    v_mov_b32 v51, v50
    v_mfma_f32_16x16x32_bf16 v[196:199], a[124:127], a[64:67], v[196:199]
    buffer_load_dwordx4 v17, s[28:31], s44 offen offset:3072 lds
    s_waitcnt lgkmcnt(0)
    v_mfma_f32_16x16x32_bf16 v[128:131], a[128:131], a[80:83], v[128:131]
    s_add_u32 m0, s43, 20480
    s_mov_b32 s44, 131200
    v_mfma_f32_16x16x32_bf16 v[136:139], a[128:131], a[84:87], v[136:139]
    ds_read_b128 a[96:99], v8 offset:24576
    ds_read_b128 a[100:103], v8 offset:25600
    v_mfma_f32_16x16x32_bf16 v[144:147], a[128:131], a[88:91], v[144:147]
    ds_read_b128 a[104:107], v8 offset:26624
    ds_read_b128 a[108:111], v8 offset:27648
    v_mfma_f32_16x16x32_bf16 v[152:155], a[128:131], a[92:95], v[152:155]
    buffer_load_dwordx4 v14, s[28:31], s44 offen offset:0 lds
    v_mfma_f32_16x16x32_bf16 v[156:159], a[132:135], a[92:95], v[156:159]
    s_waitcnt vmcnt(17)
    ds_read_b64_tr_b16 a[112:113], v2 offset:0
    v_mfma_f32_16x16x32_bf16 v[148:151], a[132:135], a[88:91], v[148:151]
    ds_read_b64_tr_b16 a[114:115], v2 offset:2048
    ds_read_b64_tr_b16 a[116:117], v3 offset:0
    v_mfma_f32_16x16x32_bf16 v[140:143], a[132:135], a[84:87], v[140:143]
    ds_read_b64_tr_b16 a[118:119], v3 offset:2048
    ds_read_b64_tr_b16 a[120:121], v4 offset:0
    v_mfma_f32_16x16x32_bf16 v[132:135], a[132:135], a[80:83], v[132:135]
    buffer_load_dwordx4 v15, s[28:31], s44 offen offset:1024 lds
    v_mfma_f32_16x16x32_bf16 v[192:195], a[136:139], a[80:83], v[192:195]
    ds_read_b64_tr_b16 a[122:123], v4 offset:2048
    ds_read_b64_tr_b16 a[124:125], v5 offset:0
    v_mfma_f32_16x16x32_bf16 v[200:203], a[136:139], a[84:87], v[200:203]
    ds_read_b64_tr_b16 a[126:127], v5 offset:2048
    s_nop 1
    v_mfma_f32_16x16x32_bf16 v[208:211], a[136:139], a[88:91], v[208:211]
    v_permlane16_swap_b32 v50, v51
    s_nop 0
    v_max_f32 v50, v50, v51
    v_mfma_f32_16x16x32_bf16 v[216:219], a[136:139], a[92:95], v[216:219]
    buffer_load_dwordx4 v16, s[28:31], s44 offen offset:2048 lds
    v_mfma_f32_16x16x32_bf16 v[220:223], a[140:143], a[92:95], v[220:223]
    s_cmp_lg_u32 s54, 0
    s_cselect_b64 vcc, -1, 0
    s_nop 0
    v_mfma_f32_16x16x32_bf16 v[212:215], a[140:143], a[88:91], v[212:215]
    v_cndmask_b32 v50, v50, v34, vcc
    v_sub_f32 v232, 0, v50
    v_sub_f32 v233, 0, v50
    v_mfma_f32_16x16x32_bf16 v[204:207], a[140:143], a[84:87], v[204:207]
    v_sub_f32 v234, 0, v50
    v_sub_f32 v235, 0, v50
    v_sub_f32 v176, v176, v50
    v_mfma_f32_16x16x32_bf16 v[196:199], a[140:143], a[80:83], v[196:199]
    buffer_load_dwordx4 v17, s[28:31], s44 offen offset:3072 lds
    v_sub_f32 v177, v177, v50
    s_waitcnt lgkmcnt(0)
    v_mfma_f32_16x16x32_bf16 v[128:131], a[112:115], a[96:99], v[128:131]
    s_add_u32 m0, s43, 0
    s_mov_b32 s44, 163968
    v_mfma_f32_16x16x32_bf16 v[136:139], a[112:115], a[100:103], v[136:139]
    s_waitcnt vmcnt(16)
    v_sub_f32 v178, v178, v50
    v_mfma_f32_16x16x32_bf16 v[144:147], a[112:115], a[104:107], v[144:147]
    ds_read_b64_tr_b16 a[128:129], v2 offset:4096
    v_sub_f32 v179, v179, v50
    v_mfma_f32_16x16x32_bf16 v[152:155], a[112:115], a[108:111], v[152:155]
    buffer_load_dwordx4 v14, s[28:31], s44 offen offset:0 lds
    v_mfma_f32_16x16x32_bf16 v[156:159], a[116:119], a[108:111], v[156:159]
    ds_read_b64_tr_b16 a[130:131], v2 offset:6144
    v_sub_f32 v180, v180, v50
    v_mfma_f32_16x16x32_bf16 v[148:151], a[116:119], a[104:107], v[148:151]
    ds_read_b64_tr_b16 a[132:133], v3 offset:4096
    v_sub_f32 v181, v181, v50
    v_mfma_f32_16x16x32_bf16 v[140:143], a[116:119], a[100:103], v[140:143]
    ds_read_b64_tr_b16 a[134:135], v3 offset:6144
    v_sub_f32 v182, v182, v50
    v_mfma_f32_16x16x32_bf16 v[132:135], a[116:119], a[96:99], v[132:135]
    buffer_load_dwordx4 v15, s[28:31], s44 offen offset:1024 lds
    v_mfma_f32_16x16x32_bf16 v[192:195], a[120:123], a[96:99], v[192:195]
    ds_read_b64_tr_b16 a[136:137], v4 offset:4096
    v_sub_f32 v183, v183, v50
    v_mfma_f32_16x16x32_bf16 v[200:203], a[120:123], a[100:103], v[200:203]
    ds_read_b64_tr_b16 a[138:139], v4 offset:6144
    v_max3_f32 v50, v184, v185, v186
    v_mfma_f32_16x16x32_bf16 v[208:211], a[120:123], a[104:107], v[208:211]
    ds_read_b64_tr_b16 a[140:141], v5 offset:4096
    v_max3_f32 v50, v50, v187, v188
    v_mfma_f32_16x16x32_bf16 v[216:219], a[120:123], a[108:111], v[216:219]
    buffer_load_dwordx4 v16, s[28:31], s44 offen offset:2048 lds
    v_mfma_f32_16x16x32_bf16 v[220:223], a[124:127], a[108:111], v[220:223]
    ds_read_b64_tr_b16 a[142:143], v5 offset:6144
    v_max3_f32 v50, v50, v189, v190
    v_mfma_f32_16x16x32_bf16 v[212:215], a[124:127], a[104:107], v[212:215]
    v_max_f32 v50, v50, v191
    v_mov_b32 v51, v50
    v_mfma_f32_16x16x32_bf16 v[204:207], a[124:127], a[100:103], v[204:207]
    s_nop 1
    v_mfma_f32_16x16x32_bf16 v[196:199], a[124:127], a[96:99], v[196:199]
    buffer_load_dwordx4 v17, s[28:31], s44 offen offset:3072 lds
    s_barrier
    s_waitcnt lgkmcnt(0)
    v_mfma_f32_16x16x32_bf16 a[192:195], a[128:131], a[0:3], 0
    s_add_u32 m0, s43, 4096
    s_mov_b32 s44, 196736
    v_mfma_f32_16x16x32_bf16 a[200:203], a[128:131], a[4:7], 0
    s_waitcnt vmcnt(16)
    v_permlane32_swap_b32 v50, v51
    v_mfma_f32_16x16x32_bf16 a[208:211], a[128:131], a[8:11], 0
    ds_read_b64_tr_b16 a[112:113], v2 offset:8192
    s_nop 0
    v_mfma_f32_16x16x32_bf16 a[216:219], a[128:131], a[12:15], 0
    buffer_load_dwordx4 v14, s[28:31], s44 offen offset:0 lds
    v_mfma_f32_16x16x32_bf16 a[220:223], a[132:135], a[12:15], 0
    ds_read_b64_tr_b16 a[114:115], v2 offset:10240
    v_max_f32 v50, v50, v51
    v_mfma_f32_16x16x32_bf16 a[212:215], a[132:135], a[8:11], 0
    ds_read_b64_tr_b16 a[116:117], v3 offset:8192
    v_mov_b32 v51, v50
    v_mfma_f32_16x16x32_bf16 a[204:207], a[132:135], a[4:7], 0
    ds_read_b64_tr_b16 a[118:119], v3 offset:10240
    v_mfma_f32_16x16x32_bf16 a[196:199], a[132:135], a[0:3], 0
    buffer_load_dwordx4 v15, s[28:31], s44 offen offset:1024 lds
    v_mfma_f32_16x16x32_bf16 a[224:227], a[136:139], a[0:3], 0
    ds_read_b64_tr_b16 a[120:121], v4 offset:8192
    v_mfma_f32_16x16x32_bf16 a[232:235], a[136:139], a[4:7], 0
    ds_read_b64_tr_b16 a[122:123], v4 offset:10240
    v_mfma_f32_16x16x32_bf16 a[240:243], a[136:139], a[8:11], 0
    ds_read_b64_tr_b16 a[124:125], v5 offset:8192
    v_mfma_f32_16x16x32_bf16 a[248:251], a[136:139], a[12:15], 0
    buffer_load_dwordx4 v16, s[28:31], s44 offen offset:2048 lds
    v_mfma_f32_16x16x32_bf16 a[252:255], a[140:143], a[12:15], 0
    ds_read_b64_tr_b16 a[126:127], v5 offset:10240
    v_mfma_f32_16x16x32_bf16 a[244:247], a[140:143], a[8:11], 0
    s_nop 1
    v_mfma_f32_16x16x32_bf16 a[236:239], a[140:143], a[4:7], 0
    v_permlane16_swap_b32 v50, v51
    s_nop 0
    v_mfma_f32_16x16x32_bf16 a[228:231], a[140:143], a[0:3], 0
    buffer_load_dwordx4 v17, s[28:31], s44 offen offset:3072 lds
    s_waitcnt lgkmcnt(0)
    v_mfma_f32_16x16x32_bf16 a[192:195], a[112:115], a[16:19], a[192:195]
    s_add_u32 m0, s50, 0
    s_mov_b32 s48, 0
    v_mfma_f32_16x16x32_bf16 a[200:203], a[112:115], a[20:23], a[200:203]
    s_waitcnt vmcnt(16)
    ds_read_b64_tr_b16 a[128:129], v2 offset:12288
    v_mfma_f32_16x16x32_bf16 a[208:211], a[112:115], a[24:27], a[208:211]
    ds_read_b64_tr_b16 a[130:131], v2 offset:14336
    ds_read_b64_tr_b16 a[132:133], v3 offset:12288
    v_mfma_f32_16x16x32_bf16 a[216:219], a[112:115], a[28:31], a[216:219]
    buffer_load_dwordx4 v28, s[12:15], s48 offen lds
    v_mfma_f32_16x16x32_bf16 a[220:223], a[116:119], a[28:31], a[220:223]
    ds_read_b64_tr_b16 a[134:135], v3 offset:14336
    ds_read_b64_tr_b16 a[136:137], v4 offset:12288
    v_mfma_f32_16x16x32_bf16 a[212:215], a[116:119], a[24:27], a[212:215]
    ds_read_b64_tr_b16 a[138:139], v4 offset:14336
    ds_read_b64_tr_b16 a[140:141], v5 offset:12288
    v_mfma_f32_16x16x32_bf16 a[204:207], a[116:119], a[20:23], a[204:207]
    ds_read_b64_tr_b16 a[142:143], v5 offset:14336
    v_max_f32 v50, v50, v51
    v_mfma_f32_16x16x32_bf16 a[196:199], a[116:119], a[16:19], a[196:199]
    buffer_load_dwordx4 v29, s[12:15], s48 offen offset:1024 lds
    v_mfma_f32_16x16x32_bf16 a[224:227], a[120:123], a[16:19], a[224:227]
    s_cmp_lg_u32 s54, 0
    s_cselect_b64 vcc, -1, 0
    v_mfma_f32_16x16x32_bf16 a[232:235], a[120:123], a[20:23], a[232:235]
    s_add_u32 m0, s50, 49152
    s_mov_b32 s48, 16384
    v_mfma_f32_16x16x32_bf16 a[240:243], a[120:123], a[24:27], a[240:243]
    s_nop 0
    v_cndmask_b32 v50, v50, v35, vcc
    v_mfma_f32_16x16x32_bf16 a[248:251], a[120:123], a[28:31], a[248:251]
    buffer_load_dwordx4 v26, s[8:11], s48 offen lds
    v_mfma_f32_16x16x32_bf16 a[252:255], a[124:127], a[28:31], a[252:255]
    v_sub_f32 v236, 0, v50
    v_sub_f32 v237, 0, v50
    v_mfma_f32_16x16x32_bf16 a[244:247], a[124:127], a[24:27], a[244:247]
    v_sub_f32 v238, 0, v50
    v_sub_f32 v239, 0, v50
    v_mfma_f32_16x16x32_bf16 a[236:239], a[124:127], a[20:23], a[236:239]
    v_sub_f32 v184, v184, v50
    v_sub_f32 v185, v185, v50
    v_mfma_f32_16x16x32_bf16 a[228:231], a[124:127], a[16:19], a[228:231]
    buffer_load_dwordx4 v27, s[8:11], s48 offen offset:1024 lds
    s_waitcnt lgkmcnt(0)
    v_mfma_f32_16x16x32_bf16 a[192:195], a[128:131], a[32:35], a[192:195]
    s_add_u32 m0, s50, 8192
    s_mov_b32 s48, 8192
    v_mfma_f32_16x16x32_bf16 a[200:203], a[128:131], a[36:39], a[200:203]
    s_waitcnt vmcnt(16)
    ds_read_b64_tr_b16 a[112:113], v2 offset:16384
    v_mfma_f32_16x16x32_bf16 a[208:211], a[128:131], a[40:43], a[208:211]
    ds_read_b64_tr_b16 a[114:115], v2 offset:18432
    ds_read_b64_tr_b16 a[116:117], v3 offset:16384
    v_mfma_f32_16x16x32_bf16 a[216:219], a[128:131], a[44:47], a[216:219]
    buffer_load_dwordx4 v28, s[12:15], s48 offen lds
    v_mfma_f32_16x16x32_bf16 a[220:223], a[132:135], a[44:47], a[220:223]
    ds_read_b64_tr_b16 a[118:119], v3 offset:18432
    ds_read_b64_tr_b16 a[120:121], v4 offset:16384
    v_mfma_f32_16x16x32_bf16 a[212:215], a[132:135], a[40:43], a[212:215]
    ds_read_b64_tr_b16 a[122:123], v4 offset:18432
    ds_read_b64_tr_b16 a[124:125], v5 offset:16384
    v_mfma_f32_16x16x32_bf16 a[204:207], a[132:135], a[36:39], a[204:207]
    ds_read_b64_tr_b16 a[126:127], v5 offset:18432
    v_sub_f32 v186, v186, v50
    v_mfma_f32_16x16x32_bf16 a[196:199], a[132:135], a[32:35], a[196:199]
    buffer_load_dwordx4 v29, s[12:15], s48 offen offset:1024 lds
    v_mfma_f32_16x16x32_bf16 a[224:227], a[136:139], a[32:35], a[224:227]
    v_sub_f32 v187, v187, v50
    v_sub_f32 v188, v188, v50
    v_mfma_f32_16x16x32_bf16 a[232:235], a[136:139], a[36:39], a[232:235]
    s_add_u32 m0, s50, 57344
    s_mov_b32 s48, 24576
    v_mfma_f32_16x16x32_bf16 a[240:243], a[136:139], a[40:43], a[240:243]
    v_sub_f32 v189, v189, v50
    v_sub_f32 v190, v190, v50
    v_mfma_f32_16x16x32_bf16 a[248:251], a[136:139], a[44:47], a[248:251]
    buffer_load_dwordx4 v26, s[8:11], s48 offen lds
    v_mfma_f32_16x16x32_bf16 a[252:255], a[140:143], a[44:47], a[252:255]
    v_sub_f32 v191, v191, v50
    v_mfma_f32_16x16x32_bf16 a[244:247], a[140:143], a[40:43], a[244:247]
    v_exp_f32 v160, v160
    v_mfma_f32_16x16x32_bf16 a[236:239], a[140:143], a[36:39], a[236:239]
    v_exp_f32 v161, v161
    v_mfma_f32_16x16x32_bf16 a[228:231], a[140:143], a[32:35], a[228:231]
    buffer_load_dwordx4 v27, s[8:11], s48 offen offset:1024 lds
    buffer_store_dwordx4 v[40:43], v30, s[36:39], s17 offen sc1
    s_waitcnt lgkmcnt(0)
    v_mfma_f32_16x16x32_bf16 a[192:195], a[112:115], a[48:51], a[192:195]
    s_add_u32 m0, s50, 16384
    s_mov_b32 s48, 16384
    v_mfma_f32_16x16x32_bf16 a[200:203], a[112:115], a[52:55], a[200:203]
    s_waitcnt vmcnt(17)
    v_mfma_f32_16x16x32_bf16 a[208:211], a[112:115], a[56:59], a[208:211]
    ds_read_b64_tr_b16 a[128:129], v2 offset:20480
    v_mfma_f32_16x16x32_bf16 a[216:219], a[112:115], a[60:63], a[216:219]
    buffer_load_dwordx4 v28, s[12:15], s48 offen lds
    v_mfma_f32_16x16x32_bf16 a[220:223], a[116:119], a[60:63], a[220:223]
    ds_read_b64_tr_b16 a[130:131], v2 offset:22528
    v_mfma_f32_16x16x32_bf16 a[212:215], a[116:119], a[56:59], a[212:215]
    ds_read_b64_tr_b16 a[132:133], v3 offset:20480
    v_mfma_f32_16x16x32_bf16 a[204:207], a[116:119], a[52:55], a[204:207]
    ds_read_b64_tr_b16 a[134:135], v3 offset:22528
    v_mfma_f32_16x16x32_bf16 a[196:199], a[116:119], a[48:51], a[196:199]
    buffer_load_dwordx4 v29, s[12:15], s48 offen offset:1024 lds
    v_mfma_f32_16x16x32_bf16 a[224:227], a[120:123], a[48:51], a[224:227]
    ds_read_b64_tr_b16 a[136:137], v4 offset:20480
    v_mfma_f32_16x16x32_bf16 a[232:235], a[120:123], a[52:55], a[232:235]
    ds_read_b64_tr_b16 a[138:139], v4 offset:22528
    v_mfma_f32_16x16x32_bf16 a[240:243], a[120:123], a[56:59], a[240:243]
    ds_read_b64_tr_b16 a[140:141], v5 offset:20480
    v_mfma_f32_16x16x32_bf16 a[248:251], a[120:123], a[60:63], a[248:251]
    ds_read_b64_tr_b16 a[142:143], v5 offset:22528
    v_mfma_f32_16x16x32_bf16 a[252:255], a[124:127], a[60:63], a[252:255]
    v_exp_f32 v162, v162
    v_mfma_f32_16x16x32_bf16 a[244:247], a[124:127], a[56:59], a[244:247]
    v_cvt_pk_bf16_f32 v56, v160, v161
    v_mfma_f32_16x16x32_bf16 a[236:239], a[124:127], a[52:55], a[236:239]
    v_exp_f32 v163, v163
    v_mfma_f32_16x16x32_bf16 a[228:231], a[124:127], a[48:51], a[228:231]
    buffer_store_dwordx4 v[40:43], v30, s[36:39], s18 offen sc1
    s_waitcnt lgkmcnt(0)
    v_mfma_f32_16x16x32_bf16 a[192:195], a[128:131], a[64:67], a[192:195]
    s_waitcnt vmcnt(16)
    v_mfma_f32_16x16x32_bf16 a[200:203], a[128:131], a[68:71], a[200:203]
    ds_read_b64_tr_b16 a[112:113], v2 offset:0
    v_mfma_f32_16x16x32_bf16 a[208:211], a[128:131], a[72:75], a[208:211]
    ds_read_b64_tr_b16 a[114:115], v2 offset:2048
    v_mfma_f32_16x16x32_bf16 a[216:219], a[128:131], a[76:79], a[216:219]
    ds_read_b64_tr_b16 a[116:117], v3 offset:0
    v_mfma_f32_16x16x32_bf16 a[220:223], a[132:135], a[76:79], a[220:223]
    ds_read_b64_tr_b16 a[118:119], v3 offset:2048
    v_mfma_f32_16x16x32_bf16 a[212:215], a[132:135], a[72:75], a[212:215]
    ds_read_b64_tr_b16 a[120:121], v4 offset:0
    v_mfma_f32_16x16x32_bf16 a[204:207], a[132:135], a[68:71], a[204:207]
    ds_read_b64_tr_b16 a[122:123], v4 offset:2048
    v_mfma_f32_16x16x32_bf16 a[196:199], a[132:135], a[64:67], a[196:199]
    ds_read_b64_tr_b16 a[124:125], v5 offset:0
    v_mfma_f32_16x16x32_bf16 a[224:227], a[136:139], a[64:67], a[224:227]
    ds_read_b64_tr_b16 a[126:127], v5 offset:2048
    v_mfma_f32_16x16x32_bf16 a[232:235], a[136:139], a[68:71], a[232:235]
    v_exp_f32 v164, v164
    v_mfma_f32_16x16x32_bf16 a[240:243], a[136:139], a[72:75], a[240:243]
    v_cvt_pk_bf16_f32 v57, v162, v163
    v_mfma_f32_16x16x32_bf16 a[248:251], a[136:139], a[76:79], a[248:251]
    v_exp_f32 v165, v165
    v_mfma_f32_16x16x32_bf16 a[252:255], a[140:143], a[76:79], a[252:255]
    v_exp_f32 v166, v166
    v_mfma_f32_16x16x32_bf16 a[244:247], a[140:143], a[72:75], a[244:247]
    v_cvt_pk_bf16_f32 v58, v164, v165
    v_mfma_f32_16x16x32_bf16 a[236:239], a[140:143], a[68:71], a[236:239]
    v_exp_f32 v167, v167
    v_mfma_f32_16x16x32_bf16 a[228:231], a[140:143], a[64:67], a[228:231]
    buffer_store_dwordx4 v[40:43], v30, s[36:39], s19 offen sc1
    s_waitcnt lgkmcnt(0)
    v_mfma_f32_16x16x32_bf16 a[192:195], a[112:115], a[80:83], a[192:195]
    s_waitcnt vmcnt(13)
    v_mfma_f32_16x16x32_bf16 a[200:203], a[112:115], a[84:87], a[200:203]
    ds_read_b64_tr_b16 a[128:129], v2 offset:4096
    v_mfma_f32_16x16x32_bf16 a[208:211], a[112:115], a[88:91], a[208:211]
    ds_read_b64_tr_b16 a[130:131], v2 offset:6144
    v_mfma_f32_16x16x32_bf16 a[216:219], a[112:115], a[92:95], a[216:219]
    ds_read_b64_tr_b16 a[132:133], v3 offset:4096
    v_mfma_f32_16x16x32_bf16 a[220:223], a[116:119], a[92:95], a[220:223]
    ds_read_b64_tr_b16 a[134:135], v3 offset:6144
    v_mfma_f32_16x16x32_bf16 a[212:215], a[116:119], a[88:91], a[212:215]
    ds_read_b64_tr_b16 a[136:137], v4 offset:4096
    v_mfma_f32_16x16x32_bf16 a[204:207], a[116:119], a[84:87], a[204:207]
    ds_read_b64_tr_b16 a[138:139], v4 offset:6144
    v_mfma_f32_16x16x32_bf16 a[196:199], a[116:119], a[80:83], a[196:199]
    ds_read_b64_tr_b16 a[140:141], v5 offset:4096
    v_mfma_f32_16x16x32_bf16 a[224:227], a[120:123], a[80:83], a[224:227]
    ds_read_b64_tr_b16 a[142:143], v5 offset:6144
    v_mfma_f32_16x16x32_bf16 a[232:235], a[120:123], a[84:87], a[232:235]
    v_exp_f32 v168, v168
    v_mfma_f32_16x16x32_bf16 a[240:243], a[120:123], a[88:91], a[240:243]
    v_cvt_pk_bf16_f32 v59, v166, v167
    v_mfma_f32_16x16x32_bf16 a[248:251], a[120:123], a[92:95], a[248:251]
    v_exp_f32 v169, v169
    v_mfma_f32_16x16x32_bf16 a[252:255], a[124:127], a[92:95], a[252:255]
    v_exp_f32 v170, v170
    v_mfma_f32_16x16x32_bf16 a[244:247], a[124:127], a[88:91], a[244:247]
    v_cvt_pk_bf16_f32 v60, v168, v169
    v_mfma_f32_16x16x32_bf16 a[236:239], a[124:127], a[84:87], a[236:239]
    v_exp_f32 v171, v171
    v_mfma_f32_16x16x32_bf16 a[228:231], a[124:127], a[80:83], a[228:231]
    buffer_store_dwordx4 v[40:43], v30, s[36:39], s24 offen sc1
L_pg4:
    s_cbranch_execz L_pg8
    s_waitcnt lgkmcnt(0)
    v_mfma_f32_16x16x32_bf16 a[192:195], a[128:131], a[96:99], a[192:195]
    v_exp_f32 v172, v172
    v_mfma_f32_16x16x32_bf16 a[200:203], a[128:131], a[100:103], a[200:203]
    v_cvt_pk_bf16_f32 v61, v170, v171
    v_mfma_f32_16x16x32_bf16 a[208:211], a[128:131], a[104:107], a[208:211]
    v_exp_f32 v173, v173
    v_mfma_f32_16x16x32_bf16 a[216:219], a[128:131], a[108:111], a[216:219]
    v_exp_f32 v174, v174
    v_mfma_f32_16x16x32_bf16 a[220:223], a[132:135], a[108:111], a[220:223]
    v_cvt_pk_bf16_f32 v62, v172, v173
    v_mfma_f32_16x16x32_bf16 a[212:215], a[132:135], a[104:107], a[212:215]
    v_exp_f32 v175, v175
    v_mfma_f32_16x16x32_bf16 a[204:207], a[132:135], a[100:103], a[204:207]
    s_nop 0
    v_cvt_pk_bf16_f32 v63, v174, v175
    v_mfma_f32_16x16x32_bf16 a[196:199], a[132:135], a[96:99], a[196:199]
    v_cvt_pk_bf16_f32 v128, v128, v129
    v_cvt_pk_bf16_f32 v129, v130, v131
    v_mfma_f32_16x16x32_bf16 a[224:227], a[136:139], a[96:99], a[224:227]
    v_cvt_pk_bf16_f32 v130, v132, v133
    v_cvt_pk_bf16_f32 v131, v134, v135
    v_mfma_f32_16x16x32_bf16 a[232:235], a[136:139], a[100:103], a[232:235]
    v_cvt_pk_bf16_f32 v132, v136, v137
    v_cvt_pk_bf16_f32 v133, v138, v139
    v_mfma_f32_16x16x32_bf16 a[240:243], a[136:139], a[104:107], a[240:243]
    v_cvt_pk_bf16_f32 v134, v140, v141
    v_cvt_pk_bf16_f32 v135, v142, v143
    v_mfma_f32_16x16x32_bf16 a[248:251], a[136:139], a[108:111], a[248:251]
    v_cvt_pk_bf16_f32 v136, v144, v145
    v_cvt_pk_bf16_f32 v137, v146, v147
    v_mfma_f32_16x16x32_bf16 a[252:255], a[140:143], a[108:111], a[252:255]
    v_cvt_pk_bf16_f32 v138, v148, v149
    v_cvt_pk_bf16_f32 v139, v150, v151
    v_mfma_f32_16x16x32_bf16 a[244:247], a[140:143], a[104:107], a[244:247]
    v_cvt_pk_bf16_f32 v140, v152, v153
    v_cvt_pk_bf16_f32 v141, v154, v155
    v_mfma_f32_16x16x32_bf16 a[236:239], a[140:143], a[100:103], a[236:239]
    v_cvt_pk_bf16_f32 v142, v156, v157
    v_cvt_pk_bf16_f32 v143, v158, v159
    v_mfma_f32_16x16x32_bf16 a[228:231], a[140:143], a[96:99], a[228:231]
    buffer_store_dwordx4 v[40:43], v30, s[36:39], s25 offen sc1
    v_cvt_pk_bf16_f32 v144, v192, v193
    v_cvt_pk_bf16_f32 v145, v194, v195
    v_cvt_pk_bf16_f32 v146, v196, v197
    v_cvt_pk_bf16_f32 v147, v198, v199
    v_cvt_pk_bf16_f32 v148, v200, v201
    v_cvt_pk_bf16_f32 v149, v202, v203
    v_cvt_pk_bf16_f32 v150, v204, v205
    v_cvt_pk_bf16_f32 v151, v206, v207
    v_cvt_pk_bf16_f32 v152, v208, v209
    v_cvt_pk_bf16_f32 v153, v210, v211
    v_cvt_pk_bf16_f32 v154, v212, v213
    v_cvt_pk_bf16_f32 v155, v214, v215
    v_cvt_pk_bf16_f32 v156, v216, v217
    v_cvt_pk_bf16_f32 v157, v218, v219
    v_cvt_pk_bf16_f32 v158, v220, v221
    v_cvt_pk_bf16_f32 v159, v222, v223
    s_waitcnt vmcnt(11)
    s_waitcnt lgkmcnt(0)
    s_barrier
    v_mfma_f32_16x16x32_bf16 v[160:163], a[160:163], v[64:67], v[224:227]
    v_exp_f32 v176, v176
    v_mfma_f32_16x16x32_bf16 v[168:171], a[160:163], v[68:71], v[228:231]
    v_exp_f32 v177, v177
    v_mfma_f32_16x16x32_bf16 v[164:167], a[164:167], v[64:67], v[224:227]
    ds_read_b64_tr_b16 a[128:129], v22 offset:0
    ds_read_b64_tr_b16 a[130:131], v22 offset:2048
    v_mfma_f32_16x16x32_bf16 v[172:175], a[164:167], v[68:71], v[228:231]
    v_exp_f32 v178, v178
    v_mfma_f32_16x16x32_bf16 v[160:163], a[168:171], v[80:83], v[160:163]
    ds_read_b64_tr_b16 a[132:133], v23 offset:0
    v_cvt_pk_bf16_f32 v216, v176, v177
    v_mfma_f32_16x16x32_bf16 v[168:171], a[168:171], v[84:87], v[168:171]
    v_exp_f32 v179, v179
    v_mfma_f32_16x16x32_bf16 v[164:167], a[172:175], v[80:83], v[164:167]
    ds_read_b64_tr_b16 a[134:135], v23 offset:2048
    ds_read_b64_tr_b16 a[136:137], v24 offset:0
    v_mfma_f32_16x16x32_bf16 v[172:175], a[172:175], v[84:87], v[172:175]
    v_exp_f32 v180, v180
    v_mfma_f32_16x16x32_bf16 v[160:163], a[176:179], v[96:99], v[160:163]
    ds_read_b64_tr_b16 a[138:139], v24 offset:2048
    v_cvt_pk_bf16_f32 v217, v178, v179
    v_mfma_f32_16x16x32_bf16 v[168:171], a[176:179], v[100:103], v[168:171]
    v_exp_f32 v181, v181
    v_mfma_f32_16x16x32_bf16 v[164:167], a[180:183], v[96:99], v[164:167]
    ds_read_b64_tr_b16 a[140:141], v25 offset:0
    ds_read_b64_tr_b16 a[142:143], v25 offset:2048
    v_mfma_f32_16x16x32_bf16 v[172:175], a[180:183], v[100:103], v[172:175]
    v_exp_f32 v182, v182
    v_mfma_f32_16x16x32_bf16 v[160:163], a[184:187], v[112:115], v[160:163]
    ds_read_b64_tr_b16 a[144:145], v22 offset:4096
    v_cvt_pk_bf16_f32 v218, v180, v181
    v_mfma_f32_16x16x32_bf16 v[168:171], a[184:187], v[116:119], v[168:171]
    v_exp_f32 v183, v183
    v_mfma_f32_16x16x32_bf16 v[164:167], a[188:191], v[112:115], v[164:167]
    ds_read_b64_tr_b16 a[146:147], v22 offset:6144
    ds_read_b64_tr_b16 a[148:149], v23 offset:4096
    v_mfma_f32_16x16x32_bf16 v[172:175], a[188:191], v[116:119], v[172:175]
    v_exp_f32 v184, v184
    v_mfma_f32_16x16x32_bf16 v[192:195], a[160:163], v[72:75], v[232:235]
    ds_read_b64_tr_b16 a[150:151], v23 offset:6144
    v_cvt_pk_bf16_f32 v219, v182, v183
    v_mfma_f32_16x16x32_bf16 v[200:203], a[160:163], v[76:79], v[236:239]
    v_exp_f32 v185, v185
    v_mfma_f32_16x16x32_bf16 v[196:199], a[164:167], v[72:75], v[232:235]
    ds_read_b64_tr_b16 a[152:153], v24 offset:4096
    ds_read_b64_tr_b16 a[154:155], v24 offset:6144
    v_mfma_f32_16x16x32_bf16 v[204:207], a[164:167], v[76:79], v[236:239]
    v_exp_f32 v186, v186
    v_mfma_f32_16x16x32_bf16 v[192:195], a[168:171], v[88:91], v[192:195]
    ds_read_b64_tr_b16 a[156:157], v25 offset:4096
    v_cvt_pk_bf16_f32 v220, v184, v185
    v_mfma_f32_16x16x32_bf16 v[200:203], a[168:171], v[92:95], v[200:203]
    v_exp_f32 v187, v187
    v_mfma_f32_16x16x32_bf16 v[196:199], a[172:175], v[88:91], v[196:199]
    ds_read_b64_tr_b16 a[158:159], v25 offset:6144
    s_add_u32 m0, s50, 32768
    v_mfma_f32_16x16x32_bf16 v[204:207], a[172:175], v[92:95], v[204:207]
    v_exp_f32 v188, v188
    v_mfma_f32_16x16x32_bf16 v[192:195], a[176:179], v[104:107], v[192:195]
    s_mov_b32 s48, 32768
    v_cvt_pk_bf16_f32 v221, v186, v187
    v_mfma_f32_16x16x32_bf16 v[200:203], a[176:179], v[108:111], v[200:203]
    v_exp_f32 v189, v189
    v_mfma_f32_16x16x32_bf16 v[196:199], a[180:183], v[104:107], v[196:199]
    buffer_load_dwordx4 v26, s[8:11], s48 offen lds
    v_mfma_f32_16x16x32_bf16 v[204:207], a[180:183], v[108:111], v[204:207]
    v_exp_f32 v190, v190
    v_mfma_f32_16x16x32_bf16 v[192:195], a[184:187], v[120:123], v[192:195]
    buffer_load_dwordx4 v27, s[8:11], s48 offen offset:1024 lds
    v_cvt_pk_bf16_f32 v222, v188, v189
    v_mfma_f32_16x16x32_bf16 v[200:203], a[184:187], v[124:127], v[200:203]
    v_exp_f32 v191, v191
    v_mfma_f32_16x16x32_bf16 v[196:199], a[188:191], v[120:123], v[196:199]
    v_lshlrev_b32 v50, 6, v0
    v_mov_b32 v51, 0
    v_mfma_f32_16x16x32_bf16 v[204:207], a[188:191], v[124:127], v[204:207]
    v_cvt_pk_bf16_f32 v223, v190, v191
    v_mov_b32 v53, 1
    v_mfma_f32_16x16x32_bf16 v[44:47], v[36:39], v[56:59], 0
    v_accvgpr_read_b32 v240, a192
    v_accvgpr_read_b32 v241, a193
    v_mfma_f32_16x16x32_bf16 v[248:251], v[36:39], v[60:63], 0
    s_waitcnt lgkmcnt(0)
    v_exp_f32 v160, v160
    v_mfma_f32_16x16x32_bf16 a[0:3], a[128:131], v[56:59], 0
    ds_read_b128 a[160:163], v18 offset:16384
    ds_read_b128 a[164:167], v18 offset:20480
    v_mfma_f32_16x16x32_bf16 a[8:11], a[128:131], v[60:63], 0
    v_exp_f32 v161, v161
    v_mfma_f32_16x16x32_bf16 a[4:7], a[132:135], v[56:59], 0
    ds_read_b128 a[168:171], v19 offset:16384
    ds_read_b128 a[172:175], v19 offset:20480
    v_mfma_f32_16x16x32_bf16 a[12:15], a[132:135], v[60:63], 0
    v_exp_f32 v162, v162
    v_mfma_f32_16x16x32_bf16 a[16:19], a[136:139], v[56:59], 0
    ds_read_b128 a[176:179], v20 offset:16384
    v_cvt_pk_bf16_f32 v208, v160, v161
    v_mfma_f32_16x16x32_bf16 a[24:27], a[136:139], v[60:63], 0
    v_exp_f32 v163, v163
    v_mfma_f32_16x16x32_bf16 a[20:23], a[140:143], v[56:59], 0
    ds_read_b128 a[180:183], v20 offset:20480
    ds_read_b128 a[184:187], v21 offset:16384
    v_mfma_f32_16x16x32_bf16 a[28:31], a[140:143], v[60:63], 0
    v_exp_f32 v164, v164
    v_mfma_f32_16x16x32_bf16 a[32:35], a[144:147], v[56:59], 0
    ds_read_b128 a[188:191], v21 offset:20480
    v_cvt_pk_bf16_f32 v209, v162, v163
    v_mfma_f32_16x16x32_bf16 a[40:43], a[144:147], v[60:63], 0
    v_exp_f32 v165, v165
    v_mfma_f32_16x16x32_bf16 a[36:39], a[148:151], v[56:59], 0
    buffer_store_dwordx4 v[128:131], v12, s[36:39], s16 offen sc1
    v_mfma_f32_16x16x32_bf16 a[44:47], a[148:151], v[60:63], 0
    v_exp_f32 v166, v166
    v_mfma_f32_16x16x32_bf16 a[48:51], a[152:155], v[56:59], 0
    s_add_u32 m0, s50, 24576
    s_mov_b32 s48, 24576
    v_cvt_pk_bf16_f32 v210, v164, v165
    v_mfma_f32_16x16x32_bf16 a[56:59], a[152:155], v[60:63], 0
    v_exp_f32 v167, v167
    v_mfma_f32_16x16x32_bf16 a[52:55], a[156:159], v[56:59], 0
    buffer_load_dwordx4 v28, s[12:15], s48 offen lds
    v_mfma_f32_16x16x32_bf16 a[60:63], a[156:159], v[60:63], 0
    v_exp_f32 v168, v168
    v_mfma_f32_16x16x32_bf16 v[252:255], v[36:39], v[216:219], 0
    v_cvt_pk_bf16_f32 v211, v166, v167
    v_accvgpr_read_b32 v242, a194
    v_mfma_f32_16x16x32_bf16 v[32:35], v[36:39], v[220:223], 0
    v_exp_f32 v169, v169
    v_mfma_f32_16x16x32_bf16 a[64:67], a[128:131], v[216:219], 0
    buffer_load_dwordx4 v29, s[12:15], s48 offen offset:1024 lds
    v_mfma_f32_16x16x32_bf16 a[72:75], a[128:131], v[220:223], 0
    v_exp_f32 v170, v170
    v_mfma_f32_16x16x32_bf16 a[68:71], a[132:135], v[216:219], 0
    s_add_u32 m0, s50, 40960
    s_mov_b32 s48, 40960
    v_cvt_pk_bf16_f32 v212, v168, v169
    v_mfma_f32_16x16x32_bf16 a[76:79], a[132:135], v[220:223], 0
    v_exp_f32 v171, v171
    v_mfma_f32_16x16x32_bf16 a[80:83], a[136:139], v[216:219], 0
    buffer_load_dwordx4 v26, s[8:11], s48 offen lds
    v_mfma_f32_16x16x32_bf16 a[88:91], a[136:139], v[220:223], 0
    v_exp_f32 v172, v172
    v_mfma_f32_16x16x32_bf16 a[84:87], a[140:143], v[216:219], 0
    v_cvt_pk_bf16_f32 v213, v170, v171
    v_accvgpr_read_b32 v243, a195
    v_mfma_f32_16x16x32_bf16 a[92:95], a[140:143], v[220:223], 0
    v_exp_f32 v173, v173
    v_mfma_f32_16x16x32_bf16 a[96:99], a[144:147], v[216:219], 0
    buffer_load_dwordx4 v27, s[8:11], s48 offen offset:1024 lds
    v_mfma_f32_16x16x32_bf16 a[104:107], a[144:147], v[220:223], 0
    v_exp_f32 v174, v174
    v_mfma_f32_16x16x32_bf16 a[100:103], a[148:151], v[216:219], 0
    v_cvt_pk_bf16_f32 v214, v172, v173
    v_accvgpr_read_b32 v244, a196
    v_mfma_f32_16x16x32_bf16 a[108:111], a[148:151], v[220:223], 0
    v_exp_f32 v175, v175
    v_mfma_f32_16x16x32_bf16 a[112:115], a[152:155], v[216:219], 0
    s_waitcnt vmcnt(14) lgkmcnt(0)
    v_accvgpr_read_b32 v245, a197
    v_mfma_f32_16x16x32_bf16 a[120:123], a[152:155], v[220:223], 0
    s_barrier
    v_accvgpr_read_b32 v246, a198
    v_mfma_f32_16x16x32_bf16 a[116:119], a[156:159], v[216:219], 0
    v_cvt_pk_bf16_f32 v215, v174, v175
    v_accvgpr_read_b32 v247, a199
    v_cvt_pk_bf16_f32 v240, v240, v241
    v_cvt_pk_bf16_f32 v241, v242, v243
    v_cvt_pk_bf16_f32 v242, v244, v245
    v_cvt_pk_bf16_f32 v243, v246, v247
    v_mfma_f32_16x16x32_bf16 a[124:127], a[156:159], v[220:223], 0
    buffer_store_dwordx4 v[240:243], v13, s[36:39], s16 offen sc1
    v_mfma_f32_16x16x32_bf16 v[160:163], a[160:163], v[64:67], v[224:227]
    v_exp_f32 v192, v192
    v_mfma_f32_16x16x32_bf16 v[168:171], a[160:163], v[68:71], v[228:231]
    v_exp_f32 v193, v193
    v_mfma_f32_16x16x32_bf16 v[164:167], a[164:167], v[64:67], v[224:227]
    ds_read_b64_tr_b16 a[128:129], v22 offset:8192
    ds_read_b64_tr_b16 a[130:131], v22 offset:10240
    v_mfma_f32_16x16x32_bf16 v[172:175], a[164:167], v[68:71], v[228:231]
    v_exp_f32 v194, v194
    v_mfma_f32_16x16x32_bf16 v[160:163], a[168:171], v[80:83], v[160:163]
    ds_read_b64_tr_b16 a[132:133], v23 offset:8192
    v_cvt_pk_bf16_f32 v216, v192, v193
    v_mfma_f32_16x16x32_bf16 v[168:171], a[168:171], v[84:87], v[168:171]
    v_exp_f32 v195, v195
    v_mfma_f32_16x16x32_bf16 v[164:167], a[172:175], v[80:83], v[164:167]
    ds_read_b64_tr_b16 a[134:135], v23 offset:10240
    ds_read_b64_tr_b16 a[136:137], v24 offset:8192
    v_mfma_f32_16x16x32_bf16 v[172:175], a[172:175], v[84:87], v[172:175]
    v_exp_f32 v196, v196
    v_mfma_f32_16x16x32_bf16 v[160:163], a[176:179], v[96:99], v[160:163]
    ds_read_b64_tr_b16 a[138:139], v24 offset:10240
    v_cvt_pk_bf16_f32 v217, v194, v195
    v_mfma_f32_16x16x32_bf16 v[168:171], a[176:179], v[100:103], v[168:171]
    v_exp_f32 v197, v197
    v_mfma_f32_16x16x32_bf16 v[164:167], a[180:183], v[96:99], v[164:167]
    ds_read_b64_tr_b16 a[140:141], v25 offset:8192
    ds_read_b64_tr_b16 a[142:143], v25 offset:10240
    v_mfma_f32_16x16x32_bf16 v[172:175], a[180:183], v[100:103], v[172:175]
    v_exp_f32 v198, v198
    v_mfma_f32_16x16x32_bf16 v[160:163], a[184:187], v[112:115], v[160:163]
    ds_read_b64_tr_b16 a[144:145], v22 offset:12288
    v_cvt_pk_bf16_f32 v218, v196, v197
    v_mfma_f32_16x16x32_bf16 v[168:171], a[184:187], v[116:119], v[168:171]
    v_exp_f32 v199, v199
    v_mfma_f32_16x16x32_bf16 v[164:167], a[188:191], v[112:115], v[164:167]
    ds_read_b64_tr_b16 a[146:147], v22 offset:14336
    ds_read_b64_tr_b16 a[148:149], v23 offset:12288
    v_mfma_f32_16x16x32_bf16 v[172:175], a[188:191], v[116:119], v[172:175]
    v_exp_f32 v200, v200
    v_mfma_f32_16x16x32_bf16 v[176:179], a[160:163], v[72:75], v[232:235]
    ds_read_b64_tr_b16 a[150:151], v23 offset:14336
    v_cvt_pk_bf16_f32 v219, v198, v199
    v_mfma_f32_16x16x32_bf16 v[184:187], a[160:163], v[76:79], v[236:239]
    v_exp_f32 v201, v201
    v_mfma_f32_16x16x32_bf16 v[180:183], a[164:167], v[72:75], v[232:235]
    ds_read_b64_tr_b16 a[152:153], v24 offset:12288
    ds_read_b64_tr_b16 a[154:155], v24 offset:14336
    v_mfma_f32_16x16x32_bf16 v[188:191], a[164:167], v[76:79], v[236:239]
    v_exp_f32 v202, v202
    v_mfma_f32_16x16x32_bf16 v[176:179], a[168:171], v[88:91], v[176:179]
    ds_read_b64_tr_b16 a[156:157], v25 offset:12288
    v_cvt_pk_bf16_f32 v220, v200, v201
    v_mfma_f32_16x16x32_bf16 v[184:187], a[168:171], v[92:95], v[184:187]
    v_exp_f32 v203, v203
    v_mfma_f32_16x16x32_bf16 v[180:183], a[172:175], v[88:91], v[180:183]
    ds_read_b64_tr_b16 a[158:159], v25 offset:14336
    v_accvgpr_read_b32 v240, a200
    v_mfma_f32_16x16x32_bf16 v[188:191], a[172:175], v[92:95], v[188:191]
    v_exp_f32 v204, v204
    v_mfma_f32_16x16x32_bf16 v[176:179], a[176:179], v[104:107], v[176:179]
    v_cvt_pk_bf16_f32 v221, v202, v203
    v_accvgpr_read_b32 v241, a201
    v_mfma_f32_16x16x32_bf16 v[184:187], a[176:179], v[108:111], v[184:187]
    v_exp_f32 v205, v205
    v_mfma_f32_16x16x32_bf16 v[180:183], a[180:183], v[104:107], v[180:183]
    buffer_store_dwordx4 v[40:43], v30, s[36:39], s26 offen sc1
    v_mfma_f32_16x16x32_bf16 v[188:191], a[180:183], v[108:111], v[188:191]
    v_exp_f32 v206, v206
    v_mfma_f32_16x16x32_bf16 v[176:179], a[184:187], v[120:123], v[176:179]
    v_cvt_pk_bf16_f32 v222, v204, v205
    v_accvgpr_read_b32 v242, a202
    v_mfma_f32_16x16x32_bf16 v[184:187], a[184:187], v[124:127], v[184:187]
    v_exp_f32 v207, v207
    v_mfma_f32_16x16x32_bf16 v[180:183], a[188:191], v[120:123], v[180:183]
    v_accvgpr_read_b32 v243, a203
    v_accvgpr_read_b32 v244, a204
    v_mfma_f32_16x16x32_bf16 v[188:191], a[188:191], v[124:127], v[188:191]
    v_cvt_pk_bf16_f32 v223, v206, v207
    v_accvgpr_read_b32 v245, a205
    v_mfma_f32_16x16x32_bf16 v[44:47], v[36:39], v[208:211], v[44:47]
    v_accvgpr_read_b32 v246, a206
    v_accvgpr_read_b32 v247, a207
    v_mfma_f32_16x16x32_bf16 v[248:251], v[36:39], v[212:215], v[248:251]
    s_waitcnt lgkmcnt(0)
    v_exp_f32 v160, v160
    v_mfma_f32_16x16x32_bf16 a[0:3], a[128:131], v[208:211], a[0:3]
    ds_read_b128 a[160:163], v18 offset:24576
    ds_read_b128 a[164:167], v18 offset:28672
    v_mfma_f32_16x16x32_bf16 a[8:11], a[128:131], v[212:215], a[8:11]
    v_exp_f32 v161, v161
    v_mfma_f32_16x16x32_bf16 a[4:7], a[132:135], v[208:211], a[4:7]
    ds_read_b128 a[168:171], v19 offset:24576
    ds_read_b128 a[172:175], v19 offset:28672
    v_mfma_f32_16x16x32_bf16 a[12:15], a[132:135], v[212:215], a[12:15]
    v_exp_f32 v162, v162
    v_mfma_f32_16x16x32_bf16 a[16:19], a[136:139], v[208:211], a[16:19]
    ds_read_b128 a[176:179], v20 offset:24576
    v_cvt_pk_bf16_f32 v56, v160, v161
    v_mfma_f32_16x16x32_bf16 a[24:27], a[136:139], v[212:215], a[24:27]
    v_exp_f32 v163, v163
    v_mfma_f32_16x16x32_bf16 a[20:23], a[140:143], v[208:211], a[20:23]
    ds_read_b128 a[180:183], v20 offset:28672
    ds_read_b128 a[184:187], v21 offset:24576
    v_mfma_f32_16x16x32_bf16 a[28:31], a[140:143], v[212:215], a[28:31]
    v_exp_f32 v164, v164
    v_mfma_f32_16x16x32_bf16 a[32:35], a[144:147], v[208:211], a[32:35]
    ds_read_b128 a[188:191], v21 offset:28672
    v_cvt_pk_bf16_f32 v57, v162, v163
    v_mfma_f32_16x16x32_bf16 a[40:43], a[144:147], v[212:215], a[40:43]
    v_exp_f32 v165, v165
    v_mfma_f32_16x16x32_bf16 a[36:39], a[148:151], v[208:211], a[36:39]
    buffer_store_dwordx4 v[132:135], v12, s[36:39], s17 offen sc1
    v_mfma_f32_16x16x32_bf16 a[44:47], a[148:151], v[212:215], a[44:47]
    v_exp_f32 v166, v166
    v_mfma_f32_16x16x32_bf16 a[48:51], a[152:155], v[208:211], a[48:51]
    s_add_u32 m0, s50, 0
    s_mov_b32 s48, 32768
    v_cvt_pk_bf16_f32 v58, v164, v165
    v_mfma_f32_16x16x32_bf16 a[56:59], a[152:155], v[212:215], a[56:59]
    v_exp_f32 v167, v167
    v_mfma_f32_16x16x32_bf16 a[52:55], a[156:159], v[208:211], a[52:55]
    buffer_load_dwordx4 v28, s[12:15], s48 offen lds
    v_mfma_f32_16x16x32_bf16 a[60:63], a[156:159], v[212:215], a[60:63]
    v_exp_f32 v168, v168
    v_mfma_f32_16x16x32_bf16 v[252:255], v[36:39], v[216:219], v[252:255]
    v_cvt_pk_bf16_f32 v59, v166, v167
    v_cvt_pk_bf16_f32 v240, v240, v241
    v_mfma_f32_16x16x32_bf16 v[32:35], v[36:39], v[220:223], v[32:35]
    v_exp_f32 v169, v169
    v_mfma_f32_16x16x32_bf16 a[64:67], a[128:131], v[216:219], a[64:67]
    buffer_load_dwordx4 v29, s[12:15], s48 offen offset:1024 lds
    v_mfma_f32_16x16x32_bf16 a[72:75], a[128:131], v[220:223], a[72:75]
    v_exp_f32 v170, v170
    v_mfma_f32_16x16x32_bf16 a[68:71], a[132:135], v[216:219], a[68:71]
    s_add_u32 m0, s50, 49152
    s_mov_b32 s48, 49152
    v_cvt_pk_bf16_f32 v60, v168, v169
    v_mfma_f32_16x16x32_bf16 a[76:79], a[132:135], v[220:223], a[76:79]
    v_exp_f32 v171, v171
    v_mfma_f32_16x16x32_bf16 a[80:83], a[136:139], v[216:219], a[80:83]
    buffer_load_dwordx4 v26, s[8:11], s48 offen lds
    v_mfma_f32_16x16x32_bf16 a[88:91], a[136:139], v[220:223], a[88:91]
    v_exp_f32 v172, v172
    v_mfma_f32_16x16x32_bf16 a[84:87], a[140:143], v[216:219], a[84:87]
    v_cvt_pk_bf16_f32 v61, v170, v171
    v_cvt_pk_bf16_f32 v241, v242, v243
    v_mfma_f32_16x16x32_bf16 a[92:95], a[140:143], v[220:223], a[92:95]
    v_exp_f32 v173, v173
    v_mfma_f32_16x16x32_bf16 a[96:99], a[144:147], v[216:219], a[96:99]
    buffer_load_dwordx4 v27, s[8:11], s48 offen offset:1024 lds
    v_mfma_f32_16x16x32_bf16 a[104:107], a[144:147], v[220:223], a[104:107]
    v_exp_f32 v174, v174
    v_mfma_f32_16x16x32_bf16 a[100:103], a[148:151], v[216:219], a[100:103]
    v_cvt_pk_bf16_f32 v62, v172, v173
    v_cvt_pk_bf16_f32 v242, v244, v245
    v_mfma_f32_16x16x32_bf16 a[108:111], a[148:151], v[220:223], a[108:111]
    v_exp_f32 v175, v175
    v_mfma_f32_16x16x32_bf16 a[112:115], a[152:155], v[216:219], a[112:115]
    s_waitcnt vmcnt(12) lgkmcnt(0)
    v_cvt_pk_bf16_f32 v243, v246, v247
    v_mfma_f32_16x16x32_bf16 a[120:123], a[152:155], v[220:223], a[120:123]
    s_barrier
    v_mfma_f32_16x16x32_bf16 a[116:119], a[156:159], v[216:219], a[116:119]
    v_cvt_pk_bf16_f32 v63, v174, v175
    v_mfma_f32_16x16x32_bf16 a[124:127], a[156:159], v[220:223], a[124:127]
    buffer_store_dwordx4 v[240:243], v13, s[36:39], s17 offen sc1
    v_mfma_f32_16x16x32_bf16 v[160:163], a[160:163], v[64:67], v[224:227]
    v_exp_f32 v176, v176
    v_mfma_f32_16x16x32_bf16 v[168:171], a[160:163], v[68:71], v[228:231]
    v_exp_f32 v177, v177
    v_mfma_f32_16x16x32_bf16 v[164:167], a[164:167], v[64:67], v[224:227]
    ds_read_b64_tr_b16 a[128:129], v22 offset:16384
    ds_read_b64_tr_b16 a[130:131], v22 offset:18432
    v_mfma_f32_16x16x32_bf16 v[172:175], a[164:167], v[68:71], v[228:231]
    v_exp_f32 v178, v178
    v_mfma_f32_16x16x32_bf16 v[160:163], a[168:171], v[80:83], v[160:163]
    ds_read_b64_tr_b16 a[132:133], v23 offset:16384
    v_cvt_pk_bf16_f32 v216, v176, v177
    v_mfma_f32_16x16x32_bf16 v[168:171], a[168:171], v[84:87], v[168:171]
    v_exp_f32 v179, v179
    v_mfma_f32_16x16x32_bf16 v[164:167], a[172:175], v[80:83], v[164:167]
    ds_read_b64_tr_b16 a[134:135], v23 offset:18432
    ds_read_b64_tr_b16 a[136:137], v24 offset:16384
    v_mfma_f32_16x16x32_bf16 v[172:175], a[172:175], v[84:87], v[172:175]
    v_exp_f32 v180, v180
    v_mfma_f32_16x16x32_bf16 v[160:163], a[176:179], v[96:99], v[160:163]
    ds_read_b64_tr_b16 a[138:139], v24 offset:18432
    v_cvt_pk_bf16_f32 v217, v178, v179
    v_mfma_f32_16x16x32_bf16 v[168:171], a[176:179], v[100:103], v[168:171]
    v_exp_f32 v181, v181
    v_mfma_f32_16x16x32_bf16 v[164:167], a[180:183], v[96:99], v[164:167]
    ds_read_b64_tr_b16 a[140:141], v25 offset:16384
    ds_read_b64_tr_b16 a[142:143], v25 offset:18432
    v_mfma_f32_16x16x32_bf16 v[172:175], a[180:183], v[100:103], v[172:175]
    v_exp_f32 v182, v182
    v_mfma_f32_16x16x32_bf16 v[160:163], a[184:187], v[112:115], v[160:163]
    ds_read_b64_tr_b16 a[144:145], v22 offset:20480
    v_cvt_pk_bf16_f32 v218, v180, v181
    v_mfma_f32_16x16x32_bf16 v[168:171], a[184:187], v[116:119], v[168:171]
    v_exp_f32 v183, v183
    v_mfma_f32_16x16x32_bf16 v[164:167], a[188:191], v[112:115], v[164:167]
    ds_read_b64_tr_b16 a[146:147], v22 offset:22528
    ds_read_b64_tr_b16 a[148:149], v23 offset:20480
    v_mfma_f32_16x16x32_bf16 v[172:175], a[188:191], v[116:119], v[172:175]
    v_exp_f32 v184, v184
    v_mfma_f32_16x16x32_bf16 v[192:195], a[160:163], v[72:75], v[232:235]
    ds_read_b64_tr_b16 a[150:151], v23 offset:22528
    v_cvt_pk_bf16_f32 v219, v182, v183
    v_mfma_f32_16x16x32_bf16 v[200:203], a[160:163], v[76:79], v[236:239]
    v_exp_f32 v185, v185
    v_mfma_f32_16x16x32_bf16 v[196:199], a[164:167], v[72:75], v[232:235]
    ds_read_b64_tr_b16 a[152:153], v24 offset:20480
    ds_read_b64_tr_b16 a[154:155], v24 offset:22528
    v_mfma_f32_16x16x32_bf16 v[204:207], a[164:167], v[76:79], v[236:239]
    v_exp_f32 v186, v186
    v_mfma_f32_16x16x32_bf16 v[192:195], a[168:171], v[88:91], v[192:195]
    ds_read_b64_tr_b16 a[156:157], v25 offset:20480
    v_cvt_pk_bf16_f32 v220, v184, v185
    v_mfma_f32_16x16x32_bf16 v[200:203], a[168:171], v[92:95], v[200:203]
    v_exp_f32 v187, v187
    v_mfma_f32_16x16x32_bf16 v[196:199], a[172:175], v[88:91], v[196:199]
    ds_read_b64_tr_b16 a[158:159], v25 offset:22528
    v_accvgpr_read_b32 v240, a208
    v_mfma_f32_16x16x32_bf16 v[204:207], a[172:175], v[92:95], v[204:207]
    v_exp_f32 v188, v188
    v_mfma_f32_16x16x32_bf16 v[192:195], a[176:179], v[104:107], v[192:195]
    v_cvt_pk_bf16_f32 v221, v186, v187
    v_accvgpr_read_b32 v241, a209
    v_mfma_f32_16x16x32_bf16 v[200:203], a[176:179], v[108:111], v[200:203]
    v_exp_f32 v189, v189
    v_mfma_f32_16x16x32_bf16 v[196:199], a[180:183], v[104:107], v[196:199]
    buffer_store_dwordx4 v[40:43], v30, s[36:39], s27 offen sc1
    v_mfma_f32_16x16x32_bf16 v[204:207], a[180:183], v[108:111], v[204:207]
    v_exp_f32 v190, v190
    v_mfma_f32_16x16x32_bf16 v[192:195], a[184:187], v[120:123], v[192:195]
    v_cvt_pk_bf16_f32 v222, v188, v189
    v_accvgpr_read_b32 v242, a210
    v_mfma_f32_16x16x32_bf16 v[200:203], a[184:187], v[124:127], v[200:203]
    v_exp_f32 v191, v191
    v_mfma_f32_16x16x32_bf16 v[196:199], a[188:191], v[120:123], v[196:199]
    v_accvgpr_read_b32 v243, a211
    v_accvgpr_read_b32 v244, a212
    v_mfma_f32_16x16x32_bf16 v[204:207], a[188:191], v[124:127], v[204:207]
    v_cvt_pk_bf16_f32 v223, v190, v191
    v_accvgpr_read_b32 v245, a213
    v_mfma_f32_16x16x32_bf16 v[44:47], v[36:39], v[56:59], v[44:47]
    v_accvgpr_read_b32 v246, a214
    v_accvgpr_read_b32 v247, a215
    v_mfma_f32_16x16x32_bf16 v[248:251], v[36:39], v[60:63], v[248:251]
    s_waitcnt lgkmcnt(0)
    v_exp_f32 v160, v160
    v_mfma_f32_16x16x32_bf16 a[0:3], a[128:131], v[56:59], a[0:3]
    ds_read_b128 a[160:163], v18 offset:0
    ds_read_b128 a[164:167], v18 offset:4096
    v_mfma_f32_16x16x32_bf16 a[8:11], a[128:131], v[60:63], a[8:11]
    v_exp_f32 v161, v161
    v_mfma_f32_16x16x32_bf16 a[4:7], a[132:135], v[56:59], a[4:7]
    ds_read_b128 a[168:171], v19 offset:0
    ds_read_b128 a[172:175], v19 offset:4096
    v_mfma_f32_16x16x32_bf16 a[12:15], a[132:135], v[60:63], a[12:15]
    v_exp_f32 v162, v162
    v_mfma_f32_16x16x32_bf16 a[16:19], a[136:139], v[56:59], a[16:19]
    ds_read_b128 a[176:179], v20 offset:0
    v_cvt_pk_bf16_f32 v208, v160, v161
    v_mfma_f32_16x16x32_bf16 a[24:27], a[136:139], v[60:63], a[24:27]
    v_exp_f32 v163, v163
    v_mfma_f32_16x16x32_bf16 a[20:23], a[140:143], v[56:59], a[20:23]
    ds_read_b128 a[180:183], v20 offset:4096
    ds_read_b128 a[184:187], v21 offset:0
    v_mfma_f32_16x16x32_bf16 a[28:31], a[140:143], v[60:63], a[28:31]
    v_exp_f32 v164, v164
    v_mfma_f32_16x16x32_bf16 a[32:35], a[144:147], v[56:59], a[32:35]
    ds_read_b128 a[188:191], v21 offset:4096
    v_cvt_pk_bf16_f32 v209, v162, v163
    v_mfma_f32_16x16x32_bf16 a[40:43], a[144:147], v[60:63], a[40:43]
    v_exp_f32 v165, v165
    v_mfma_f32_16x16x32_bf16 a[36:39], a[148:151], v[56:59], a[36:39]
    buffer_store_dwordx4 v[136:139], v12, s[36:39], s18 offen sc1
    v_mfma_f32_16x16x32_bf16 a[44:47], a[148:151], v[60:63], a[44:47]
    v_exp_f32 v166, v166
    v_mfma_f32_16x16x32_bf16 a[48:51], a[152:155], v[56:59], a[48:51]
    s_add_u32 m0, s50, 8192
    s_mov_b32 s48, 40960
    v_cvt_pk_bf16_f32 v210, v164, v165
    v_mfma_f32_16x16x32_bf16 a[56:59], a[152:155], v[60:63], a[56:59]
    v_exp_f32 v167, v167
    v_mfma_f32_16x16x32_bf16 a[52:55], a[156:159], v[56:59], a[52:55]
    buffer_load_dwordx4 v28, s[12:15], s48 offen lds
    v_mfma_f32_16x16x32_bf16 a[60:63], a[156:159], v[60:63], a[60:63]
    v_exp_f32 v168, v168
    v_mfma_f32_16x16x32_bf16 v[252:255], v[36:39], v[216:219], v[252:255]
    v_cvt_pk_bf16_f32 v211, v166, v167
    v_cvt_pk_bf16_f32 v240, v240, v241
    v_mfma_f32_16x16x32_bf16 v[32:35], v[36:39], v[220:223], v[32:35]
    v_exp_f32 v169, v169
    v_mfma_f32_16x16x32_bf16 a[64:67], a[128:131], v[216:219], a[64:67]
    buffer_load_dwordx4 v29, s[12:15], s48 offen offset:1024 lds
    v_mfma_f32_16x16x32_bf16 a[72:75], a[128:131], v[220:223], a[72:75]
    v_exp_f32 v170, v170
    v_mfma_f32_16x16x32_bf16 a[68:71], a[132:135], v[216:219], a[68:71]
    s_add_u32 m0, s50, 57344
    s_mov_b32 s48, 57344
    v_cvt_pk_bf16_f32 v212, v168, v169
    v_mfma_f32_16x16x32_bf16 a[76:79], a[132:135], v[220:223], a[76:79]
    v_exp_f32 v171, v171
    v_mfma_f32_16x16x32_bf16 a[80:83], a[136:139], v[216:219], a[80:83]
    buffer_load_dwordx4 v26, s[8:11], s48 offen lds
    v_mfma_f32_16x16x32_bf16 a[88:91], a[136:139], v[220:223], a[88:91]
    v_exp_f32 v172, v172
    v_mfma_f32_16x16x32_bf16 a[84:87], a[140:143], v[216:219], a[84:87]
    v_cvt_pk_bf16_f32 v213, v170, v171
    v_cvt_pk_bf16_f32 v241, v242, v243
    v_mfma_f32_16x16x32_bf16 a[92:95], a[140:143], v[220:223], a[92:95]
    v_exp_f32 v173, v173
    v_mfma_f32_16x16x32_bf16 a[96:99], a[144:147], v[216:219], a[96:99]
    buffer_load_dwordx4 v27, s[8:11], s48 offen offset:1024 lds
    v_mfma_f32_16x16x32_bf16 a[104:107], a[144:147], v[220:223], a[104:107]
    v_exp_f32 v174, v174
    v_mfma_f32_16x16x32_bf16 a[100:103], a[148:151], v[216:219], a[100:103]
    v_cvt_pk_bf16_f32 v214, v172, v173
    v_cvt_pk_bf16_f32 v242, v244, v245
    v_mfma_f32_16x16x32_bf16 a[108:111], a[148:151], v[220:223], a[108:111]
    v_exp_f32 v175, v175
    v_mfma_f32_16x16x32_bf16 a[112:115], a[152:155], v[216:219], a[112:115]
    s_waitcnt vmcnt(14) lgkmcnt(0)
    v_cvt_pk_bf16_f32 v243, v246, v247
    v_mfma_f32_16x16x32_bf16 a[120:123], a[152:155], v[220:223], a[120:123]
    s_barrier
    buffer_load_dword v54, v51, s[64:67], 0 offen sc1
    v_mfma_f32_16x16x32_bf16 a[116:119], a[156:159], v[216:219], a[116:119]
    v_cvt_pk_bf16_f32 v215, v174, v175
    v_mfma_f32_16x16x32_bf16 a[124:127], a[156:159], v[220:223], a[124:127]
    buffer_store_dwordx4 v[240:243], v13, s[36:39], s18 offen sc1
    v_mfma_f32_16x16x32_bf16 v[160:163], a[160:163], v[64:67], v[224:227]
    v_exp_f32 v192, v192
    v_mfma_f32_16x16x32_bf16 v[168:171], a[160:163], v[68:71], v[228:231]
    v_exp_f32 v193, v193
    v_mfma_f32_16x16x32_bf16 v[164:167], a[164:167], v[64:67], v[224:227]
L_pg5:
    s_cbranch_execz L_pg9
    ds_read_b64_tr_b16 a[128:129], v22 offset:24576
    ds_read_b64_tr_b16 a[130:131], v22 offset:26624
    v_mfma_f32_16x16x32_bf16 v[172:175], a[164:167], v[68:71], v[228:231]
    v_exp_f32 v194, v194
    v_mfma_f32_16x16x32_bf16 v[160:163], a[168:171], v[80:83], v[160:163]
    ds_read_b64_tr_b16 a[132:133], v23 offset:24576
    v_cvt_pk_bf16_f32 v216, v192, v193
    v_mfma_f32_16x16x32_bf16 v[168:171], a[168:171], v[84:87], v[168:171]
    v_exp_f32 v195, v195
    v_mfma_f32_16x16x32_bf16 v[164:167], a[172:175], v[80:83], v[164:167]
    ds_read_b64_tr_b16 a[134:135], v23 offset:26624
    ds_read_b64_tr_b16 a[136:137], v24 offset:24576
    v_mfma_f32_16x16x32_bf16 v[172:175], a[172:175], v[84:87], v[172:175]
    v_exp_f32 v196, v196
    v_mfma_f32_16x16x32_bf16 v[160:163], a[176:179], v[96:99], v[160:163]
    ds_read_b64_tr_b16 a[138:139], v24 offset:26624
    v_cvt_pk_bf16_f32 v217, v194, v195
    v_mfma_f32_16x16x32_bf16 v[168:171], a[176:179], v[100:103], v[168:171]
    v_exp_f32 v197, v197
    v_mfma_f32_16x16x32_bf16 v[164:167], a[180:183], v[96:99], v[164:167]
    ds_read_b64_tr_b16 a[140:141], v25 offset:24576
    ds_read_b64_tr_b16 a[142:143], v25 offset:26624
    v_mfma_f32_16x16x32_bf16 v[172:175], a[180:183], v[100:103], v[172:175]
    v_exp_f32 v198, v198
    v_mfma_f32_16x16x32_bf16 v[160:163], a[184:187], v[112:115], v[160:163]
    ds_read_b64_tr_b16 a[144:145], v22 offset:28672
    v_cvt_pk_bf16_f32 v218, v196, v197
    v_mfma_f32_16x16x32_bf16 v[168:171], a[184:187], v[116:119], v[168:171]
    v_exp_f32 v199, v199
    v_mfma_f32_16x16x32_bf16 v[164:167], a[188:191], v[112:115], v[164:167]
    ds_read_b64_tr_b16 a[146:147], v22 offset:30720
    ds_read_b64_tr_b16 a[148:149], v23 offset:28672
    v_mfma_f32_16x16x32_bf16 v[172:175], a[188:191], v[116:119], v[172:175]
    v_exp_f32 v200, v200
    v_mfma_f32_16x16x32_bf16 v[176:179], a[160:163], v[72:75], v[232:235]
    ds_read_b64_tr_b16 a[150:151], v23 offset:30720
    v_cvt_pk_bf16_f32 v219, v198, v199
    v_mfma_f32_16x16x32_bf16 v[184:187], a[160:163], v[76:79], v[236:239]
    v_exp_f32 v201, v201
    v_mfma_f32_16x16x32_bf16 v[180:183], a[164:167], v[72:75], v[232:235]
    ds_read_b64_tr_b16 a[152:153], v24 offset:28672
    ds_read_b64_tr_b16 a[154:155], v24 offset:30720
    v_mfma_f32_16x16x32_bf16 v[188:191], a[164:167], v[76:79], v[236:239]
    v_exp_f32 v202, v202
    v_mfma_f32_16x16x32_bf16 v[176:179], a[168:171], v[88:91], v[176:179]
    ds_read_b64_tr_b16 a[156:157], v25 offset:28672
    v_cvt_pk_bf16_f32 v220, v200, v201
    v_mfma_f32_16x16x32_bf16 v[184:187], a[168:171], v[92:95], v[184:187]
    v_exp_f32 v203, v203
    v_mfma_f32_16x16x32_bf16 v[180:183], a[172:175], v[88:91], v[180:183]
    ds_read_b64_tr_b16 a[158:159], v25 offset:30720
    v_accvgpr_read_b32 v240, a216
    v_mfma_f32_16x16x32_bf16 v[188:191], a[172:175], v[92:95], v[188:191]
    v_exp_f32 v204, v204
    v_mfma_f32_16x16x32_bf16 v[176:179], a[176:179], v[104:107], v[176:179]
    v_cvt_pk_bf16_f32 v221, v202, v203
    v_accvgpr_read_b32 v241, a217
    v_mfma_f32_16x16x32_bf16 v[184:187], a[176:179], v[108:111], v[184:187]
    v_exp_f32 v205, v205
    v_mfma_f32_16x16x32_bf16 v[180:183], a[180:183], v[104:107], v[180:183]
    buffer_store_dwordx4 v[40:43], v31, s[36:39], s17 offen sc1
    v_mfma_f32_16x16x32_bf16 v[188:191], a[180:183], v[108:111], v[188:191]
    v_exp_f32 v206, v206
    v_mfma_f32_16x16x32_bf16 v[176:179], a[184:187], v[120:123], v[176:179]
    v_cvt_pk_bf16_f32 v222, v204, v205
    v_accvgpr_read_b32 v242, a218
    v_mfma_f32_16x16x32_bf16 v[184:187], a[184:187], v[124:127], v[184:187]
    v_exp_f32 v207, v207
    v_mfma_f32_16x16x32_bf16 v[180:183], a[188:191], v[120:123], v[180:183]
    v_accvgpr_read_b32 v243, a219
    v_accvgpr_read_b32 v244, a220
    v_mfma_f32_16x16x32_bf16 v[188:191], a[188:191], v[124:127], v[188:191]
    v_cvt_pk_bf16_f32 v223, v206, v207
    v_accvgpr_read_b32 v245, a221
    v_mfma_f32_16x16x32_bf16 v[44:47], v[36:39], v[208:211], v[44:47]
    v_accvgpr_read_b32 v246, a222
    v_accvgpr_read_b32 v247, a223
    v_mfma_f32_16x16x32_bf16 v[248:251], v[36:39], v[212:215], v[248:251]
    s_waitcnt lgkmcnt(0)
    v_exp_f32 v160, v160
    v_mfma_f32_16x16x32_bf16 a[0:3], a[128:131], v[208:211], a[0:3]
    ds_read_b128 a[160:163], v18 offset:8192
    ds_read_b128 a[164:167], v18 offset:12288
    v_mfma_f32_16x16x32_bf16 a[8:11], a[128:131], v[212:215], a[8:11]
    v_exp_f32 v161, v161
    v_mfma_f32_16x16x32_bf16 a[4:7], a[132:135], v[208:211], a[4:7]
    ds_read_b128 a[168:171], v19 offset:8192
    ds_read_b128 a[172:175], v19 offset:12288
    v_mfma_f32_16x16x32_bf16 a[12:15], a[132:135], v[212:215], a[12:15]
    v_exp_f32 v162, v162
    v_mfma_f32_16x16x32_bf16 a[16:19], a[136:139], v[208:211], a[16:19]
    ds_read_b128 a[176:179], v20 offset:8192
    v_cvt_pk_bf16_f32 v56, v160, v161
    v_mfma_f32_16x16x32_bf16 a[24:27], a[136:139], v[212:215], a[24:27]
    v_exp_f32 v163, v163
    v_mfma_f32_16x16x32_bf16 a[20:23], a[140:143], v[208:211], a[20:23]
    ds_read_b128 a[180:183], v20 offset:12288
    ds_read_b128 a[184:187], v21 offset:8192
    v_mfma_f32_16x16x32_bf16 a[28:31], a[140:143], v[212:215], a[28:31]
    v_exp_f32 v164, v164
    v_mfma_f32_16x16x32_bf16 a[32:35], a[144:147], v[208:211], a[32:35]
    ds_read_b128 a[188:191], v21 offset:12288
    v_cvt_pk_bf16_f32 v57, v162, v163
    v_mfma_f32_16x16x32_bf16 a[40:43], a[144:147], v[212:215], a[40:43]
    v_exp_f32 v165, v165
    v_mfma_f32_16x16x32_bf16 a[36:39], a[148:151], v[208:211], a[36:39]
    buffer_store_dwordx4 v[140:143], v12, s[36:39], s19 offen sc1
    v_mfma_f32_16x16x32_bf16 a[44:47], a[148:151], v[212:215], a[44:47]
    v_exp_f32 v166, v166
    v_mfma_f32_16x16x32_bf16 a[48:51], a[152:155], v[208:211], a[48:51]
    s_add_u32 m0, s50, 16384
    s_mov_b32 s48, 49152
    v_cvt_pk_bf16_f32 v58, v164, v165
    v_mfma_f32_16x16x32_bf16 a[56:59], a[152:155], v[212:215], a[56:59]
    v_exp_f32 v167, v167
    v_mfma_f32_16x16x32_bf16 a[52:55], a[156:159], v[208:211], a[52:55]
    buffer_load_dwordx4 v28, s[12:15], s48 offen lds
    v_mfma_f32_16x16x32_bf16 a[60:63], a[156:159], v[212:215], a[60:63]
    v_exp_f32 v168, v168
    v_mfma_f32_16x16x32_bf16 v[252:255], v[36:39], v[216:219], v[252:255]
    v_cvt_pk_bf16_f32 v59, v166, v167
    v_cvt_pk_bf16_f32 v240, v240, v241
    v_mfma_f32_16x16x32_bf16 v[32:35], v[36:39], v[220:223], v[32:35]
    v_exp_f32 v169, v169
    v_mfma_f32_16x16x32_bf16 a[64:67], a[128:131], v[216:219], a[64:67]
    buffer_load_dwordx4 v29, s[12:15], s48 offen offset:1024 lds
    v_mfma_f32_16x16x32_bf16 a[72:75], a[128:131], v[220:223], a[72:75]
    v_exp_f32 v170, v170
    v_mfma_f32_16x16x32_bf16 a[68:71], a[132:135], v[216:219], a[68:71]
    s_add_u32 m0, s50, 32768
    s_mov_b32 s48, 65536
    v_cvt_pk_bf16_f32 v60, v168, v169
    v_mfma_f32_16x16x32_bf16 a[76:79], a[132:135], v[220:223], a[76:79]
    v_exp_f32 v171, v171
    v_mfma_f32_16x16x32_bf16 a[80:83], a[136:139], v[216:219], a[80:83]
    buffer_load_dwordx4 v26, s[8:11], s48 offen lds
    v_mfma_f32_16x16x32_bf16 a[88:91], a[136:139], v[220:223], a[88:91]
    v_exp_f32 v172, v172
    v_mfma_f32_16x16x32_bf16 a[84:87], a[140:143], v[216:219], a[84:87]
    v_cvt_pk_bf16_f32 v61, v170, v171
    v_cvt_pk_bf16_f32 v241, v242, v243
    v_mfma_f32_16x16x32_bf16 a[92:95], a[140:143], v[220:223], a[92:95]
    v_exp_f32 v173, v173
    v_mfma_f32_16x16x32_bf16 a[96:99], a[144:147], v[216:219], a[96:99]
    buffer_load_dwordx4 v27, s[8:11], s48 offen offset:1024 lds
    v_mfma_f32_16x16x32_bf16 a[104:107], a[144:147], v[220:223], a[104:107]
    v_exp_f32 v174, v174
    v_mfma_f32_16x16x32_bf16 a[100:103], a[148:151], v[216:219], a[100:103]
    v_cvt_pk_bf16_f32 v62, v172, v173
    v_cvt_pk_bf16_f32 v242, v244, v245
    v_mfma_f32_16x16x32_bf16 a[108:111], a[148:151], v[220:223], a[108:111]
    v_exp_f32 v175, v175
    v_mfma_f32_16x16x32_bf16 a[112:115], a[152:155], v[216:219], a[112:115]
    s_waitcnt vmcnt(15) lgkmcnt(0)
    v_cvt_pk_bf16_f32 v243, v246, v247
    v_mfma_f32_16x16x32_bf16 a[120:123], a[152:155], v[220:223], a[120:123]
    s_barrier
    v_mfma_f32_16x16x32_bf16 a[116:119], a[156:159], v[216:219], a[116:119]
    v_cvt_pk_bf16_f32 v63, v174, v175
    v_mfma_f32_16x16x32_bf16 a[124:127], a[156:159], v[220:223], a[124:127]
    buffer_store_dwordx4 v[240:243], v13, s[36:39], s19 offen sc1
    v_mfma_f32_16x16x32_bf16 v[160:163], a[160:163], v[64:67], v[224:227]
    v_exp_f32 v176, v176
    v_mfma_f32_16x16x32_bf16 v[168:171], a[160:163], v[68:71], v[228:231]
    v_exp_f32 v177, v177
    v_mfma_f32_16x16x32_bf16 v[164:167], a[164:167], v[64:67], v[224:227]
    ds_read_b64_tr_b16 a[128:129], v22 offset:0
    ds_read_b64_tr_b16 a[130:131], v22 offset:2048
    v_mfma_f32_16x16x32_bf16 v[172:175], a[164:167], v[68:71], v[228:231]
    v_exp_f32 v178, v178
    v_mfma_f32_16x16x32_bf16 v[160:163], a[168:171], v[80:83], v[160:163]
    ds_read_b64_tr_b16 a[132:133], v23 offset:0
    v_cvt_pk_bf16_f32 v216, v176, v177
    v_mfma_f32_16x16x32_bf16 v[168:171], a[168:171], v[84:87], v[168:171]
    v_exp_f32 v179, v179
    v_mfma_f32_16x16x32_bf16 v[164:167], a[172:175], v[80:83], v[164:167]
    ds_read_b64_tr_b16 a[134:135], v23 offset:2048
    ds_read_b64_tr_b16 a[136:137], v24 offset:0
    v_mfma_f32_16x16x32_bf16 v[172:175], a[172:175], v[84:87], v[172:175]
    v_exp_f32 v180, v180
    v_mfma_f32_16x16x32_bf16 v[160:163], a[176:179], v[96:99], v[160:163]
    ds_read_b64_tr_b16 a[138:139], v24 offset:2048
    v_cvt_pk_bf16_f32 v217, v178, v179
    v_mfma_f32_16x16x32_bf16 v[168:171], a[176:179], v[100:103], v[168:171]
    v_exp_f32 v181, v181
    v_mfma_f32_16x16x32_bf16 v[164:167], a[180:183], v[96:99], v[164:167]
    ds_read_b64_tr_b16 a[140:141], v25 offset:0
    ds_read_b64_tr_b16 a[142:143], v25 offset:2048
    v_mfma_f32_16x16x32_bf16 v[172:175], a[180:183], v[100:103], v[172:175]
    v_exp_f32 v182, v182
    v_mfma_f32_16x16x32_bf16 v[160:163], a[184:187], v[112:115], v[160:163]
    ds_read_b64_tr_b16 a[144:145], v22 offset:4096
    v_cvt_pk_bf16_f32 v218, v180, v181
    v_mfma_f32_16x16x32_bf16 v[168:171], a[184:187], v[116:119], v[168:171]
    v_exp_f32 v183, v183
    v_mfma_f32_16x16x32_bf16 v[164:167], a[188:191], v[112:115], v[164:167]
    ds_read_b64_tr_b16 a[146:147], v22 offset:6144
    ds_read_b64_tr_b16 a[148:149], v23 offset:4096
    v_mfma_f32_16x16x32_bf16 v[172:175], a[188:191], v[116:119], v[172:175]
    v_exp_f32 v184, v184
    v_mfma_f32_16x16x32_bf16 v[192:195], a[160:163], v[72:75], v[232:235]
    ds_read_b64_tr_b16 a[150:151], v23 offset:6144
    v_cvt_pk_bf16_f32 v219, v182, v183
    v_mfma_f32_16x16x32_bf16 v[200:203], a[160:163], v[76:79], v[236:239]
    v_exp_f32 v185, v185
    v_mfma_f32_16x16x32_bf16 v[196:199], a[164:167], v[72:75], v[232:235]
    ds_read_b64_tr_b16 a[152:153], v24 offset:4096
    ds_read_b64_tr_b16 a[154:155], v24 offset:6144
    v_mfma_f32_16x16x32_bf16 v[204:207], a[164:167], v[76:79], v[236:239]
    v_exp_f32 v186, v186
    v_mfma_f32_16x16x32_bf16 v[192:195], a[168:171], v[88:91], v[192:195]
    ds_read_b64_tr_b16 a[156:157], v25 offset:4096
    v_cvt_pk_bf16_f32 v220, v184, v185
    v_mfma_f32_16x16x32_bf16 v[200:203], a[168:171], v[92:95], v[200:203]
    v_exp_f32 v187, v187
    v_mfma_f32_16x16x32_bf16 v[196:199], a[172:175], v[88:91], v[196:199]
    ds_read_b64_tr_b16 a[158:159], v25 offset:6144
    v_accvgpr_read_b32 v240, a224
    v_mfma_f32_16x16x32_bf16 v[204:207], a[172:175], v[92:95], v[204:207]
    v_exp_f32 v188, v188
    v_mfma_f32_16x16x32_bf16 v[192:195], a[176:179], v[104:107], v[192:195]
    v_cvt_pk_bf16_f32 v221, v186, v187
    v_accvgpr_read_b32 v241, a225
    v_mfma_f32_16x16x32_bf16 v[200:203], a[176:179], v[108:111], v[200:203]
    v_exp_f32 v189, v189
    v_mfma_f32_16x16x32_bf16 v[196:199], a[180:183], v[104:107], v[196:199]
    buffer_store_dwordx4 v[40:43], v31, s[36:39], s18 offen sc1
    v_mfma_f32_16x16x32_bf16 v[204:207], a[180:183], v[108:111], v[204:207]
    v_exp_f32 v190, v190
    v_mfma_f32_16x16x32_bf16 v[192:195], a[184:187], v[120:123], v[192:195]
    v_cvt_pk_bf16_f32 v222, v188, v189
    v_accvgpr_read_b32 v242, a226
    v_mfma_f32_16x16x32_bf16 v[200:203], a[184:187], v[124:127], v[200:203]
    v_exp_f32 v191, v191
    v_mfma_f32_16x16x32_bf16 v[196:199], a[188:191], v[120:123], v[196:199]
    v_accvgpr_read_b32 v243, a227
    v_accvgpr_read_b32 v244, a228
    v_mfma_f32_16x16x32_bf16 v[204:207], a[188:191], v[124:127], v[204:207]
    v_cvt_pk_bf16_f32 v223, v190, v191
    v_accvgpr_read_b32 v245, a229
    v_mfma_f32_16x16x32_bf16 v[44:47], v[36:39], v[56:59], v[44:47]
    v_accvgpr_read_b32 v246, a230
    v_accvgpr_read_b32 v247, a231
    v_mfma_f32_16x16x32_bf16 v[248:251], v[36:39], v[60:63], v[248:251]
    s_waitcnt lgkmcnt(0)
    v_exp_f32 v160, v160
    v_mfma_f32_16x16x32_bf16 a[0:3], a[128:131], v[56:59], a[0:3]
    ds_read_b128 a[160:163], v18 offset:16384
    ds_read_b128 a[164:167], v18 offset:20480
    v_mfma_f32_16x16x32_bf16 a[8:11], a[128:131], v[60:63], a[8:11]
    v_exp_f32 v161, v161
    v_mfma_f32_16x16x32_bf16 a[4:7], a[132:135], v[56:59], a[4:7]
    ds_read_b128 a[168:171], v19 offset:16384
    ds_read_b128 a[172:175], v19 offset:20480
    v_mfma_f32_16x16x32_bf16 a[12:15], a[132:135], v[60:63], a[12:15]
    v_exp_f32 v162, v162
    v_mfma_f32_16x16x32_bf16 a[16:19], a[136:139], v[56:59], a[16:19]
    ds_read_b128 a[176:179], v20 offset:16384
    v_cvt_pk_bf16_f32 v208, v160, v161
    v_mfma_f32_16x16x32_bf16 a[24:27], a[136:139], v[60:63], a[24:27]
    v_exp_f32 v163, v163
    v_mfma_f32_16x16x32_bf16 a[20:23], a[140:143], v[56:59], a[20:23]
    ds_read_b128 a[180:183], v20 offset:20480
    ds_read_b128 a[184:187], v21 offset:16384
    v_mfma_f32_16x16x32_bf16 a[28:31], a[140:143], v[60:63], a[28:31]
    v_exp_f32 v164, v164
    v_mfma_f32_16x16x32_bf16 a[32:35], a[144:147], v[56:59], a[32:35]
    ds_read_b128 a[188:191], v21 offset:20480
    v_cvt_pk_bf16_f32 v209, v162, v163
    v_mfma_f32_16x16x32_bf16 a[40:43], a[144:147], v[60:63], a[40:43]
    v_exp_f32 v165, v165
    v_mfma_f32_16x16x32_bf16 a[36:39], a[148:151], v[56:59], a[36:39]
    buffer_store_dwordx4 v[144:147], v12, s[36:39], s24 offen sc1
    v_mfma_f32_16x16x32_bf16 a[44:47], a[148:151], v[60:63], a[44:47]
    v_exp_f32 v166, v166
    v_mfma_f32_16x16x32_bf16 a[48:51], a[152:155], v[56:59], a[48:51]
    s_add_u32 m0, s50, 24576
    s_mov_b32 s48, 57344
    v_cvt_pk_bf16_f32 v210, v164, v165
    v_mfma_f32_16x16x32_bf16 a[56:59], a[152:155], v[60:63], a[56:59]
    v_exp_f32 v167, v167
    v_mfma_f32_16x16x32_bf16 a[52:55], a[156:159], v[56:59], a[52:55]
    buffer_load_dwordx4 v28, s[12:15], s48 offen lds
    v_mfma_f32_16x16x32_bf16 a[60:63], a[156:159], v[60:63], a[60:63]
    v_exp_f32 v168, v168
    v_mfma_f32_16x16x32_bf16 v[252:255], v[36:39], v[216:219], v[252:255]
    v_cvt_pk_bf16_f32 v211, v166, v167
    v_cvt_pk_bf16_f32 v240, v240, v241
    v_mfma_f32_16x16x32_bf16 v[32:35], v[36:39], v[220:223], v[32:35]
    v_exp_f32 v169, v169
    v_mfma_f32_16x16x32_bf16 a[64:67], a[128:131], v[216:219], a[64:67]
    buffer_load_dwordx4 v29, s[12:15], s48 offen offset:1024 lds
    v_mfma_f32_16x16x32_bf16 a[72:75], a[128:131], v[220:223], a[72:75]
    v_exp_f32 v170, v170
    v_mfma_f32_16x16x32_bf16 a[68:71], a[132:135], v[216:219], a[68:71]
    s_add_u32 m0, s50, 40960
    s_mov_b32 s48, 73728
    v_cvt_pk_bf16_f32 v212, v168, v169
    v_mfma_f32_16x16x32_bf16 a[76:79], a[132:135], v[220:223], a[76:79]
    v_exp_f32 v171, v171
    v_mfma_f32_16x16x32_bf16 a[80:83], a[136:139], v[216:219], a[80:83]
    buffer_load_dwordx4 v26, s[8:11], s48 offen lds
    v_mfma_f32_16x16x32_bf16 a[88:91], a[136:139], v[220:223], a[88:91]
    v_exp_f32 v172, v172
    v_mfma_f32_16x16x32_bf16 a[84:87], a[140:143], v[216:219], a[84:87]
    v_cvt_pk_bf16_f32 v213, v170, v171
    v_cvt_pk_bf16_f32 v241, v242, v243
    v_mfma_f32_16x16x32_bf16 a[92:95], a[140:143], v[220:223], a[92:95]
    v_exp_f32 v173, v173
    v_mfma_f32_16x16x32_bf16 a[96:99], a[144:147], v[216:219], a[96:99]
    buffer_load_dwordx4 v27, s[8:11], s48 offen offset:1024 lds
    v_mfma_f32_16x16x32_bf16 a[104:107], a[144:147], v[220:223], a[104:107]
    v_exp_f32 v174, v174
    v_mfma_f32_16x16x32_bf16 a[100:103], a[148:151], v[216:219], a[100:103]
    v_cvt_pk_bf16_f32 v214, v172, v173
    v_cvt_pk_bf16_f32 v242, v244, v245
    v_mfma_f32_16x16x32_bf16 a[108:111], a[148:151], v[220:223], a[108:111]
    v_exp_f32 v175, v175
    v_mfma_f32_16x16x32_bf16 a[112:115], a[152:155], v[216:219], a[112:115]
    s_waitcnt vmcnt(15) lgkmcnt(0)
    v_cvt_pk_bf16_f32 v243, v246, v247
    v_mfma_f32_16x16x32_bf16 a[120:123], a[152:155], v[220:223], a[120:123]
    s_barrier
    v_mfma_f32_16x16x32_bf16 a[116:119], a[156:159], v[216:219], a[116:119]
    v_cvt_pk_bf16_f32 v215, v174, v175
    v_mfma_f32_16x16x32_bf16 a[124:127], a[156:159], v[220:223], a[124:127]
    buffer_store_dwordx4 v[240:243], v13, s[36:39], s24 offen sc1
    v_mfma_f32_16x16x32_bf16 v[160:163], a[160:163], v[64:67], v[224:227]
    v_exp_f32 v192, v192
    v_mfma_f32_16x16x32_bf16 v[168:171], a[160:163], v[68:71], v[228:231]
    v_exp_f32 v193, v193
    v_mfma_f32_16x16x32_bf16 v[164:167], a[164:167], v[64:67], v[224:227]
    ds_read_b64_tr_b16 a[128:129], v22 offset:8192
    ds_read_b64_tr_b16 a[130:131], v22 offset:10240
    v_mfma_f32_16x16x32_bf16 v[172:175], a[164:167], v[68:71], v[228:231]
    v_exp_f32 v194, v194
    v_mfma_f32_16x16x32_bf16 v[160:163], a[168:171], v[80:83], v[160:163]
    ds_read_b64_tr_b16 a[132:133], v23 offset:8192
    v_cvt_pk_bf16_f32 v216, v192, v193
    v_mfma_f32_16x16x32_bf16 v[168:171], a[168:171], v[84:87], v[168:171]
    v_exp_f32 v195, v195
    v_mfma_f32_16x16x32_bf16 v[164:167], a[172:175], v[80:83], v[164:167]
    ds_read_b64_tr_b16 a[134:135], v23 offset:10240
    ds_read_b64_tr_b16 a[136:137], v24 offset:8192
    v_mfma_f32_16x16x32_bf16 v[172:175], a[172:175], v[84:87], v[172:175]
    v_exp_f32 v196, v196
    v_mfma_f32_16x16x32_bf16 v[160:163], a[176:179], v[96:99], v[160:163]
    ds_read_b64_tr_b16 a[138:139], v24 offset:10240
    v_cvt_pk_bf16_f32 v217, v194, v195
    v_mfma_f32_16x16x32_bf16 v[168:171], a[176:179], v[100:103], v[168:171]
    v_exp_f32 v197, v197
    v_mfma_f32_16x16x32_bf16 v[164:167], a[180:183], v[96:99], v[164:167]
    ds_read_b64_tr_b16 a[140:141], v25 offset:8192
    ds_read_b64_tr_b16 a[142:143], v25 offset:10240
    v_mfma_f32_16x16x32_bf16 v[172:175], a[180:183], v[100:103], v[172:175]
    v_exp_f32 v198, v198
    v_mfma_f32_16x16x32_bf16 v[160:163], a[184:187], v[112:115], v[160:163]
    ds_read_b64_tr_b16 a[144:145], v22 offset:12288
    v_cvt_pk_bf16_f32 v218, v196, v197
    v_mfma_f32_16x16x32_bf16 v[168:171], a[184:187], v[116:119], v[168:171]
    v_exp_f32 v199, v199
    v_mfma_f32_16x16x32_bf16 v[164:167], a[188:191], v[112:115], v[164:167]
    ds_read_b64_tr_b16 a[146:147], v22 offset:14336
    ds_read_b64_tr_b16 a[148:149], v23 offset:12288
    v_mfma_f32_16x16x32_bf16 v[172:175], a[188:191], v[116:119], v[172:175]
    v_exp_f32 v200, v200
    v_mfma_f32_16x16x32_bf16 v[176:179], a[160:163], v[72:75], v[232:235]
    ds_read_b64_tr_b16 a[150:151], v23 offset:14336
    v_cvt_pk_bf16_f32 v219, v198, v199
    v_mfma_f32_16x16x32_bf16 v[184:187], a[160:163], v[76:79], v[236:239]
    v_exp_f32 v201, v201
    v_mfma_f32_16x16x32_bf16 v[180:183], a[164:167], v[72:75], v[232:235]
    ds_read_b64_tr_b16 a[152:153], v24 offset:12288
    ds_read_b64_tr_b16 a[154:155], v24 offset:14336
    v_mfma_f32_16x16x32_bf16 v[188:191], a[164:167], v[76:79], v[236:239]
    v_exp_f32 v202, v202
    v_mfma_f32_16x16x32_bf16 v[176:179], a[168:171], v[88:91], v[176:179]
    ds_read_b64_tr_b16 a[156:157], v25 offset:12288
    v_cvt_pk_bf16_f32 v220, v200, v201
    v_mfma_f32_16x16x32_bf16 v[184:187], a[168:171], v[92:95], v[184:187]
    v_exp_f32 v203, v203
    v_mfma_f32_16x16x32_bf16 v[180:183], a[172:175], v[88:91], v[180:183]
    ds_read_b64_tr_b16 a[158:159], v25 offset:14336
    s_lshl_b32 s47, s42, 14
    buffer_load_dword v49, v50, s[20:23], s47 offen
    v_mfma_f32_16x16x32_bf16 v[188:191], a[172:175], v[92:95], v[188:191]
    v_exp_f32 v204, v204
    v_mfma_f32_16x16x32_bf16 v[176:179], a[176:179], v[104:107], v[176:179]
    v_cvt_pk_bf16_f32 v221, v202, v203
    v_accvgpr_read_b32 v240, a232
    v_mfma_f32_16x16x32_bf16 v[184:187], a[176:179], v[108:111], v[184:187]
    v_exp_f32 v205, v205
    v_mfma_f32_16x16x32_bf16 v[180:183], a[180:183], v[104:107], v[180:183]
    buffer_store_dwordx4 v[40:43], v31, s[36:39], s19 offen sc1
    v_mfma_f32_16x16x32_bf16 v[188:191], a[180:183], v[108:111], v[188:191]
    v_exp_f32 v206, v206
    v_mfma_f32_16x16x32_bf16 v[176:179], a[184:187], v[120:123], v[176:179]
    v_cvt_pk_bf16_f32 v222, v204, v205
    v_accvgpr_read_b32 v241, a233
    v_mfma_f32_16x16x32_bf16 v[184:187], a[184:187], v[124:127], v[184:187]
    v_exp_f32 v207, v207
    v_mfma_f32_16x16x32_bf16 v[180:183], a[188:191], v[120:123], v[180:183]
    v_accvgpr_read_b32 v242, a234
    v_accvgpr_read_b32 v243, a235
    v_mfma_f32_16x16x32_bf16 v[188:191], a[188:191], v[124:127], v[188:191]
    v_cvt_pk_bf16_f32 v223, v206, v207
    v_accvgpr_read_b32 v244, a236
    v_mfma_f32_16x16x32_bf16 v[44:47], v[36:39], v[208:211], v[44:47]
    v_accvgpr_read_b32 v245, a237
    v_accvgpr_read_b32 v246, a238
    v_mfma_f32_16x16x32_bf16 v[248:251], v[36:39], v[212:215], v[248:251]
    s_waitcnt lgkmcnt(0)
    v_exp_f32 v160, v160
    v_mfma_f32_16x16x32_bf16 a[0:3], a[128:131], v[208:211], a[0:3]
    ds_read_b128 a[160:163], v18 offset:24576
    ds_read_b128 a[164:167], v18 offset:28672
    v_mfma_f32_16x16x32_bf16 a[8:11], a[128:131], v[212:215], a[8:11]
    v_exp_f32 v161, v161
    v_mfma_f32_16x16x32_bf16 a[4:7], a[132:135], v[208:211], a[4:7]
    ds_read_b128 a[168:171], v19 offset:24576
    ds_read_b128 a[172:175], v19 offset:28672
    v_mfma_f32_16x16x32_bf16 a[12:15], a[132:135], v[212:215], a[12:15]
    v_exp_f32 v162, v162
    v_mfma_f32_16x16x32_bf16 a[16:19], a[136:139], v[208:211], a[16:19]
    ds_read_b128 a[176:179], v20 offset:24576
    v_cvt_pk_bf16_f32 v56, v160, v161
    v_mfma_f32_16x16x32_bf16 a[24:27], a[136:139], v[212:215], a[24:27]
    v_exp_f32 v163, v163
    v_mfma_f32_16x16x32_bf16 a[20:23], a[140:143], v[208:211], a[20:23]
    ds_read_b128 a[180:183], v20 offset:28672
    ds_read_b128 a[184:187], v21 offset:24576
    v_mfma_f32_16x16x32_bf16 a[28:31], a[140:143], v[212:215], a[28:31]
    v_exp_f32 v164, v164
    v_mfma_f32_16x16x32_bf16 a[32:35], a[144:147], v[208:211], a[32:35]
    ds_read_b128 a[188:191], v21 offset:28672
    v_cvt_pk_bf16_f32 v57, v162, v163
    v_mfma_f32_16x16x32_bf16 a[40:43], a[144:147], v[212:215], a[40:43]
    v_exp_f32 v165, v165
    v_mfma_f32_16x16x32_bf16 a[36:39], a[148:151], v[208:211], a[36:39]
    buffer_store_dwordx4 v[148:151], v12, s[36:39], s25 offen sc1
    v_mfma_f32_16x16x32_bf16 a[44:47], a[148:151], v[212:215], a[44:47]
    v_exp_f32 v166, v166
    v_mfma_f32_16x16x32_bf16 a[48:51], a[152:155], v[208:211], a[48:51]
    s_add_u32 m0, s50, 0
    s_mov_b32 s48, 65536
    v_cvt_pk_bf16_f32 v58, v164, v165
    v_mfma_f32_16x16x32_bf16 a[56:59], a[152:155], v[212:215], a[56:59]
    v_exp_f32 v167, v167
    v_mfma_f32_16x16x32_bf16 a[52:55], a[156:159], v[208:211], a[52:55]
    buffer_load_dwordx4 v28, s[12:15], s48 offen lds
    v_mfma_f32_16x16x32_bf16 a[60:63], a[156:159], v[212:215], a[60:63]
    v_exp_f32 v168, v168
    v_mfma_f32_16x16x32_bf16 v[252:255], v[36:39], v[216:219], v[252:255]
    v_cvt_pk_bf16_f32 v59, v166, v167
    v_accvgpr_read_b32 v247, a239
    v_mfma_f32_16x16x32_bf16 v[32:35], v[36:39], v[220:223], v[32:35]
    v_exp_f32 v169, v169
    v_mfma_f32_16x16x32_bf16 a[64:67], a[128:131], v[216:219], a[64:67]
    buffer_load_dwordx4 v29, s[12:15], s48 offen offset:1024 lds
    v_mfma_f32_16x16x32_bf16 a[72:75], a[128:131], v[220:223], a[72:75]
    v_exp_f32 v170, v170
    v_mfma_f32_16x16x32_bf16 a[68:71], a[132:135], v[216:219], a[68:71]
    s_add_u32 m0, s50, 49152
    s_mov_b32 s48, 81920
    v_cvt_pk_bf16_f32 v60, v168, v169
    v_mfma_f32_16x16x32_bf16 a[76:79], a[132:135], v[220:223], a[76:79]
    v_exp_f32 v171, v171
    v_mfma_f32_16x16x32_bf16 a[80:83], a[136:139], v[216:219], a[80:83]
    buffer_load_dwordx4 v26, s[8:11], s48 offen lds
    v_mfma_f32_16x16x32_bf16 a[88:91], a[136:139], v[220:223], a[88:91]
    v_exp_f32 v172, v172
    v_mfma_f32_16x16x32_bf16 a[84:87], a[140:143], v[216:219], a[84:87]
    v_cvt_pk_bf16_f32 v61, v170, v171
    v_cvt_pk_bf16_f32 v240, v240, v241
    v_mfma_f32_16x16x32_bf16 a[92:95], a[140:143], v[220:223], a[92:95]
    v_exp_f32 v173, v173
    v_mfma_f32_16x16x32_bf16 a[96:99], a[144:147], v[216:219], a[96:99]
    buffer_load_dwordx4 v27, s[8:11], s48 offen offset:1024 lds
    v_mfma_f32_16x16x32_bf16 a[104:107], a[144:147], v[220:223], a[104:107]
    v_exp_f32 v174, v174
    v_mfma_f32_16x16x32_bf16 a[100:103], a[148:151], v[216:219], a[100:103]
    v_cvt_pk_bf16_f32 v62, v172, v173
    v_cvt_pk_bf16_f32 v241, v242, v243
    v_mfma_f32_16x16x32_bf16 a[108:111], a[148:151], v[220:223], a[108:111]
    v_exp_f32 v175, v175
    v_mfma_f32_16x16x32_bf16 a[112:115], a[152:155], v[216:219], a[112:115]
    s_waitcnt vmcnt(15) lgkmcnt(0)
    v_cvt_pk_bf16_f32 v242, v244, v245
    v_mfma_f32_16x16x32_bf16 a[120:123], a[152:155], v[220:223], a[120:123]
    s_barrier
    v_cvt_pk_bf16_f32 v243, v246, v247
    v_mfma_f32_16x16x32_bf16 a[116:119], a[156:159], v[216:219], a[116:119]
    v_cvt_pk_bf16_f32 v63, v174, v175
    v_mfma_f32_16x16x32_bf16 a[124:127], a[156:159], v[220:223], a[124:127]
    buffer_store_dwordx4 v[240:243], v13, s[36:39], s25 offen sc1
    v_mfma_f32_16x16x32_bf16 v[160:163], a[160:163], v[64:67], v[224:227]
    v_exp_f32 v176, v176
    v_mfma_f32_16x16x32_bf16 v[168:171], a[160:163], v[68:71], v[228:231]
    v_exp_f32 v177, v177
    v_mfma_f32_16x16x32_bf16 v[164:167], a[164:167], v[64:67], v[224:227]
    ds_read_b64_tr_b16 a[128:129], v22 offset:16384
    ds_read_b64_tr_b16 a[130:131], v22 offset:18432
    v_mfma_f32_16x16x32_bf16 v[172:175], a[164:167], v[68:71], v[228:231]
    v_exp_f32 v178, v178
    v_mfma_f32_16x16x32_bf16 v[160:163], a[168:171], v[80:83], v[160:163]
    ds_read_b64_tr_b16 a[132:133], v23 offset:16384
    v_cvt_pk_bf16_f32 v216, v176, v177
    v_mfma_f32_16x16x32_bf16 v[168:171], a[168:171], v[84:87], v[168:171]
    v_exp_f32 v179, v179
    v_mfma_f32_16x16x32_bf16 v[164:167], a[172:175], v[80:83], v[164:167]
    ds_read_b64_tr_b16 a[134:135], v23 offset:18432
    ds_read_b64_tr_b16 a[136:137], v24 offset:16384
    v_mfma_f32_16x16x32_bf16 v[172:175], a[172:175], v[84:87], v[172:175]
    v_exp_f32 v180, v180
    v_mfma_f32_16x16x32_bf16 v[160:163], a[176:179], v[96:99], v[160:163]
    ds_read_b64_tr_b16 a[138:139], v24 offset:18432
    v_cvt_pk_bf16_f32 v217, v178, v179
    v_mfma_f32_16x16x32_bf16 v[168:171], a[176:179], v[100:103], v[168:171]
    v_exp_f32 v181, v181
    v_mfma_f32_16x16x32_bf16 v[164:167], a[180:183], v[96:99], v[164:167]
    ds_read_b64_tr_b16 a[140:141], v25 offset:16384
    ds_read_b64_tr_b16 a[142:143], v25 offset:18432
    v_mfma_f32_16x16x32_bf16 v[172:175], a[180:183], v[100:103], v[172:175]
    v_exp_f32 v182, v182
    v_mfma_f32_16x16x32_bf16 v[160:163], a[184:187], v[112:115], v[160:163]
    ds_read_b64_tr_b16 a[144:145], v22 offset:20480
    v_cvt_pk_bf16_f32 v218, v180, v181
    v_mfma_f32_16x16x32_bf16 v[168:171], a[184:187], v[116:119], v[168:171]
    v_exp_f32 v183, v183
    v_mfma_f32_16x16x32_bf16 v[164:167], a[188:191], v[112:115], v[164:167]
    ds_read_b64_tr_b16 a[146:147], v22 offset:22528
    ds_read_b64_tr_b16 a[148:149], v23 offset:20480
    v_mfma_f32_16x16x32_bf16 v[172:175], a[188:191], v[116:119], v[172:175]
    v_exp_f32 v184, v184
    v_mfma_f32_16x16x32_bf16 v[192:195], a[160:163], v[72:75], v[232:235]
    ds_read_b64_tr_b16 a[150:151], v23 offset:22528
    v_cvt_pk_bf16_f32 v219, v182, v183
    v_mfma_f32_16x16x32_bf16 v[200:203], a[160:163], v[76:79], v[236:239]
    v_exp_f32 v185, v185
    v_mfma_f32_16x16x32_bf16 v[196:199], a[164:167], v[72:75], v[232:235]
    ds_read_b64_tr_b16 a[152:153], v24 offset:20480
    ds_read_b64_tr_b16 a[154:155], v24 offset:22528
    v_mfma_f32_16x16x32_bf16 v[204:207], a[164:167], v[76:79], v[236:239]
    v_exp_f32 v186, v186
    v_mfma_f32_16x16x32_bf16 v[192:195], a[168:171], v[88:91], v[192:195]
    ds_read_b64_tr_b16 a[156:157], v25 offset:20480
    v_cvt_pk_bf16_f32 v220, v184, v185
    v_mfma_f32_16x16x32_bf16 v[200:203], a[168:171], v[92:95], v[200:203]
    v_exp_f32 v187, v187
    v_mfma_f32_16x16x32_bf16 v[196:199], a[172:175], v[88:91], v[196:199]
    ds_read_b64_tr_b16 a[158:159], v25 offset:22528
    v_accvgpr_read_b32 v240, a240
    v_mfma_f32_16x16x32_bf16 v[204:207], a[172:175], v[92:95], v[204:207]
    v_exp_f32 v188, v188
    v_mfma_f32_16x16x32_bf16 v[192:195], a[176:179], v[104:107], v[192:195]
    v_cvt_pk_bf16_f32 v221, v186, v187
    v_accvgpr_read_b32 v241, a241
    v_mfma_f32_16x16x32_bf16 v[200:203], a[176:179], v[108:111], v[200:203]
    v_exp_f32 v189, v189
    v_mfma_f32_16x16x32_bf16 v[196:199], a[180:183], v[104:107], v[196:199]
    buffer_store_dwordx4 v[40:43], v31, s[36:39], s24 offen sc1
    v_mfma_f32_16x16x32_bf16 v[204:207], a[180:183], v[108:111], v[204:207]
    v_exp_f32 v190, v190
    v_mfma_f32_16x16x32_bf16 v[192:195], a[184:187], v[120:123], v[192:195]
    v_cvt_pk_bf16_f32 v222, v188, v189
    v_accvgpr_read_b32 v242, a242
    v_mfma_f32_16x16x32_bf16 v[200:203], a[184:187], v[124:127], v[200:203]
    v_exp_f32 v191, v191
    v_mfma_f32_16x16x32_bf16 v[196:199], a[188:191], v[120:123], v[196:199]
    v_accvgpr_read_b32 v243, a243
    v_accvgpr_read_b32 v244, a244
    v_mfma_f32_16x16x32_bf16 v[204:207], a[188:191], v[124:127], v[204:207]
L_pg6:
    s_cbranch_execz L_pg10
    v_cvt_pk_bf16_f32 v223, v190, v191
    v_accvgpr_read_b32 v245, a245
    v_mfma_f32_16x16x32_bf16 v[44:47], v[36:39], v[56:59], v[44:47]
    v_accvgpr_read_b32 v246, a246
    v_accvgpr_read_b32 v247, a247
    v_mfma_f32_16x16x32_bf16 v[248:251], v[36:39], v[60:63], v[248:251]
    s_waitcnt lgkmcnt(0)
    v_exp_f32 v160, v160
    v_mfma_f32_16x16x32_bf16 a[0:3], a[128:131], v[56:59], a[0:3]
    ds_read_b128 a[160:163], v18 offset:0
    ds_read_b128 a[164:167], v18 offset:4096
    v_mfma_f32_16x16x32_bf16 a[8:11], a[128:131], v[60:63], a[8:11]
    v_exp_f32 v161, v161
    v_mfma_f32_16x16x32_bf16 a[4:7], a[132:135], v[56:59], a[4:7]
    ds_read_b128 a[168:171], v19 offset:0
    ds_read_b128 a[172:175], v19 offset:4096
    v_mfma_f32_16x16x32_bf16 a[12:15], a[132:135], v[60:63], a[12:15]
    v_exp_f32 v162, v162
    v_mfma_f32_16x16x32_bf16 a[16:19], a[136:139], v[56:59], a[16:19]
    ds_read_b128 a[176:179], v20 offset:0
    v_cvt_pk_bf16_f32 v208, v160, v161
    v_mfma_f32_16x16x32_bf16 a[24:27], a[136:139], v[60:63], a[24:27]
    v_exp_f32 v163, v163
    v_mfma_f32_16x16x32_bf16 a[20:23], a[140:143], v[56:59], a[20:23]
    ds_read_b128 a[180:183], v20 offset:4096
    ds_read_b128 a[184:187], v21 offset:0
    v_mfma_f32_16x16x32_bf16 a[28:31], a[140:143], v[60:63], a[28:31]
    v_exp_f32 v164, v164
    v_mfma_f32_16x16x32_bf16 a[32:35], a[144:147], v[56:59], a[32:35]
    ds_read_b128 a[188:191], v21 offset:4096
    v_cvt_pk_bf16_f32 v209, v162, v163
    v_mfma_f32_16x16x32_bf16 a[40:43], a[144:147], v[60:63], a[40:43]
    v_exp_f32 v165, v165
    v_mfma_f32_16x16x32_bf16 a[36:39], a[148:151], v[56:59], a[36:39]
    buffer_store_dwordx4 v[152:155], v12, s[36:39], s26 offen sc1
    v_mfma_f32_16x16x32_bf16 a[44:47], a[148:151], v[60:63], a[44:47]
    v_exp_f32 v166, v166
    v_mfma_f32_16x16x32_bf16 a[48:51], a[152:155], v[56:59], a[48:51]
    s_add_u32 m0, s50, 8192
    s_mov_b32 s48, 73728
    v_cvt_pk_bf16_f32 v210, v164, v165
    v_mfma_f32_16x16x32_bf16 a[56:59], a[152:155], v[60:63], a[56:59]
    v_exp_f32 v167, v167
    v_mfma_f32_16x16x32_bf16 a[52:55], a[156:159], v[56:59], a[52:55]
    buffer_load_dwordx4 v28, s[12:15], s48 offen lds
    v_mfma_f32_16x16x32_bf16 a[60:63], a[156:159], v[60:63], a[60:63]
    v_exp_f32 v168, v168
    v_mfma_f32_16x16x32_bf16 v[252:255], v[36:39], v[216:219], v[252:255]
    v_cvt_pk_bf16_f32 v211, v166, v167
    v_cvt_pk_bf16_f32 v240, v240, v241
    v_mfma_f32_16x16x32_bf16 v[32:35], v[36:39], v[220:223], v[32:35]
    v_exp_f32 v169, v169
    v_mfma_f32_16x16x32_bf16 a[64:67], a[128:131], v[216:219], a[64:67]
    buffer_load_dwordx4 v29, s[12:15], s48 offen offset:1024 lds
    v_mfma_f32_16x16x32_bf16 a[72:75], a[128:131], v[220:223], a[72:75]
    v_exp_f32 v170, v170
    v_mfma_f32_16x16x32_bf16 a[68:71], a[132:135], v[216:219], a[68:71]
    s_add_u32 m0, s50, 57344
    s_mov_b32 s48, 90112
    v_cvt_pk_bf16_f32 v212, v168, v169
    v_mfma_f32_16x16x32_bf16 a[76:79], a[132:135], v[220:223], a[76:79]
    v_exp_f32 v171, v171
    v_mfma_f32_16x16x32_bf16 a[80:83], a[136:139], v[216:219], a[80:83]
    buffer_load_dwordx4 v26, s[8:11], s48 offen lds
    v_mfma_f32_16x16x32_bf16 a[88:91], a[136:139], v[220:223], a[88:91]
    v_exp_f32 v172, v172
    v_mfma_f32_16x16x32_bf16 a[84:87], a[140:143], v[216:219], a[84:87]
    v_cvt_pk_bf16_f32 v213, v170, v171
    v_cvt_pk_bf16_f32 v241, v242, v243
    v_mfma_f32_16x16x32_bf16 a[92:95], a[140:143], v[220:223], a[92:95]
    v_exp_f32 v173, v173
    v_mfma_f32_16x16x32_bf16 a[96:99], a[144:147], v[216:219], a[96:99]
    buffer_load_dwordx4 v27, s[8:11], s48 offen offset:1024 lds
    v_mfma_f32_16x16x32_bf16 a[104:107], a[144:147], v[220:223], a[104:107]
    v_exp_f32 v174, v174
    v_mfma_f32_16x16x32_bf16 a[100:103], a[148:151], v[216:219], a[100:103]
    v_cvt_pk_bf16_f32 v214, v172, v173
    v_cvt_pk_bf16_f32 v242, v244, v245
    v_mfma_f32_16x16x32_bf16 a[108:111], a[148:151], v[220:223], a[108:111]
    v_exp_f32 v175, v175
    v_mfma_f32_16x16x32_bf16 a[112:115], a[152:155], v[216:219], a[112:115]
    s_waitcnt vmcnt(15) lgkmcnt(0)
    v_cvt_pk_bf16_f32 v243, v246, v247
    v_mfma_f32_16x16x32_bf16 a[120:123], a[152:155], v[220:223], a[120:123]
    s_barrier
    v_mfma_f32_16x16x32_bf16 a[116:119], a[156:159], v[216:219], a[116:119]
    v_cvt_pk_bf16_f32 v215, v174, v175
    v_mfma_f32_16x16x32_bf16 a[124:127], a[156:159], v[220:223], a[124:127]
    buffer_store_dwordx4 v[240:243], v13, s[36:39], s26 offen sc1
    v_mfma_f32_16x16x32_bf16 v[160:163], a[160:163], v[64:67], v[224:227]
    v_exp_f32 v192, v192
    v_mfma_f32_16x16x32_bf16 v[168:171], a[160:163], v[68:71], v[228:231]
    v_exp_f32 v193, v193
    v_mfma_f32_16x16x32_bf16 v[164:167], a[164:167], v[64:67], v[224:227]
    ds_read_b64_tr_b16 a[128:129], v22 offset:24576
    ds_read_b64_tr_b16 a[130:131], v22 offset:26624
    v_mfma_f32_16x16x32_bf16 v[172:175], a[164:167], v[68:71], v[228:231]
    v_exp_f32 v194, v194
    v_mfma_f32_16x16x32_bf16 v[160:163], a[168:171], v[80:83], v[160:163]
    ds_read_b64_tr_b16 a[132:133], v23 offset:24576
    v_cvt_pk_bf16_f32 v216, v192, v193
    v_mfma_f32_16x16x32_bf16 v[168:171], a[168:171], v[84:87], v[168:171]
    v_exp_f32 v195, v195
    v_mfma_f32_16x16x32_bf16 v[164:167], a[172:175], v[80:83], v[164:167]
    ds_read_b64_tr_b16 a[134:135], v23 offset:26624
    ds_read_b64_tr_b16 a[136:137], v24 offset:24576
    v_mfma_f32_16x16x32_bf16 v[172:175], a[172:175], v[84:87], v[172:175]
    v_exp_f32 v196, v196
    v_mfma_f32_16x16x32_bf16 v[160:163], a[176:179], v[96:99], v[160:163]
    ds_read_b64_tr_b16 a[138:139], v24 offset:26624
    v_cvt_pk_bf16_f32 v217, v194, v195
    v_mfma_f32_16x16x32_bf16 v[168:171], a[176:179], v[100:103], v[168:171]
    v_exp_f32 v197, v197
    v_mfma_f32_16x16x32_bf16 v[164:167], a[180:183], v[96:99], v[164:167]
    ds_read_b64_tr_b16 a[140:141], v25 offset:24576
    ds_read_b64_tr_b16 a[142:143], v25 offset:26624
    v_mfma_f32_16x16x32_bf16 v[172:175], a[180:183], v[100:103], v[172:175]
    v_exp_f32 v198, v198
    v_mfma_f32_16x16x32_bf16 v[160:163], a[184:187], v[112:115], v[160:163]
    ds_read_b64_tr_b16 a[144:145], v22 offset:28672
    v_cvt_pk_bf16_f32 v218, v196, v197
    v_mfma_f32_16x16x32_bf16 v[168:171], a[184:187], v[116:119], v[168:171]
    v_exp_f32 v199, v199
    v_mfma_f32_16x16x32_bf16 v[164:167], a[188:191], v[112:115], v[164:167]
    ds_read_b64_tr_b16 a[146:147], v22 offset:30720
    ds_read_b64_tr_b16 a[148:149], v23 offset:28672
    v_mfma_f32_16x16x32_bf16 v[172:175], a[188:191], v[116:119], v[172:175]
    v_exp_f32 v200, v200
    v_mfma_f32_16x16x32_bf16 v[176:179], a[160:163], v[72:75], v[232:235]
    ds_read_b64_tr_b16 a[150:151], v23 offset:30720
    v_cvt_pk_bf16_f32 v219, v198, v199
    v_mfma_f32_16x16x32_bf16 v[184:187], a[160:163], v[76:79], v[236:239]
    v_exp_f32 v201, v201
    v_mfma_f32_16x16x32_bf16 v[180:183], a[164:167], v[72:75], v[232:235]
    ds_read_b64_tr_b16 a[152:153], v24 offset:28672
    ds_read_b64_tr_b16 a[154:155], v24 offset:30720
    v_mfma_f32_16x16x32_bf16 v[188:191], a[164:167], v[76:79], v[236:239]
    v_exp_f32 v202, v202
    v_mfma_f32_16x16x32_bf16 v[176:179], a[168:171], v[88:91], v[176:179]
    ds_read_b64_tr_b16 a[156:157], v25 offset:28672
    v_cvt_pk_bf16_f32 v220, v200, v201
    v_mfma_f32_16x16x32_bf16 v[184:187], a[168:171], v[92:95], v[184:187]
    v_exp_f32 v203, v203
    v_mfma_f32_16x16x32_bf16 v[180:183], a[172:175], v[88:91], v[180:183]
    ds_read_b64_tr_b16 a[158:159], v25 offset:30720
    s_add_u32 m0, s43, 0
    v_mfma_f32_16x16x32_bf16 v[188:191], a[172:175], v[92:95], v[188:191]
    v_exp_f32 v204, v204
    v_mfma_f32_16x16x32_bf16 v[176:179], a[176:179], v[104:107], v[176:179]
    s_mov_b32 s44, 0
    v_cvt_pk_bf16_f32 v221, v202, v203
    v_mfma_f32_16x16x32_bf16 v[184:187], a[176:179], v[108:111], v[184:187]
    v_exp_f32 v205, v205
    v_mfma_f32_16x16x32_bf16 v[180:183], a[180:183], v[104:107], v[180:183]
    buffer_load_dwordx4 v14, s[20:23], s44 offen offset:0 lds
    v_mfma_f32_16x16x32_bf16 v[188:191], a[180:183], v[108:111], v[188:191]
    v_exp_f32 v206, v206
    v_mfma_f32_16x16x32_bf16 v[176:179], a[184:187], v[120:123], v[176:179]
    buffer_load_dwordx4 v15, s[20:23], s44 offen offset:1024 lds
    v_cvt_pk_bf16_f32 v222, v204, v205
    v_mfma_f32_16x16x32_bf16 v[184:187], a[184:187], v[124:127], v[184:187]
    v_exp_f32 v207, v207
    v_mfma_f32_16x16x32_bf16 v[180:183], a[188:191], v[120:123], v[180:183]
    buffer_load_dwordx4 v16, s[20:23], s44 offen offset:2048 lds
    v_mfma_f32_16x16x32_bf16 v[188:191], a[188:191], v[124:127], v[188:191]
    buffer_load_dwordx4 v17, s[20:23], s44 offen offset:3072 lds
    v_cvt_pk_bf16_f32 v223, v206, v207
    v_mfma_f32_16x16x32_bf16 v[44:47], v[36:39], v[208:211], v[44:47]
    v_accvgpr_read_b32 v240, a248
    v_accvgpr_read_b32 v241, a249
    v_mfma_f32_16x16x32_bf16 v[248:251], v[36:39], v[212:215], v[248:251]
    s_waitcnt lgkmcnt(0)
    v_exp_f32 v160, v160
    v_mfma_f32_16x16x32_bf16 a[0:3], a[128:131], v[208:211], a[0:3]
    ds_read_b128 a[160:163], v18 offset:8192
    ds_read_b128 a[164:167], v18 offset:12288
    v_mfma_f32_16x16x32_bf16 a[8:11], a[128:131], v[212:215], a[8:11]
    v_exp_f32 v161, v161
    v_mfma_f32_16x16x32_bf16 a[4:7], a[132:135], v[208:211], a[4:7]
    ds_read_b128 a[168:171], v19 offset:8192
    ds_read_b128 a[172:175], v19 offset:12288
    v_mfma_f32_16x16x32_bf16 a[12:15], a[132:135], v[212:215], a[12:15]
    v_exp_f32 v162, v162
    v_mfma_f32_16x16x32_bf16 a[16:19], a[136:139], v[208:211], a[16:19]
    ds_read_b128 a[176:179], v20 offset:8192
    v_cvt_pk_bf16_f32 v56, v160, v161
    v_mfma_f32_16x16x32_bf16 a[24:27], a[136:139], v[212:215], a[24:27]
    v_exp_f32 v163, v163
    v_mfma_f32_16x16x32_bf16 a[20:23], a[140:143], v[208:211], a[20:23]
    ds_read_b128 a[180:183], v20 offset:12288
    ds_read_b128 a[184:187], v21 offset:8192
    v_mfma_f32_16x16x32_bf16 a[28:31], a[140:143], v[212:215], a[28:31]
    v_exp_f32 v164, v164
    v_mfma_f32_16x16x32_bf16 a[32:35], a[144:147], v[208:211], a[32:35]
    ds_read_b128 a[188:191], v21 offset:12288
    v_cvt_pk_bf16_f32 v57, v162, v163
    v_mfma_f32_16x16x32_bf16 a[40:43], a[144:147], v[212:215], a[40:43]
    v_exp_f32 v165, v165
    v_mfma_f32_16x16x32_bf16 a[36:39], a[148:151], v[208:211], a[36:39]
    buffer_store_dwordx4 v[40:43], v31, s[36:39], s25 offen sc1
    v_mfma_f32_16x16x32_bf16 a[44:47], a[148:151], v[212:215], a[44:47]
    v_exp_f32 v166, v166
    v_mfma_f32_16x16x32_bf16 a[48:51], a[152:155], v[208:211], a[48:51]
    s_add_u32 m0, s50, 16384
    s_mov_b32 s48, 81920
    v_cvt_pk_bf16_f32 v58, v164, v165
    v_mfma_f32_16x16x32_bf16 a[56:59], a[152:155], v[212:215], a[56:59]
    v_exp_f32 v167, v167
    v_mfma_f32_16x16x32_bf16 a[52:55], a[156:159], v[208:211], a[52:55]
    buffer_load_dwordx4 v28, s[12:15], s48 offen lds
    v_mfma_f32_16x16x32_bf16 a[60:63], a[156:159], v[212:215], a[60:63]
    v_exp_f32 v168, v168
    v_mfma_f32_16x16x32_bf16 v[252:255], v[36:39], v[216:219], v[252:255]
    v_cvt_pk_bf16_f32 v59, v166, v167
    v_accvgpr_read_b32 v242, a250
    v_mfma_f32_16x16x32_bf16 v[32:35], v[36:39], v[220:223], v[32:35]
    v_exp_f32 v169, v169
    v_mfma_f32_16x16x32_bf16 a[64:67], a[128:131], v[216:219], a[64:67]
    buffer_load_dwordx4 v29, s[12:15], s48 offen offset:1024 lds
    v_mfma_f32_16x16x32_bf16 a[72:75], a[128:131], v[220:223], a[72:75]
    v_exp_f32 v170, v170
    v_mfma_f32_16x16x32_bf16 a[68:71], a[132:135], v[216:219], a[68:71]
    s_add_u32 m0, s50, 32768
    s_mov_b32 s48, 98304
    v_cvt_pk_bf16_f32 v60, v168, v169
    v_mfma_f32_16x16x32_bf16 a[76:79], a[132:135], v[220:223], a[76:79]
    v_exp_f32 v171, v171
    v_mfma_f32_16x16x32_bf16 a[80:83], a[136:139], v[216:219], a[80:83]
    buffer_load_dwordx4 v26, s[8:11], s48 offen lds
    v_mfma_f32_16x16x32_bf16 a[88:91], a[136:139], v[220:223], a[88:91]
    v_exp_f32 v172, v172
    v_mfma_f32_16x16x32_bf16 a[84:87], a[140:143], v[216:219], a[84:87]
    v_cvt_pk_bf16_f32 v61, v170, v171
    v_accvgpr_read_b32 v243, a251
    v_mfma_f32_16x16x32_bf16 a[92:95], a[140:143], v[220:223], a[92:95]
    v_exp_f32 v173, v173
    v_mfma_f32_16x16x32_bf16 a[96:99], a[144:147], v[216:219], a[96:99]
    buffer_load_dwordx4 v27, s[8:11], s48 offen offset:1024 lds
    v_mfma_f32_16x16x32_bf16 a[104:107], a[144:147], v[220:223], a[104:107]
    v_exp_f32 v174, v174
    v_mfma_f32_16x16x32_bf16 a[100:103], a[148:151], v[216:219], a[100:103]
    v_cvt_pk_bf16_f32 v62, v172, v173
    v_accvgpr_read_b32 v244, a252
    v_mfma_f32_16x16x32_bf16 a[108:111], a[148:151], v[220:223], a[108:111]
    v_exp_f32 v175, v175
    v_mfma_f32_16x16x32_bf16 a[112:115], a[152:155], v[216:219], a[112:115]
    s_waitcnt vmcnt(17) lgkmcnt(0)
    v_accvgpr_read_b32 v245, a253
    v_mfma_f32_16x16x32_bf16 a[120:123], a[152:155], v[220:223], a[120:123]
    s_barrier
    v_accvgpr_read_b32 v246, a254
    v_mfma_f32_16x16x32_bf16 a[116:119], a[156:159], v[216:219], a[116:119]
    v_cvt_pk_bf16_f32 v63, v174, v175
    v_accvgpr_read_b32 v247, a255
    v_cvt_pk_bf16_f32 v240, v240, v241
    v_cvt_pk_bf16_f32 v241, v242, v243
    v_cvt_pk_bf16_f32 v242, v244, v245
    v_cvt_pk_bf16_f32 v243, v246, v247
    v_mfma_f32_16x16x32_bf16 a[124:127], a[156:159], v[220:223], a[124:127]
    buffer_store_dwordx4 v[240:243], v13, s[36:39], s27 offen sc1
    v_mfma_f32_16x16x32_bf16 v[160:163], a[160:163], v[64:67], v[224:227]
    v_exp_f32 v176, v176
    v_mfma_f32_16x16x32_bf16 v[168:171], a[160:163], v[68:71], v[228:231]
    v_exp_f32 v177, v177
    v_mfma_f32_16x16x32_bf16 v[164:167], a[164:167], v[64:67], v[224:227]
    ds_read_b64_tr_b16 a[128:129], v22 offset:0
    ds_read_b64_tr_b16 a[130:131], v22 offset:2048
    v_mfma_f32_16x16x32_bf16 v[172:175], a[164:167], v[68:71], v[228:231]
    v_exp_f32 v178, v178
    v_mfma_f32_16x16x32_bf16 v[160:163], a[168:171], v[80:83], v[160:163]
    ds_read_b64_tr_b16 a[132:133], v23 offset:0
    v_cvt_pk_bf16_f32 v216, v176, v177
    v_mfma_f32_16x16x32_bf16 v[168:171], a[168:171], v[84:87], v[168:171]
    v_exp_f32 v179, v179
    v_mfma_f32_16x16x32_bf16 v[164:167], a[172:175], v[80:83], v[164:167]
    ds_read_b64_tr_b16 a[134:135], v23 offset:2048
    ds_read_b64_tr_b16 a[136:137], v24 offset:0
    v_mfma_f32_16x16x32_bf16 v[172:175], a[172:175], v[84:87], v[172:175]
    v_exp_f32 v180, v180
    v_mfma_f32_16x16x32_bf16 v[160:163], a[176:179], v[96:99], v[160:163]
    ds_read_b64_tr_b16 a[138:139], v24 offset:2048
    v_cvt_pk_bf16_f32 v217, v178, v179
    v_mfma_f32_16x16x32_bf16 v[168:171], a[176:179], v[100:103], v[168:171]
    v_exp_f32 v181, v181
    v_mfma_f32_16x16x32_bf16 v[164:167], a[180:183], v[96:99], v[164:167]
    ds_read_b64_tr_b16 a[140:141], v25 offset:0
    ds_read_b64_tr_b16 a[142:143], v25 offset:2048
    v_mfma_f32_16x16x32_bf16 v[172:175], a[180:183], v[100:103], v[172:175]
    v_exp_f32 v182, v182
    v_mfma_f32_16x16x32_bf16 v[160:163], a[184:187], v[112:115], v[160:163]
    ds_read_b64_tr_b16 a[144:145], v22 offset:4096
    v_cvt_pk_bf16_f32 v218, v180, v181
    v_mfma_f32_16x16x32_bf16 v[168:171], a[184:187], v[116:119], v[168:171]
    v_exp_f32 v183, v183
    v_mfma_f32_16x16x32_bf16 v[164:167], a[188:191], v[112:115], v[164:167]
    ds_read_b64_tr_b16 a[146:147], v22 offset:6144
    ds_read_b64_tr_b16 a[148:149], v23 offset:4096
    v_mfma_f32_16x16x32_bf16 v[172:175], a[188:191], v[116:119], v[172:175]
    v_exp_f32 v184, v184
    v_mfma_f32_16x16x32_bf16 v[192:195], a[160:163], v[72:75], v[232:235]
    ds_read_b64_tr_b16 a[150:151], v23 offset:6144
    v_cvt_pk_bf16_f32 v219, v182, v183
    v_mfma_f32_16x16x32_bf16 v[200:203], a[160:163], v[76:79], v[236:239]
    v_exp_f32 v185, v185
    v_mfma_f32_16x16x32_bf16 v[196:199], a[164:167], v[72:75], v[232:235]
    ds_read_b64_tr_b16 a[152:153], v24 offset:4096
    ds_read_b64_tr_b16 a[154:155], v24 offset:6144
    v_mfma_f32_16x16x32_bf16 v[204:207], a[164:167], v[76:79], v[236:239]
    v_exp_f32 v186, v186
    v_mfma_f32_16x16x32_bf16 v[192:195], a[168:171], v[88:91], v[192:195]
    ds_read_b64_tr_b16 a[156:157], v25 offset:4096
    v_cvt_pk_bf16_f32 v220, v184, v185
    v_mfma_f32_16x16x32_bf16 v[200:203], a[168:171], v[92:95], v[200:203]
    v_exp_f32 v187, v187
    v_mfma_f32_16x16x32_bf16 v[196:199], a[172:175], v[88:91], v[196:199]
    ds_read_b64_tr_b16 a[158:159], v25 offset:6144
    s_add_u32 m0, s43, 4096
    v_mfma_f32_16x16x32_bf16 v[204:207], a[172:175], v[92:95], v[204:207]
    v_exp_f32 v188, v188
    v_mfma_f32_16x16x32_bf16 v[192:195], a[176:179], v[104:107], v[192:195]
    s_mov_b32 s44, 32768
    v_cvt_pk_bf16_f32 v221, v186, v187
    v_mfma_f32_16x16x32_bf16 v[200:203], a[176:179], v[108:111], v[200:203]
    v_exp_f32 v189, v189
    v_mfma_f32_16x16x32_bf16 v[196:199], a[180:183], v[104:107], v[196:199]
    buffer_load_dwordx4 v14, s[20:23], s44 offen offset:0 lds
    v_mfma_f32_16x16x32_bf16 v[204:207], a[180:183], v[108:111], v[204:207]
    v_exp_f32 v190, v190
    v_mfma_f32_16x16x32_bf16 v[192:195], a[184:187], v[120:123], v[192:195]
    buffer_load_dwordx4 v15, s[20:23], s44 offen offset:1024 lds
    v_cvt_pk_bf16_f32 v222, v188, v189
    v_mfma_f32_16x16x32_bf16 v[200:203], a[184:187], v[124:127], v[200:203]
    v_exp_f32 v191, v191
    v_mfma_f32_16x16x32_bf16 v[196:199], a[188:191], v[120:123], v[196:199]
    buffer_load_dwordx4 v16, s[20:23], s44 offen offset:2048 lds
    v_mfma_f32_16x16x32_bf16 v[204:207], a[188:191], v[124:127], v[204:207]
    buffer_load_dwordx4 v17, s[20:23], s44 offen offset:3072 lds
    v_cvt_pk_bf16_f32 v223, v190, v191
    v_mfma_f32_16x16x32_bf16 v[44:47], v[36:39], v[56:59], v[44:47]
    v_mfma_f32_16x16x32_bf16 v[248:251], v[36:39], v[60:63], v[248:251]
    s_waitcnt lgkmcnt(0)
    v_exp_f32 v160, v160
    v_mfma_f32_16x16x32_bf16 a[0:3], a[128:131], v[56:59], a[0:3]
    ds_read_b128 a[160:163], v18 offset:16384
    ds_read_b128 a[164:167], v18 offset:20480
    v_mfma_f32_16x16x32_bf16 a[8:11], a[128:131], v[60:63], a[8:11]
    v_exp_f32 v161, v161
    v_mfma_f32_16x16x32_bf16 a[4:7], a[132:135], v[56:59], a[4:7]
    ds_read_b128 a[168:171], v19 offset:16384
    ds_read_b128 a[172:175], v19 offset:20480
    v_mfma_f32_16x16x32_bf16 a[12:15], a[132:135], v[60:63], a[12:15]
    v_exp_f32 v162, v162
    v_mfma_f32_16x16x32_bf16 a[16:19], a[136:139], v[56:59], a[16:19]
    ds_read_b128 a[176:179], v20 offset:16384
    v_cvt_pk_bf16_f32 v208, v160, v161
    v_mfma_f32_16x16x32_bf16 a[24:27], a[136:139], v[60:63], a[24:27]
    v_exp_f32 v163, v163
    v_mfma_f32_16x16x32_bf16 a[20:23], a[140:143], v[56:59], a[20:23]
    ds_read_b128 a[180:183], v20 offset:20480
    ds_read_b128 a[184:187], v21 offset:16384
    v_mfma_f32_16x16x32_bf16 a[28:31], a[140:143], v[60:63], a[28:31]
    v_exp_f32 v164, v164
    v_mfma_f32_16x16x32_bf16 a[32:35], a[144:147], v[56:59], a[32:35]
    ds_read_b128 a[188:191], v21 offset:20480
    v_cvt_pk_bf16_f32 v209, v162, v163
    v_mfma_f32_16x16x32_bf16 a[40:43], a[144:147], v[60:63], a[40:43]
    v_exp_f32 v165, v165
    v_mfma_f32_16x16x32_bf16 a[36:39], a[148:151], v[56:59], a[36:39]
    buffer_store_dwordx4 v[156:159], v12, s[36:39], s27 offen sc1
    v_mfma_f32_16x16x32_bf16 a[44:47], a[148:151], v[60:63], a[44:47]
    v_exp_f32 v166, v166
    v_mfma_f32_16x16x32_bf16 a[48:51], a[152:155], v[56:59], a[48:51]
    s_add_u32 m0, s50, 24576
    s_mov_b32 s48, 90112
    v_cvt_pk_bf16_f32 v210, v164, v165
    v_mfma_f32_16x16x32_bf16 a[56:59], a[152:155], v[60:63], a[56:59]
    v_exp_f32 v167, v167
    v_mfma_f32_16x16x32_bf16 a[52:55], a[156:159], v[56:59], a[52:55]
    buffer_load_dwordx4 v28, s[12:15], s48 offen lds
    v_mfma_f32_16x16x32_bf16 a[60:63], a[156:159], v[60:63], a[60:63]
    v_exp_f32 v168, v168
    v_mfma_f32_16x16x32_bf16 v[252:255], v[36:39], v[216:219], v[252:255]
    v_cvt_pk_bf16_f32 v211, v166, v167
    v_mfma_f32_16x16x32_bf16 v[32:35], v[36:39], v[220:223], v[32:35]
    v_exp_f32 v169, v169
    v_mfma_f32_16x16x32_bf16 a[64:67], a[128:131], v[216:219], a[64:67]
    buffer_load_dwordx4 v29, s[12:15], s48 offen offset:1024 lds
    v_mfma_f32_16x16x32_bf16 a[72:75], a[128:131], v[220:223], a[72:75]
    v_exp_f32 v170, v170
    v_mfma_f32_16x16x32_bf16 a[68:71], a[132:135], v[216:219], a[68:71]
    s_add_u32 m0, s50, 40960
    s_mov_b32 s48, 106496
    v_cvt_pk_bf16_f32 v212, v168, v169
    v_mfma_f32_16x16x32_bf16 a[76:79], a[132:135], v[220:223], a[76:79]
    v_exp_f32 v171, v171
    v_mfma_f32_16x16x32_bf16 a[80:83], a[136:139], v[216:219], a[80:83]
    buffer_load_dwordx4 v26, s[8:11], s48 offen lds
    v_mfma_f32_16x16x32_bf16 a[88:91], a[136:139], v[220:223], a[88:91]
    v_exp_f32 v172, v172
    v_mfma_f32_16x16x32_bf16 a[84:87], a[140:143], v[216:219], a[84:87]
    v_cvt_pk_bf16_f32 v213, v170, v171
    v_mfma_f32_16x16x32_bf16 a[92:95], a[140:143], v[220:223], a[92:95]
    v_exp_f32 v173, v173
    v_mfma_f32_16x16x32_bf16 a[96:99], a[144:147], v[216:219], a[96:99]
    buffer_load_dwordx4 v27, s[8:11], s48 offen offset:1024 lds
    v_mfma_f32_16x16x32_bf16 a[104:107], a[144:147], v[220:223], a[104:107]
    v_exp_f32 v174, v174
    v_mfma_f32_16x16x32_bf16 a[100:103], a[148:151], v[216:219], a[100:103]
    v_cvt_pk_bf16_f32 v214, v172, v173
    v_mfma_f32_16x16x32_bf16 a[108:111], a[148:151], v[220:223], a[108:111]
    v_exp_f32 v175, v175
    v_mfma_f32_16x16x32_bf16 a[112:115], a[152:155], v[216:219], a[112:115]
    s_waitcnt vmcnt(20) lgkmcnt(0)
    v_mfma_f32_16x16x32_bf16 a[120:123], a[152:155], v[220:223], a[120:123]
    s_barrier
    v_mfma_f32_16x16x32_bf16 a[116:119], a[156:159], v[216:219], a[116:119]
    v_cvt_pk_bf16_f32 v215, v174, v175
    v_mfma_f32_16x16x32_bf16 a[124:127], a[156:159], v[220:223], a[124:127]
    buffer_store_dwordx4 v[40:43], v31, s[36:39], s26 offen sc1
    v_mfma_f32_16x16x32_bf16 v[160:163], a[160:163], v[64:67], v[224:227]
    v_exp_f32 v192, v192
    v_mfma_f32_16x16x32_bf16 v[168:171], a[160:163], v[68:71], v[228:231]
    v_exp_f32 v193, v193
    v_mfma_f32_16x16x32_bf16 v[164:167], a[164:167], v[64:67], v[224:227]
    ds_read_b64_tr_b16 a[128:129], v22 offset:8192
    ds_read_b64_tr_b16 a[130:131], v22 offset:10240
    v_mfma_f32_16x16x32_bf16 v[172:175], a[164:167], v[68:71], v[228:231]
    v_exp_f32 v194, v194
    v_mfma_f32_16x16x32_bf16 v[160:163], a[168:171], v[80:83], v[160:163]
    ds_read_b64_tr_b16 a[132:133], v23 offset:8192
    v_cvt_pk_bf16_f32 v216, v192, v193
    v_mfma_f32_16x16x32_bf16 v[168:171], a[168:171], v[84:87], v[168:171]
    v_exp_f32 v195, v195
    v_mfma_f32_16x16x32_bf16 v[164:167], a[172:175], v[80:83], v[164:167]
    ds_read_b64_tr_b16 a[134:135], v23 offset:10240
    ds_read_b64_tr_b16 a[136:137], v24 offset:8192
    v_mfma_f32_16x16x32_bf16 v[172:175], a[172:175], v[84:87], v[172:175]
    v_exp_f32 v196, v196
    v_mfma_f32_16x16x32_bf16 v[160:163], a[176:179], v[96:99], v[160:163]
    ds_read_b64_tr_b16 a[138:139], v24 offset:10240
    v_cvt_pk_bf16_f32 v217, v194, v195
    v_mfma_f32_16x16x32_bf16 v[168:171], a[176:179], v[100:103], v[168:171]
    v_exp_f32 v197, v197
    v_mfma_f32_16x16x32_bf16 v[164:167], a[180:183], v[96:99], v[164:167]
    ds_read_b64_tr_b16 a[140:141], v25 offset:8192
    ds_read_b64_tr_b16 a[142:143], v25 offset:10240
    v_mfma_f32_16x16x32_bf16 v[172:175], a[180:183], v[100:103], v[172:175]
    v_exp_f32 v198, v198
    v_mfma_f32_16x16x32_bf16 v[160:163], a[184:187], v[112:115], v[160:163]
    ds_read_b64_tr_b16 a[144:145], v22 offset:12288
    v_cvt_pk_bf16_f32 v218, v196, v197
    v_mfma_f32_16x16x32_bf16 v[168:171], a[184:187], v[116:119], v[168:171]
    v_exp_f32 v199, v199
    v_mfma_f32_16x16x32_bf16 v[164:167], a[188:191], v[112:115], v[164:167]
    ds_read_b64_tr_b16 a[146:147], v22 offset:14336
    ds_read_b64_tr_b16 a[148:149], v23 offset:12288
    v_mfma_f32_16x16x32_bf16 v[172:175], a[188:191], v[116:119], v[172:175]
    v_exp_f32 v200, v200
    v_mfma_f32_16x16x32_bf16 v[176:179], a[160:163], v[72:75], v[232:235]
    ds_read_b64_tr_b16 a[150:151], v23 offset:14336
    v_cvt_pk_bf16_f32 v219, v198, v199
    v_mfma_f32_16x16x32_bf16 v[184:187], a[160:163], v[76:79], v[236:239]
    v_exp_f32 v201, v201
    v_mfma_f32_16x16x32_bf16 v[180:183], a[164:167], v[72:75], v[232:235]
    ds_read_b64_tr_b16 a[152:153], v24 offset:12288
    ds_read_b64_tr_b16 a[154:155], v24 offset:14336
    v_mfma_f32_16x16x32_bf16 v[188:191], a[164:167], v[76:79], v[236:239]
    v_exp_f32 v202, v202
    v_mfma_f32_16x16x32_bf16 v[176:179], a[168:171], v[88:91], v[176:179]
    ds_read_b64_tr_b16 a[156:157], v25 offset:12288
    v_cvt_pk_bf16_f32 v220, v200, v201
    v_mfma_f32_16x16x32_bf16 v[184:187], a[168:171], v[92:95], v[184:187]
    v_exp_f32 v203, v203
    v_mfma_f32_16x16x32_bf16 v[180:183], a[172:175], v[88:91], v[180:183]
    ds_read_b64_tr_b16 a[158:159], v25 offset:14336
    s_add_u32 m0, s43, 8192
    v_mfma_f32_16x16x32_bf16 v[188:191], a[172:175], v[92:95], v[188:191]
    v_exp_f32 v204, v204
    v_mfma_f32_16x16x32_bf16 v[176:179], a[176:179], v[104:107], v[176:179]
    s_mov_b32 s44, 65536
    v_cvt_pk_bf16_f32 v221, v202, v203
    v_mfma_f32_16x16x32_bf16 v[184:187], a[176:179], v[108:111], v[184:187]
    v_exp_f32 v205, v205
    v_mfma_f32_16x16x32_bf16 v[180:183], a[180:183], v[104:107], v[180:183]
    buffer_load_dwordx4 v14, s[20:23], s44 offen offset:0 lds
    v_mfma_f32_16x16x32_bf16 v[188:191], a[180:183], v[108:111], v[188:191]
    v_exp_f32 v206, v206
    v_mfma_f32_16x16x32_bf16 v[176:179], a[184:187], v[120:123], v[176:179]
    buffer_load_dwordx4 v15, s[20:23], s44 offen offset:1024 lds
    v_cvt_pk_bf16_f32 v222, v204, v205
    v_mfma_f32_16x16x32_bf16 v[184:187], a[184:187], v[124:127], v[184:187]
    v_exp_f32 v207, v207
    v_mfma_f32_16x16x32_bf16 v[180:183], a[188:191], v[120:123], v[180:183]
    buffer_load_dwordx4 v16, s[20:23], s44 offen offset:2048 lds
    v_mfma_f32_16x16x32_bf16 v[188:191], a[188:191], v[124:127], v[188:191]
    buffer_load_dwordx4 v17, s[20:23], s44 offen offset:3072 lds
    v_cvt_pk_bf16_f32 v223, v206, v207
    v_mfma_f32_16x16x32_bf16 v[44:47], v[36:39], v[208:211], v[44:47]
    v_cmp_le_u32 vcc, 1, v54
    v_mfma_f32_16x16x32_bf16 v[248:251], v[36:39], v[212:215], v[248:251]
    s_waitcnt lgkmcnt(0)
    v_exp_f32 v160, v160
    v_mfma_f32_16x16x32_bf16 a[0:3], a[128:131], v[208:211], a[0:3]
    ds_read_b128 a[160:163], v18 offset:24576
    ds_read_b128 a[164:167], v18 offset:28672
    v_mfma_f32_16x16x32_bf16 a[8:11], a[128:131], v[212:215], a[8:11]
    v_exp_f32 v161, v161
    v_mfma_f32_16x16x32_bf16 a[4:7], a[132:135], v[208:211], a[4:7]
    ds_read_b128 a[168:171], v19 offset:24576
    ds_read_b128 a[172:175], v19 offset:28672
    v_mfma_f32_16x16x32_bf16 a[12:15], a[132:135], v[212:215], a[12:15]
    v_exp_f32 v162, v162
    v_mfma_f32_16x16x32_bf16 a[16:19], a[136:139], v[208:211], a[16:19]
    ds_read_b128 a[176:179], v20 offset:24576
    v_cvt_pk_bf16_f32 v56, v160, v161
    v_mfma_f32_16x16x32_bf16 a[24:27], a[136:139], v[212:215], a[24:27]
    v_exp_f32 v163, v163
    v_mfma_f32_16x16x32_bf16 a[20:23], a[140:143], v[208:211], a[20:23]
    ds_read_b128 a[180:183], v20 offset:28672
    ds_read_b128 a[184:187], v21 offset:24576
    v_mfma_f32_16x16x32_bf16 a[28:31], a[140:143], v[212:215], a[28:31]
    v_exp_f32 v164, v164
    v_mfma_f32_16x16x32_bf16 a[32:35], a[144:147], v[208:211], a[32:35]
    ds_read_b128 a[188:191], v21 offset:28672
    v_cvt_pk_bf16_f32 v57, v162, v163
    v_mfma_f32_16x16x32_bf16 a[40:43], a[144:147], v[212:215], a[40:43]
    v_exp_f32 v165, v165
    v_mfma_f32_16x16x32_bf16 a[36:39], a[148:151], v[208:211], a[36:39]
    buffer_store_dwordx4 v[40:43], v31, s[36:39], s27 offen sc1
    v_mfma_f32_16x16x32_bf16 a[44:47], a[148:151], v[212:215], a[44:47]
    v_exp_f32 v166, v166
    v_mfma_f32_16x16x32_bf16 a[48:51], a[152:155], v[208:211], a[48:51]
    s_add_u32 m0, s50, 0
    s_mov_b32 s48, 98304
    v_cvt_pk_bf16_f32 v58, v164, v165
    v_mfma_f32_16x16x32_bf16 a[56:59], a[152:155], v[212:215], a[56:59]
    v_exp_f32 v167, v167
    v_mfma_f32_16x16x32_bf16 a[52:55], a[156:159], v[208:211], a[52:55]
    buffer_load_dwordx4 v28, s[12:15], s48 offen lds
    v_mfma_f32_16x16x32_bf16 a[60:63], a[156:159], v[212:215], a[60:63]
    v_exp_f32 v168, v168
    v_mfma_f32_16x16x32_bf16 v[252:255], v[36:39], v[216:219], v[252:255]
    v_cvt_pk_bf16_f32 v59, v166, v167
    v_mfma_f32_16x16x32_bf16 v[32:35], v[36:39], v[220:223], v[32:35]
    v_exp_f32 v169, v169
    v_mfma_f32_16x16x32_bf16 a[64:67], a[128:131], v[216:219], a[64:67]
    buffer_load_dwordx4 v29, s[12:15], s48 offen offset:1024 lds
    v_mfma_f32_16x16x32_bf16 a[72:75], a[128:131], v[220:223], a[72:75]
    v_exp_f32 v170, v170
    v_mfma_f32_16x16x32_bf16 a[68:71], a[132:135], v[216:219], a[68:71]
    s_add_u32 m0, s50, 49152
    s_mov_b32 s48, 114688
    v_cvt_pk_bf16_f32 v60, v168, v169
    v_mfma_f32_16x16x32_bf16 a[76:79], a[132:135], v[220:223], a[76:79]
    v_exp_f32 v171, v171
    v_mfma_f32_16x16x32_bf16 a[80:83], a[136:139], v[216:219], a[80:83]
    buffer_load_dwordx4 v26, s[8:11], s48 offen lds
    v_mfma_f32_16x16x32_bf16 a[88:91], a[136:139], v[220:223], a[88:91]
    v_exp_f32 v172, v172
    v_mfma_f32_16x16x32_bf16 a[84:87], a[140:143], v[216:219], a[84:87]
    v_cvt_pk_bf16_f32 v61, v170, v171
    v_mfma_f32_16x16x32_bf16 a[92:95], a[140:143], v[220:223], a[92:95]
    v_exp_f32 v173, v173
    v_mfma_f32_16x16x32_bf16 a[96:99], a[144:147], v[216:219], a[96:99]
    buffer_load_dwordx4 v27, s[8:11], s48 offen offset:1024 lds
    v_mfma_f32_16x16x32_bf16 a[104:107], a[144:147], v[220:223], a[104:107]
    v_exp_f32 v174, v174
    v_mfma_f32_16x16x32_bf16 a[100:103], a[148:151], v[216:219], a[100:103]
    v_cvt_pk_bf16_f32 v62, v172, v173
    v_mfma_f32_16x16x32_bf16 a[108:111], a[148:151], v[220:223], a[108:111]
    v_exp_f32 v175, v175
    v_mfma_f32_16x16x32_bf16 a[112:115], a[152:155], v[216:219], a[112:115]
    s_waitcnt vmcnt(20) lgkmcnt(0)
    v_mfma_f32_16x16x32_bf16 a[120:123], a[152:155], v[220:223], a[120:123]
    s_barrier
    v_mfma_f32_16x16x32_bf16 a[116:119], a[156:159], v[216:219], a[116:119]
L_pg7:
    s_cbranch_execz L_pg11
    v_cvt_pk_bf16_f32 v63, v174, v175
    s_cmp_eq_u64 vcc, -1
    s_cbranch_scc0 L_spin_gate
L_ok_gate:
    v_mfma_f32_16x16x32_bf16 a[124:127], a[156:159], v[220:223], a[124:127]
    v_mfma_f32_16x16x32_bf16 v[160:163], a[160:163], v[64:67], v[224:227]
    v_exp_f32 v176, v176
    v_mfma_f32_16x16x32_bf16 v[168:171], a[160:163], v[68:71], v[228:231]
    v_exp_f32 v177, v177
    v_mfma_f32_16x16x32_bf16 v[164:167], a[164:167], v[64:67], v[224:227]
    ds_read_b64_tr_b16 a[128:129], v22 offset:16384
    ds_read_b64_tr_b16 a[130:131], v22 offset:18432
    v_mfma_f32_16x16x32_bf16 v[172:175], a[164:167], v[68:71], v[228:231]
    v_exp_f32 v178, v178
    v_mfma_f32_16x16x32_bf16 v[160:163], a[168:171], v[80:83], v[160:163]
    ds_read_b64_tr_b16 a[132:133], v23 offset:16384
    v_cvt_pk_bf16_f32 v216, v176, v177
    v_mfma_f32_16x16x32_bf16 v[168:171], a[168:171], v[84:87], v[168:171]
    v_exp_f32 v179, v179
    v_mfma_f32_16x16x32_bf16 v[164:167], a[172:175], v[80:83], v[164:167]
    ds_read_b64_tr_b16 a[134:135], v23 offset:18432
    ds_read_b64_tr_b16 a[136:137], v24 offset:16384
    v_mfma_f32_16x16x32_bf16 v[172:175], a[172:175], v[84:87], v[172:175]
    v_exp_f32 v180, v180
    v_mfma_f32_16x16x32_bf16 v[160:163], a[176:179], v[96:99], v[160:163]
    ds_read_b64_tr_b16 a[138:139], v24 offset:18432
    v_cvt_pk_bf16_f32 v217, v178, v179
    v_mfma_f32_16x16x32_bf16 v[168:171], a[176:179], v[100:103], v[168:171]
    v_exp_f32 v181, v181
    v_mfma_f32_16x16x32_bf16 v[164:167], a[180:183], v[96:99], v[164:167]
    ds_read_b64_tr_b16 a[140:141], v25 offset:16384
    ds_read_b64_tr_b16 a[142:143], v25 offset:18432
    v_mfma_f32_16x16x32_bf16 v[172:175], a[180:183], v[100:103], v[172:175]
    v_exp_f32 v182, v182
    v_mfma_f32_16x16x32_bf16 v[160:163], a[184:187], v[112:115], v[160:163]
    ds_read_b64_tr_b16 a[144:145], v22 offset:20480
    v_cvt_pk_bf16_f32 v218, v180, v181
    v_mfma_f32_16x16x32_bf16 v[168:171], a[184:187], v[116:119], v[168:171]
    v_exp_f32 v183, v183
    v_mfma_f32_16x16x32_bf16 v[164:167], a[188:191], v[112:115], v[164:167]
    ds_read_b64_tr_b16 a[146:147], v22 offset:22528
    ds_read_b64_tr_b16 a[148:149], v23 offset:20480
    v_mfma_f32_16x16x32_bf16 v[172:175], a[188:191], v[116:119], v[172:175]
    v_exp_f32 v184, v184
    v_mfma_f32_16x16x32_bf16 v[192:195], a[160:163], v[72:75], v[232:235]
    ds_read_b64_tr_b16 a[150:151], v23 offset:22528
    v_cvt_pk_bf16_f32 v219, v182, v183
    v_mfma_f32_16x16x32_bf16 v[200:203], a[160:163], v[76:79], v[236:239]
    v_exp_f32 v185, v185
    v_mfma_f32_16x16x32_bf16 v[196:199], a[164:167], v[72:75], v[232:235]
    ds_read_b64_tr_b16 a[152:153], v24 offset:20480
    ds_read_b64_tr_b16 a[154:155], v24 offset:22528
    v_mfma_f32_16x16x32_bf16 v[204:207], a[164:167], v[76:79], v[236:239]
    v_exp_f32 v186, v186
    v_mfma_f32_16x16x32_bf16 v[192:195], a[168:171], v[88:91], v[192:195]
    ds_read_b64_tr_b16 a[156:157], v25 offset:20480
    v_cvt_pk_bf16_f32 v220, v184, v185
    v_mfma_f32_16x16x32_bf16 v[200:203], a[168:171], v[92:95], v[200:203]
    v_exp_f32 v187, v187
    v_mfma_f32_16x16x32_bf16 v[196:199], a[172:175], v[88:91], v[196:199]
    ds_read_b64_tr_b16 a[158:159], v25 offset:22528
    v_mfma_f32_16x16x32_bf16 v[204:207], a[172:175], v[92:95], v[204:207]
    v_exp_f32 v188, v188
    v_mfma_f32_16x16x32_bf16 v[192:195], a[176:179], v[104:107], v[192:195]
    v_cvt_pk_bf16_f32 v221, v186, v187
    v_mfma_f32_16x16x32_bf16 v[200:203], a[176:179], v[108:111], v[200:203]
    v_exp_f32 v189, v189
    v_mfma_f32_16x16x32_bf16 v[196:199], a[180:183], v[104:107], v[196:199]
    v_mfma_f32_16x16x32_bf16 v[204:207], a[180:183], v[108:111], v[204:207]
    v_exp_f32 v190, v190
    v_mfma_f32_16x16x32_bf16 v[192:195], a[184:187], v[120:123], v[192:195]
    v_cvt_pk_bf16_f32 v222, v188, v189
    v_mfma_f32_16x16x32_bf16 v[200:203], a[184:187], v[124:127], v[200:203]
    v_exp_f32 v191, v191
    v_mfma_f32_16x16x32_bf16 v[196:199], a[188:191], v[120:123], v[196:199]
    v_mfma_f32_16x16x32_bf16 v[204:207], a[188:191], v[124:127], v[204:207]
    v_cvt_pk_bf16_f32 v223, v190, v191
    v_mfma_f32_16x16x32_bf16 v[44:47], v[36:39], v[56:59], v[44:47]
    s_waitcnt vmcnt(0)
    buffer_store_dword v53, v10, s[60:63], 0 offen sc1
    v_mfma_f32_16x16x32_bf16 v[248:251], v[36:39], v[60:63], v[248:251]
    s_waitcnt lgkmcnt(0)
    v_exp_f32 v160, v160
    v_mfma_f32_16x16x32_bf16 a[0:3], a[128:131], v[56:59], a[0:3]
    ds_read_b128 a[160:163], v18 offset:0
    ds_read_b128 a[164:167], v18 offset:4096
    v_mfma_f32_16x16x32_bf16 a[8:11], a[128:131], v[60:63], a[8:11]
    v_exp_f32 v161, v161
    v_mfma_f32_16x16x32_bf16 a[4:7], a[132:135], v[56:59], a[4:7]
    ds_read_b128 a[168:171], v19 offset:0
    ds_read_b128 a[172:175], v19 offset:4096
    v_mfma_f32_16x16x32_bf16 a[12:15], a[132:135], v[60:63], a[12:15]
    v_exp_f32 v162, v162
    v_mfma_f32_16x16x32_bf16 a[16:19], a[136:139], v[56:59], a[16:19]
    ds_read_b128 a[176:179], v20 offset:0
    v_cvt_pk_bf16_f32 v208, v160, v161
    v_mfma_f32_16x16x32_bf16 a[24:27], a[136:139], v[60:63], a[24:27]
    v_exp_f32 v163, v163
    v_mfma_f32_16x16x32_bf16 a[20:23], a[140:143], v[56:59], a[20:23]
    ds_read_b128 a[180:183], v20 offset:4096
    ds_read_b128 a[184:187], v21 offset:0
    v_mfma_f32_16x16x32_bf16 a[28:31], a[140:143], v[60:63], a[28:31]
    v_exp_f32 v164, v164
    v_mfma_f32_16x16x32_bf16 a[32:35], a[144:147], v[56:59], a[32:35]
    ds_read_b128 a[188:191], v21 offset:4096
    v_cvt_pk_bf16_f32 v209, v162, v163
    v_mfma_f32_16x16x32_bf16 a[40:43], a[144:147], v[60:63], a[40:43]
    v_exp_f32 v165, v165
    v_mfma_f32_16x16x32_bf16 a[36:39], a[148:151], v[56:59], a[36:39]
    v_mfma_f32_16x16x32_bf16 a[44:47], a[148:151], v[60:63], a[44:47]
    v_exp_f32 v166, v166
    v_mfma_f32_16x16x32_bf16 a[48:51], a[152:155], v[56:59], a[48:51]
    s_add_u32 m0, s50, 8192
    s_mov_b32 s48, 106496
    v_cvt_pk_bf16_f32 v210, v164, v165
    v_mfma_f32_16x16x32_bf16 a[56:59], a[152:155], v[60:63], a[56:59]
    v_exp_f32 v167, v167
    v_mfma_f32_16x16x32_bf16 a[52:55], a[156:159], v[56:59], a[52:55]
    buffer_load_dwordx4 v28, s[12:15], s48 offen lds
    v_mfma_f32_16x16x32_bf16 a[60:63], a[156:159], v[60:63], a[60:63]
    v_exp_f32 v168, v168
    v_mfma_f32_16x16x32_bf16 v[252:255], v[36:39], v[216:219], v[252:255]
    v_cvt_pk_bf16_f32 v211, v166, v167
    v_mfma_f32_16x16x32_bf16 v[32:35], v[36:39], v[220:223], v[32:35]
    v_exp_f32 v169, v169
    v_mfma_f32_16x16x32_bf16 a[64:67], a[128:131], v[216:219], a[64:67]
    buffer_load_dwordx4 v29, s[12:15], s48 offen offset:1024 lds
    v_mfma_f32_16x16x32_bf16 a[72:75], a[128:131], v[220:223], a[72:75]
    v_exp_f32 v170, v170
    v_mfma_f32_16x16x32_bf16 a[68:71], a[132:135], v[216:219], a[68:71]
    s_add_u32 m0, s50, 57344
    s_mov_b32 s48, 122880
    v_cvt_pk_bf16_f32 v212, v168, v169
    v_mfma_f32_16x16x32_bf16 a[76:79], a[132:135], v[220:223], a[76:79]
    v_exp_f32 v171, v171
    v_mfma_f32_16x16x32_bf16 a[80:83], a[136:139], v[216:219], a[80:83]
    buffer_load_dwordx4 v26, s[8:11], s48 offen lds
    v_mfma_f32_16x16x32_bf16 a[88:91], a[136:139], v[220:223], a[88:91]
    v_exp_f32 v172, v172
    v_mfma_f32_16x16x32_bf16 a[84:87], a[140:143], v[216:219], a[84:87]
    v_cvt_pk_bf16_f32 v213, v170, v171
    v_mfma_f32_16x16x32_bf16 a[92:95], a[140:143], v[220:223], a[92:95]
    v_exp_f32 v173, v173
    v_mfma_f32_16x16x32_bf16 a[96:99], a[144:147], v[216:219], a[96:99]
    buffer_load_dwordx4 v27, s[8:11], s48 offen offset:1024 lds
    v_mfma_f32_16x16x32_bf16 a[104:107], a[144:147], v[220:223], a[104:107]
    v_exp_f32 v174, v174
    v_mfma_f32_16x16x32_bf16 a[100:103], a[148:151], v[216:219], a[100:103]
    v_cvt_pk_bf16_f32 v214, v172, v173
    v_mfma_f32_16x16x32_bf16 a[108:111], a[148:151], v[220:223], a[108:111]
    v_exp_f32 v175, v175
    v_mfma_f32_16x16x32_bf16 a[112:115], a[152:155], v[216:219], a[112:115]
    s_waitcnt lgkmcnt(0)
    v_mfma_f32_16x16x32_bf16 a[120:123], a[152:155], v[220:223], a[120:123]
    s_barrier
    v_mfma_f32_16x16x32_bf16 a[116:119], a[156:159], v[216:219], a[116:119]
    v_cvt_pk_bf16_f32 v215, v174, v175
    v_mfma_f32_16x16x32_bf16 a[124:127], a[156:159], v[220:223], a[124:127]
    v_mfma_f32_16x16x32_bf16 v[160:163], a[160:163], v[64:67], v[224:227]
    v_exp_f32 v192, v192
    v_mfma_f32_16x16x32_bf16 v[168:171], a[160:163], v[68:71], v[228:231]
    v_exp_f32 v193, v193
    v_mfma_f32_16x16x32_bf16 v[164:167], a[164:167], v[64:67], v[224:227]
    ds_read_b64_tr_b16 a[128:129], v22 offset:24576
    ds_read_b64_tr_b16 a[130:131], v22 offset:26624
    v_mfma_f32_16x16x32_bf16 v[172:175], a[164:167], v[68:71], v[228:231]
    v_exp_f32 v194, v194
    v_mfma_f32_16x16x32_bf16 v[160:163], a[168:171], v[80:83], v[160:163]
    ds_read_b64_tr_b16 a[132:133], v23 offset:24576
    v_cvt_pk_bf16_f32 v216, v192, v193
    v_mfma_f32_16x16x32_bf16 v[168:171], a[168:171], v[84:87], v[168:171]
    v_exp_f32 v195, v195
    v_mfma_f32_16x16x32_bf16 v[164:167], a[172:175], v[80:83], v[164:167]
    ds_read_b64_tr_b16 a[134:135], v23 offset:26624
    ds_read_b64_tr_b16 a[136:137], v24 offset:24576
    v_mfma_f32_16x16x32_bf16 v[172:175], a[172:175], v[84:87], v[172:175]
    v_exp_f32 v196, v196
    v_mfma_f32_16x16x32_bf16 v[160:163], a[176:179], v[96:99], v[160:163]
    ds_read_b64_tr_b16 a[138:139], v24 offset:26624
    v_cvt_pk_bf16_f32 v217, v194, v195
    v_mfma_f32_16x16x32_bf16 v[168:171], a[176:179], v[100:103], v[168:171]
    v_exp_f32 v197, v197
    v_mfma_f32_16x16x32_bf16 v[164:167], a[180:183], v[96:99], v[164:167]
    ds_read_b64_tr_b16 a[140:141], v25 offset:24576
    ds_read_b64_tr_b16 a[142:143], v25 offset:26624
    v_mfma_f32_16x16x32_bf16 v[172:175], a[180:183], v[100:103], v[172:175]
    v_exp_f32 v198, v198
    v_mfma_f32_16x16x32_bf16 v[160:163], a[184:187], v[112:115], v[160:163]
    ds_read_b64_tr_b16 a[144:145], v22 offset:28672
    v_cvt_pk_bf16_f32 v218, v196, v197
    v_mfma_f32_16x16x32_bf16 v[168:171], a[184:187], v[116:119], v[168:171]
    v_exp_f32 v199, v199
    v_mfma_f32_16x16x32_bf16 v[164:167], a[188:191], v[112:115], v[164:167]
    ds_read_b64_tr_b16 a[146:147], v22 offset:30720
    ds_read_b64_tr_b16 a[148:149], v23 offset:28672
    v_mfma_f32_16x16x32_bf16 v[172:175], a[188:191], v[116:119], v[172:175]
    v_exp_f32 v200, v200
    v_mfma_f32_16x16x32_bf16 v[176:179], a[160:163], v[72:75], v[232:235]
    ds_read_b64_tr_b16 a[150:151], v23 offset:30720
    v_cvt_pk_bf16_f32 v219, v198, v199
    v_mfma_f32_16x16x32_bf16 v[184:187], a[160:163], v[76:79], v[236:239]
    v_exp_f32 v201, v201
    v_mfma_f32_16x16x32_bf16 v[180:183], a[164:167], v[72:75], v[232:235]
    ds_read_b64_tr_b16 a[152:153], v24 offset:28672
    ds_read_b64_tr_b16 a[154:155], v24 offset:30720
    v_mfma_f32_16x16x32_bf16 v[188:191], a[164:167], v[76:79], v[236:239]
    v_exp_f32 v202, v202
    v_mfma_f32_16x16x32_bf16 v[176:179], a[168:171], v[88:91], v[176:179]
    ds_read_b64_tr_b16 a[156:157], v25 offset:28672
    v_cvt_pk_bf16_f32 v220, v200, v201
    v_mfma_f32_16x16x32_bf16 v[184:187], a[168:171], v[92:95], v[184:187]
    v_exp_f32 v203, v203
    v_mfma_f32_16x16x32_bf16 v[180:183], a[172:175], v[88:91], v[180:183]
    ds_read_b64_tr_b16 a[158:159], v25 offset:30720
    s_add_u32 m0, s43, 12288
    v_mfma_f32_16x16x32_bf16 v[188:191], a[172:175], v[92:95], v[188:191]
    v_exp_f32 v204, v204
    v_mfma_f32_16x16x32_bf16 v[176:179], a[176:179], v[104:107], v[176:179]
    s_mov_b32 s44, 98304
    v_cvt_pk_bf16_f32 v221, v202, v203
    v_mfma_f32_16x16x32_bf16 v[184:187], a[176:179], v[108:111], v[184:187]
    v_exp_f32 v205, v205
    v_mfma_f32_16x16x32_bf16 v[180:183], a[180:183], v[104:107], v[180:183]
    buffer_load_dwordx4 v14, s[20:23], s44 offen offset:0 lds
    v_mfma_f32_16x16x32_bf16 v[188:191], a[180:183], v[108:111], v[188:191]
    v_exp_f32 v206, v206
    v_mfma_f32_16x16x32_bf16 v[176:179], a[184:187], v[120:123], v[176:179]
    buffer_load_dwordx4 v15, s[20:23], s44 offen offset:1024 lds
    v_cvt_pk_bf16_f32 v222, v204, v205
    v_mfma_f32_16x16x32_bf16 v[184:187], a[184:187], v[124:127], v[184:187]
    v_exp_f32 v207, v207
    v_mfma_f32_16x16x32_bf16 v[180:183], a[188:191], v[120:123], v[180:183]
    buffer_load_dwordx4 v16, s[20:23], s44 offen offset:2048 lds
    v_mfma_f32_16x16x32_bf16 v[188:191], a[188:191], v[124:127], v[188:191]
    buffer_load_dwordx4 v17, s[20:23], s44 offen offset:3072 lds
    v_cvt_pk_bf16_f32 v223, v206, v207
    v_mfma_f32_16x16x32_bf16 v[44:47], v[36:39], v[208:211], v[44:47]
    s_xor_b32 s47, s42, 16
    v_mfma_f32_16x16x32_bf16 v[248:251], v[36:39], v[212:215], v[248:251]
    s_waitcnt lgkmcnt(0)
    v_exp_f32 v160, v160
    v_mfma_f32_16x16x32_bf16 a[0:3], a[128:131], v[208:211], a[0:3]
    ds_read_b128 a[160:163], v18 offset:8192
    ds_read_b128 a[164:167], v18 offset:12288
    v_mfma_f32_16x16x32_bf16 a[8:11], a[128:131], v[212:215], a[8:11]
    v_exp_f32 v161, v161
    v_mfma_f32_16x16x32_bf16 a[4:7], a[132:135], v[208:211], a[4:7]
    ds_read_b128 a[168:171], v19 offset:8192
    ds_read_b128 a[172:175], v19 offset:12288
    v_mfma_f32_16x16x32_bf16 a[12:15], a[132:135], v[212:215], a[12:15]
    v_exp_f32 v162, v162
    v_mfma_f32_16x16x32_bf16 a[16:19], a[136:139], v[208:211], a[16:19]
    ds_read_b128 a[176:179], v20 offset:8192
    v_cvt_pk_bf16_f32 v56, v160, v161
    v_mfma_f32_16x16x32_bf16 a[24:27], a[136:139], v[212:215], a[24:27]
    v_exp_f32 v163, v163
    v_mfma_f32_16x16x32_bf16 a[20:23], a[140:143], v[208:211], a[20:23]
    ds_read_b128 a[180:183], v20 offset:12288
    ds_read_b128 a[184:187], v21 offset:8192
    v_mfma_f32_16x16x32_bf16 a[28:31], a[140:143], v[212:215], a[28:31]
    v_exp_f32 v164, v164
    v_mfma_f32_16x16x32_bf16 a[32:35], a[144:147], v[208:211], a[32:35]
    ds_read_b128 a[188:191], v21 offset:12288
    v_cvt_pk_bf16_f32 v57, v162, v163
    v_mfma_f32_16x16x32_bf16 a[40:43], a[144:147], v[212:215], a[40:43]
    v_exp_f32 v165, v165
    v_mfma_f32_16x16x32_bf16 a[36:39], a[148:151], v[208:211], a[36:39]
    s_lshl_b32 s47, s47, 14
    buffer_load_dword v49, v50, s[20:23], s47 offen
    v_mfma_f32_16x16x32_bf16 a[44:47], a[148:151], v[212:215], a[44:47]
    v_exp_f32 v166, v166
    v_mfma_f32_16x16x32_bf16 a[48:51], a[152:155], v[208:211], a[48:51]
    s_add_u32 m0, s50, 16384
    s_mov_b32 s48, 114688
    v_cvt_pk_bf16_f32 v58, v164, v165
    v_mfma_f32_16x16x32_bf16 a[56:59], a[152:155], v[212:215], a[56:59]
    v_exp_f32 v167, v167
    v_mfma_f32_16x16x32_bf16 a[52:55], a[156:159], v[208:211], a[52:55]
    buffer_load_dwordx4 v28, s[12:15], s48 offen lds
    v_mfma_f32_16x16x32_bf16 a[60:63], a[156:159], v[212:215], a[60:63]
    v_exp_f32 v168, v168
    v_mfma_f32_16x16x32_bf16 v[252:255], v[36:39], v[216:219], v[252:255]
    v_cvt_pk_bf16_f32 v59, v166, v167
    v_mfma_f32_16x16x32_bf16 v[32:35], v[36:39], v[220:223], v[32:35]
    v_exp_f32 v169, v169
    v_mfma_f32_16x16x32_bf16 a[64:67], a[128:131], v[216:219], a[64:67]
    buffer_load_dwordx4 v29, s[12:15], s48 offen offset:1024 lds
    v_mfma_f32_16x16x32_bf16 a[72:75], a[128:131], v[220:223], a[72:75]
    v_exp_f32 v170, v170
    v_mfma_f32_16x16x32_bf16 a[68:71], a[132:135], v[216:219], a[68:71]
    v_cvt_pk_bf16_f32 v60, v168, v169
    v_mfma_f32_16x16x32_bf16 a[76:79], a[132:135], v[220:223], a[76:79]
    v_exp_f32 v171, v171
    v_mfma_f32_16x16x32_bf16 a[80:83], a[136:139], v[216:219], a[80:83]
    v_mfma_f32_16x16x32_bf16 a[88:91], a[136:139], v[220:223], a[88:91]
    v_exp_f32 v172, v172
    v_mfma_f32_16x16x32_bf16 a[84:87], a[140:143], v[216:219], a[84:87]
    v_cvt_pk_bf16_f32 v61, v170, v171
    v_mfma_f32_16x16x32_bf16 a[92:95], a[140:143], v[220:223], a[92:95]
    v_exp_f32 v173, v173
    v_mfma_f32_16x16x32_bf16 a[96:99], a[144:147], v[216:219], a[96:99]
    v_mfma_f32_16x16x32_bf16 a[104:107], a[144:147], v[220:223], a[104:107]
    v_exp_f32 v174, v174
    v_mfma_f32_16x16x32_bf16 a[100:103], a[148:151], v[216:219], a[100:103]
    v_cvt_pk_bf16_f32 v62, v172, v173
    v_mfma_f32_16x16x32_bf16 a[108:111], a[148:151], v[220:223], a[108:111]
    v_exp_f32 v175, v175
    v_mfma_f32_16x16x32_bf16 a[112:115], a[152:155], v[216:219], a[112:115]
    s_waitcnt lgkmcnt(0)
    v_mfma_f32_16x16x32_bf16 a[120:123], a[152:155], v[220:223], a[120:123]
    s_barrier
    v_mfma_f32_16x16x32_bf16 a[116:119], a[156:159], v[216:219], a[116:119]
    v_cvt_pk_bf16_f32 v63, v174, v175
    v_mfma_f32_16x16x32_bf16 a[124:127], a[156:159], v[220:223], a[124:127]
    v_mfma_f32_16x16x32_bf16 v[160:163], a[160:163], v[64:67], v[224:227]
    v_exp_f32 v176, v176
    v_mfma_f32_16x16x32_bf16 v[168:171], a[160:163], v[68:71], v[228:231]
    v_exp_f32 v177, v177
    v_mfma_f32_16x16x32_bf16 v[164:167], a[164:167], v[64:67], v[224:227]
    ds_read_b64_tr_b16 a[128:129], v22 offset:0
    ds_read_b64_tr_b16 a[130:131], v22 offset:2048
    v_mfma_f32_16x16x32_bf16 v[172:175], a[164:167], v[68:71], v[228:231]
    v_exp_f32 v178, v178
    v_mfma_f32_16x16x32_bf16 v[160:163], a[168:171], v[80:83], v[160:163]
    ds_read_b64_tr_b16 a[132:133], v23 offset:0
    v_cvt_pk_bf16_f32 v216, v176, v177
    v_mfma_f32_16x16x32_bf16 v[168:171], a[168:171], v[84:87], v[168:171]
    v_exp_f32 v179, v179
    v_mfma_f32_16x16x32_bf16 v[164:167], a[172:175], v[80:83], v[164:167]
    ds_read_b64_tr_b16 a[134:135], v23 offset:2048
    ds_read_b64_tr_b16 a[136:137], v24 offset:0
    v_mfma_f32_16x16x32_bf16 v[172:175], a[172:175], v[84:87], v[172:175]
    v_exp_f32 v180, v180
    v_mfma_f32_16x16x32_bf16 v[160:163], a[176:179], v[96:99], v[160:163]
    ds_read_b64_tr_b16 a[138:139], v24 offset:2048
    v_cvt_pk_bf16_f32 v217, v178, v179
    v_mfma_f32_16x16x32_bf16 v[168:171], a[176:179], v[100:103], v[168:171]
    v_exp_f32 v181, v181
    v_mfma_f32_16x16x32_bf16 v[164:167], a[180:183], v[96:99], v[164:167]
    ds_read_b64_tr_b16 a[140:141], v25 offset:0
    ds_read_b64_tr_b16 a[142:143], v25 offset:2048
    v_mfma_f32_16x16x32_bf16 v[172:175], a[180:183], v[100:103], v[172:175]
    v_exp_f32 v182, v182
    v_mfma_f32_16x16x32_bf16 v[160:163], a[184:187], v[112:115], v[160:163]
    ds_read_b64_tr_b16 a[144:145], v22 offset:4096
    v_cvt_pk_bf16_f32 v218, v180, v181
    v_mfma_f32_16x16x32_bf16 v[168:171], a[184:187], v[116:119], v[168:171]
    v_exp_f32 v183, v183
    v_mfma_f32_16x16x32_bf16 v[164:167], a[188:191], v[112:115], v[164:167]
    ds_read_b64_tr_b16 a[146:147], v22 offset:6144
    ds_read_b64_tr_b16 a[148:149], v23 offset:4096
    v_mfma_f32_16x16x32_bf16 v[172:175], a[188:191], v[116:119], v[172:175]
    v_exp_f32 v184, v184
    v_mfma_f32_16x16x32_bf16 v[192:195], a[160:163], v[72:75], v[232:235]
    ds_read_b64_tr_b16 a[150:151], v23 offset:6144
    v_cvt_pk_bf16_f32 v219, v182, v183
    v_mfma_f32_16x16x32_bf16 v[200:203], a[160:163], v[76:79], v[236:239]
    v_exp_f32 v185, v185
    v_mfma_f32_16x16x32_bf16 v[196:199], a[164:167], v[72:75], v[232:235]
    ds_read_b64_tr_b16 a[152:153], v24 offset:4096
    ds_read_b64_tr_b16 a[154:155], v24 offset:6144
    v_mfma_f32_16x16x32_bf16 v[204:207], a[164:167], v[76:79], v[236:239]
    v_exp_f32 v186, v186
    v_mfma_f32_16x16x32_bf16 v[192:195], a[168:171], v[88:91], v[192:195]
    ds_read_b64_tr_b16 a[156:157], v25 offset:4096
    v_cvt_pk_bf16_f32 v220, v184, v185
    v_mfma_f32_16x16x32_bf16 v[200:203], a[168:171], v[92:95], v[200:203]
    v_exp_f32 v187, v187
    v_mfma_f32_16x16x32_bf16 v[196:199], a[172:175], v[88:91], v[196:199]
    ds_read_b64_tr_b16 a[158:159], v25 offset:6144
    s_add_u32 m0, s43, 16384
    v_mfma_f32_16x16x32_bf16 v[204:207], a[172:175], v[92:95], v[204:207]
    v_exp_f32 v188, v188
    v_mfma_f32_16x16x32_bf16 v[192:195], a[176:179], v[104:107], v[192:195]
    s_mov_b32 s44, 131072
    v_cvt_pk_bf16_f32 v221, v186, v187
    v_mfma_f32_16x16x32_bf16 v[200:203], a[176:179], v[108:111], v[200:203]
    v_exp_f32 v189, v189
    v_mfma_f32_16x16x32_bf16 v[196:199], a[180:183], v[104:107], v[196:199]
    buffer_load_dwordx4 v14, s[20:23], s44 offen offset:0 lds
    v_mfma_f32_16x16x32_bf16 v[204:207], a[180:183], v[108:111], v[204:207]
    v_exp_f32 v190, v190
    v_mfma_f32_16x16x32_bf16 v[192:195], a[184:187], v[120:123], v[192:195]
    buffer_load_dwordx4 v15, s[20:23], s44 offen offset:1024 lds
    v_cvt_pk_bf16_f32 v222, v188, v189
    v_mfma_f32_16x16x32_bf16 v[200:203], a[184:187], v[124:127], v[200:203]
    v_exp_f32 v191, v191
    v_mfma_f32_16x16x32_bf16 v[196:199], a[188:191], v[120:123], v[196:199]
    buffer_load_dwordx4 v16, s[20:23], s44 offen offset:2048 lds
    v_mfma_f32_16x16x32_bf16 v[204:207], a[188:191], v[124:127], v[204:207]
    buffer_load_dwordx4 v17, s[20:23], s44 offen offset:3072 lds
    v_cvt_pk_bf16_f32 v223, v190, v191
    v_mfma_f32_16x16x32_bf16 v[44:47], v[36:39], v[56:59], v[44:47]
    buffer_load_dword v55, v11, s[60:63], 0 offen sc1
    v_mfma_f32_16x16x32_bf16 v[248:251], v[36:39], v[60:63], v[248:251]
    s_waitcnt lgkmcnt(0)
    v_exp_f32 v160, v160
    v_mfma_f32_16x16x32_bf16 a[0:3], a[128:131], v[56:59], a[0:3]
    ds_read_b128 a[160:163], v18 offset:16384
    ds_read_b128 a[164:167], v18 offset:20480
    v_mfma_f32_16x16x32_bf16 a[8:11], a[128:131], v[60:63], a[8:11]
    v_exp_f32 v161, v161
    v_mfma_f32_16x16x32_bf16 a[4:7], a[132:135], v[56:59], a[4:7]
    ds_read_b128 a[168:171], v19 offset:16384
    ds_read_b128 a[172:175], v19 offset:20480
    v_mfma_f32_16x16x32_bf16 a[12:15], a[132:135], v[60:63], a[12:15]
    v_exp_f32 v162, v162
    v_mfma_f32_16x16x32_bf16 a[16:19], a[136:139], v[56:59], a[16:19]
    ds_read_b128 a[176:179], v20 offset:16384
    v_cvt_pk_bf16_f32 v208, v160, v161
    v_mfma_f32_16x16x32_bf16 a[24:27], a[136:139], v[60:63], a[24:27]
    v_exp_f32 v163, v163
    v_mfma_f32_16x16x32_bf16 a[20:23], a[140:143], v[56:59], a[20:23]
    ds_read_b128 a[180:183], v20 offset:20480
    ds_read_b128 a[184:187], v21 offset:16384
    v_mfma_f32_16x16x32_bf16 a[28:31], a[140:143], v[60:63], a[28:31]
    v_exp_f32 v164, v164
    v_mfma_f32_16x16x32_bf16 a[32:35], a[144:147], v[56:59], a[32:35]
    ds_read_b128 a[188:191], v21 offset:20480
    v_cvt_pk_bf16_f32 v209, v162, v163
    v_mfma_f32_16x16x32_bf16 a[40:43], a[144:147], v[60:63], a[40:43]
    v_exp_f32 v165, v165
    v_mfma_f32_16x16x32_bf16 a[36:39], a[148:151], v[56:59], a[36:39]
    v_mfma_f32_16x16x32_bf16 a[44:47], a[148:151], v[60:63], a[44:47]
    v_exp_f32 v166, v166
    v_mfma_f32_16x16x32_bf16 a[48:51], a[152:155], v[56:59], a[48:51]
    s_add_u32 m0, s50, 24576
    s_mov_b32 s48, 122880
    v_cvt_pk_bf16_f32 v210, v164, v165
    v_mfma_f32_16x16x32_bf16 a[56:59], a[152:155], v[60:63], a[56:59]
    v_exp_f32 v167, v167
    v_mfma_f32_16x16x32_bf16 a[52:55], a[156:159], v[56:59], a[52:55]
    buffer_load_dwordx4 v28, s[12:15], s48 offen lds
    v_mfma_f32_16x16x32_bf16 a[60:63], a[156:159], v[60:63], a[60:63]
    v_exp_f32 v168, v168
    v_mfma_f32_16x16x32_bf16 v[252:255], v[36:39], v[216:219], v[252:255]
    v_cvt_pk_bf16_f32 v211, v166, v167
    v_mfma_f32_16x16x32_bf16 v[32:35], v[36:39], v[220:223], v[32:35]
    v_exp_f32 v169, v169
    v_mfma_f32_16x16x32_bf16 a[64:67], a[128:131], v[216:219], a[64:67]
    buffer_load_dwordx4 v29, s[12:15], s48 offen offset:1024 lds
    v_mfma_f32_16x16x32_bf16 a[72:75], a[128:131], v[220:223], a[72:75]
    v_exp_f32 v170, v170
    v_mfma_f32_16x16x32_bf16 a[68:71], a[132:135], v[216:219], a[68:71]
    v_cvt_pk_bf16_f32 v212, v168, v169
    v_mfma_f32_16x16x32_bf16 a[76:79], a[132:135], v[220:223], a[76:79]
    v_exp_f32 v171, v171
    v_mfma_f32_16x16x32_bf16 a[80:83], a[136:139], v[216:219], a[80:83]
    v_mfma_f32_16x16x32_bf16 a[88:91], a[136:139], v[220:223], a[88:91]
    v_exp_f32 v172, v172
    v_mfma_f32_16x16x32_bf16 a[84:87], a[140:143], v[216:219], a[84:87]
    v_cvt_pk_bf16_f32 v213, v170, v171
    v_mfma_f32_16x16x32_bf16 a[92:95], a[140:143], v[220:223], a[92:95]
    v_exp_f32 v173, v173
    v_mfma_f32_16x16x32_bf16 a[96:99], a[144:147], v[216:219], a[96:99]
    v_mfma_f32_16x16x32_bf16 a[104:107], a[144:147], v[220:223], a[104:107]
    v_exp_f32 v174, v174
    v_mfma_f32_16x16x32_bf16 a[100:103], a[148:151], v[216:219], a[100:103]
    v_cvt_pk_bf16_f32 v214, v172, v173
    v_mfma_f32_16x16x32_bf16 a[108:111], a[148:151], v[220:223], a[108:111]
    v_exp_f32 v175, v175
    v_mfma_f32_16x16x32_bf16 a[112:115], a[152:155], v[216:219], a[112:115]
    s_waitcnt vmcnt(14) lgkmcnt(0)
    v_mfma_f32_16x16x32_bf16 a[120:123], a[152:155], v[220:223], a[120:123]
    s_barrier
    v_mfma_f32_16x16x32_bf16 a[116:119], a[156:159], v[216:219], a[116:119]
    v_cvt_pk_bf16_f32 v215, v174, v175
    v_mfma_f32_16x16x32_bf16 a[124:127], a[156:159], v[220:223], a[124:127]
    v_mfma_f32_16x16x32_bf16 v[160:163], a[160:163], v[64:67], v[224:227]
    v_exp_f32 v192, v192
    v_mfma_f32_16x16x32_bf16 v[168:171], a[160:163], v[68:71], v[228:231]
    v_exp_f32 v193, v193
    v_mfma_f32_16x16x32_bf16 v[164:167], a[164:167], v[64:67], v[224:227]
    ds_read_b64_tr_b16 a[128:129], v22 offset:8192
    ds_read_b64_tr_b16 a[130:131], v22 offset:10240
    v_mfma_f32_16x16x32_bf16 v[172:175], a[164:167], v[68:71], v[228:231]
    v_exp_f32 v194, v194
    v_mfma_f32_16x16x32_bf16 v[160:163], a[168:171], v[80:83], v[160:163]
    ds_read_b64_tr_b16 a[132:133], v23 offset:8192
    v_cvt_pk_bf16_f32 v216, v192, v193
    v_mfma_f32_16x16x32_bf16 v[168:171], a[168:171], v[84:87], v[168:171]
    v_exp_f32 v195, v195
    v_mfma_f32_16x16x32_bf16 v[164:167], a[172:175], v[80:83], v[164:167]
    ds_read_b64_tr_b16 a[134:135], v23 offset:10240
    ds_read_b64_tr_b16 a[136:137], v24 offset:8192
    v_mfma_f32_16x16x32_bf16 v[172:175], a[172:175], v[84:87], v[172:175]
    v_exp_f32 v196, v196
    v_mfma_f32_16x16x32_bf16 v[160:163], a[176:179], v[96:99], v[160:163]
    ds_read_b64_tr_b16 a[138:139], v24 offset:10240
    v_cvt_pk_bf16_f32 v217, v194, v195
    v_mfma_f32_16x16x32_bf16 v[168:171], a[176:179], v[100:103], v[168:171]
    v_exp_f32 v197, v197
    v_mfma_f32_16x16x32_bf16 v[164:167], a[180:183], v[96:99], v[164:167]
    ds_read_b64_tr_b16 a[140:141], v25 offset:8192
    ds_read_b64_tr_b16 a[142:143], v25 offset:10240
    v_mfma_f32_16x16x32_bf16 v[172:175], a[180:183], v[100:103], v[172:175]
    v_exp_f32 v198, v198
    v_mfma_f32_16x16x32_bf16 v[160:163], a[184:187], v[112:115], v[160:163]
    ds_read_b64_tr_b16 a[144:145], v22 offset:12288
    v_cvt_pk_bf16_f32 v218, v196, v197
    v_mfma_f32_16x16x32_bf16 v[168:171], a[184:187], v[116:119], v[168:171]
    v_exp_f32 v199, v199
    v_mfma_f32_16x16x32_bf16 v[164:167], a[188:191], v[112:115], v[164:167]
    ds_read_b64_tr_b16 a[146:147], v22 offset:14336
    ds_read_b64_tr_b16 a[148:149], v23 offset:12288
    v_mfma_f32_16x16x32_bf16 v[172:175], a[188:191], v[116:119], v[172:175]
    v_exp_f32 v200, v200
    v_mfma_f32_16x16x32_bf16 v[176:179], a[160:163], v[72:75], v[232:235]
    ds_read_b64_tr_b16 a[150:151], v23 offset:14336
    v_cvt_pk_bf16_f32 v219, v198, v199
    v_mfma_f32_16x16x32_bf16 v[184:187], a[160:163], v[76:79], v[236:239]
    v_exp_f32 v201, v201
    v_mfma_f32_16x16x32_bf16 v[180:183], a[164:167], v[72:75], v[232:235]
    ds_read_b64_tr_b16 a[152:153], v24 offset:12288
    ds_read_b64_tr_b16 a[154:155], v24 offset:14336
    v_mfma_f32_16x16x32_bf16 v[188:191], a[164:167], v[76:79], v[236:239]
    v_exp_f32 v202, v202
    v_mfma_f32_16x16x32_bf16 v[176:179], a[168:171], v[88:91], v[176:179]
    ds_read_b64_tr_b16 a[156:157], v25 offset:12288
    v_cvt_pk_bf16_f32 v220, v200, v201
    v_mfma_f32_16x16x32_bf16 v[184:187], a[168:171], v[92:95], v[184:187]
    v_exp_f32 v203, v203
    v_mfma_f32_16x16x32_bf16 v[180:183], a[172:175], v[88:91], v[180:183]
    ds_read_b64_tr_b16 a[158:159], v25 offset:14336
    s_add_u32 m0, s43, 20480
    v_mfma_f32_16x16x32_bf16 v[188:191], a[172:175], v[92:95], v[188:191]
    v_exp_f32 v204, v204
    v_mfma_f32_16x16x32_bf16 v[176:179], a[176:179], v[104:107], v[176:179]
    s_mov_b32 s44, 163840
    v_cvt_pk_bf16_f32 v221, v202, v203
    v_mfma_f32_16x16x32_bf16 v[184:187], a[176:179], v[108:111], v[184:187]
    v_exp_f32 v205, v205
    v_mfma_f32_16x16x32_bf16 v[180:183], a[180:183], v[104:107], v[180:183]
    buffer_load_dwordx4 v14, s[20:23], s44 offen offset:0 lds
    v_mfma_f32_16x16x32_bf16 v[188:191], a[180:183], v[108:111], v[188:191]
    v_exp_f32 v206, v206
    v_mfma_f32_16x16x32_bf16 v[176:179], a[184:187], v[120:123], v[176:179]
    buffer_load_dwordx4 v15, s[20:23], s44 offen offset:1024 lds
    v_cvt_pk_bf16_f32 v222, v204, v205
    v_mfma_f32_16x16x32_bf16 v[184:187], a[184:187], v[124:127], v[184:187]
    v_exp_f32 v207, v207
    v_mfma_f32_16x16x32_bf16 v[180:183], a[188:191], v[120:123], v[180:183]
    buffer_load_dwordx4 v16, s[20:23], s44 offen offset:2048 lds
    v_mfma_f32_16x16x32_bf16 v[188:191], a[188:191], v[124:127], v[188:191]
    buffer_load_dwordx4 v17, s[20:23], s44 offen offset:3072 lds
    v_cvt_pk_bf16_f32 v223, v206, v207
    v_mfma_f32_16x16x32_bf16 v[44:47], v[36:39], v[208:211], v[44:47]
    s_waitcnt vmcnt(6)
    v_cmp_le_u32 vcc, 1, v55
    v_mfma_f32_16x16x32_bf16 v[248:251], v[36:39], v[212:215], v[248:251]
    s_waitcnt lgkmcnt(0)
    v_exp_f32 v160, v160
    v_mfma_f32_16x16x32_bf16 a[0:3], a[128:131], v[208:211], a[0:3]
    ds_read_b128 a[160:163], v18 offset:24576
    ds_read_b128 a[164:167], v18 offset:28672
    v_mfma_f32_16x16x32_bf16 a[8:11], a[128:131], v[212:215], a[8:11]
    v_exp_f32 v161, v161
    v_mfma_f32_16x16x32_bf16 a[4:7], a[132:135], v[208:211], a[4:7]
    ds_read_b128 a[168:171], v19 offset:24576
    ds_read_b128 a[172:175], v19 offset:28672
    v_mfma_f32_16x16x32_bf16 a[12:15], a[132:135], v[212:215], a[12:15]
    v_exp_f32 v162, v162
    v_mfma_f32_16x16x32_bf16 a[16:19], a[136:139], v[208:211], a[16:19]
    ds_read_b128 a[176:179], v20 offset:24576
    v_cvt_pk_bf16_f32 v56, v160, v161
    v_mfma_f32_16x16x32_bf16 a[24:27], a[136:139], v[212:215], a[24:27]
    v_exp_f32 v163, v163
    v_mfma_f32_16x16x32_bf16 a[20:23], a[140:143], v[208:211], a[20:23]
    ds_read_b128 a[180:183], v20 offset:28672
    ds_read_b128 a[184:187], v21 offset:24576
    v_mfma_f32_16x16x32_bf16 a[28:31], a[140:143], v[212:215], a[28:31]
    v_exp_f32 v164, v164
    v_mfma_f32_16x16x32_bf16 a[32:35], a[144:147], v[208:211], a[32:35]
    ds_read_b128 a[188:191], v21 offset:28672
    v_cvt_pk_bf16_f32 v57, v162, v163
    v_mfma_f32_16x16x32_bf16 a[40:43], a[144:147], v[212:215], a[40:43]
    v_exp_f32 v165, v165
    v_mfma_f32_16x16x32_bf16 a[36:39], a[148:151], v[208:211], a[36:39]
    s_cmp_eq_u64 vcc, -1
    s_cbranch_scc0 L_spin_f
L_ok_f:
    v_mfma_f32_16x16x32_bf16 a[44:47], a[148:151], v[212:215], a[44:47]
L_pg8:
    s_cbranch_execz L_pg12
    v_exp_f32 v166, v166
    v_mfma_f32_16x16x32_bf16 a[48:51], a[152:155], v[208:211], a[48:51]
    buffer_load_dwordx4 a[192:195], v12, s[88:91], 0 offen offset:0 sc1
    v_cvt_pk_bf16_f32 v58, v164, v165
    v_mfma_f32_16x16x32_bf16 a[56:59], a[152:155], v[212:215], a[56:59]
    v_exp_f32 v167, v167
    v_mfma_f32_16x16x32_bf16 a[52:55], a[156:159], v[208:211], a[52:55]
    buffer_load_dwordx4 a[196:199], v12, s[88:91], 0 offen offset:1024 sc1
    v_mfma_f32_16x16x32_bf16 a[60:63], a[156:159], v[212:215], a[60:63]
    v_exp_f32 v168, v168
    v_mfma_f32_16x16x32_bf16 v[252:255], v[36:39], v[216:219], v[252:255]
    buffer_load_dwordx4 a[200:203], v12, s[88:91], 0 offen offset:2048 sc1
    v_cvt_pk_bf16_f32 v59, v166, v167
    v_mfma_f32_16x16x32_bf16 v[32:35], v[36:39], v[220:223], v[32:35]
    v_exp_f32 v169, v169
    v_mfma_f32_16x16x32_bf16 a[64:67], a[128:131], v[216:219], a[64:67]
    buffer_load_dwordx4 a[204:207], v12, s[88:91], 0 offen offset:3072 sc1
    v_mfma_f32_16x16x32_bf16 a[72:75], a[128:131], v[220:223], a[72:75]
    v_exp_f32 v170, v170
    v_mfma_f32_16x16x32_bf16 a[68:71], a[132:135], v[216:219], a[68:71]
    buffer_load_dwordx4 a[208:211], v12, s[88:91], s56 offen offset:0 sc1
    v_cvt_pk_bf16_f32 v60, v168, v169
    v_mfma_f32_16x16x32_bf16 a[76:79], a[132:135], v[220:223], a[76:79]
    v_exp_f32 v171, v171
    v_mfma_f32_16x16x32_bf16 a[80:83], a[136:139], v[216:219], a[80:83]
    buffer_load_dwordx4 a[212:215], v12, s[88:91], s56 offen offset:1024 sc1
    v_mfma_f32_16x16x32_bf16 a[88:91], a[136:139], v[220:223], a[88:91]
    v_exp_f32 v172, v172
    v_mfma_f32_16x16x32_bf16 a[84:87], a[140:143], v[216:219], a[84:87]
    buffer_load_dwordx4 a[216:219], v12, s[88:91], s56 offen offset:2048 sc1
    v_cvt_pk_bf16_f32 v61, v170, v171
    v_mfma_f32_16x16x32_bf16 a[92:95], a[140:143], v[220:223], a[92:95]
    v_exp_f32 v173, v173
    v_mfma_f32_16x16x32_bf16 a[96:99], a[144:147], v[216:219], a[96:99]
    buffer_load_dwordx4 a[220:223], v12, s[88:91], s56 offen offset:3072 sc1
    v_mfma_f32_16x16x32_bf16 a[104:107], a[144:147], v[220:223], a[104:107]
    v_exp_f32 v174, v174
    v_mfma_f32_16x16x32_bf16 a[100:103], a[148:151], v[216:219], a[100:103]
    buffer_load_dwordx4 a[224:227], v13, s[88:91], 0 offen offset:0 sc1
    v_cvt_pk_bf16_f32 v62, v172, v173
    v_mfma_f32_16x16x32_bf16 a[108:111], a[148:151], v[220:223], a[108:111]
    v_exp_f32 v175, v175
    v_mfma_f32_16x16x32_bf16 a[112:115], a[152:155], v[216:219], a[112:115]
    s_waitcnt lgkmcnt(0)
    v_mfma_f32_16x16x32_bf16 a[120:123], a[152:155], v[220:223], a[120:123]
    s_barrier
    v_mfma_f32_16x16x32_bf16 a[116:119], a[156:159], v[216:219], a[116:119]
    v_cvt_pk_bf16_f32 v63, v174, v175
    v_mfma_f32_16x16x32_bf16 a[124:127], a[156:159], v[220:223], a[124:127]
    v_mfma_f32_16x16x32_bf16 v[160:163], a[160:163], v[64:67], v[224:227]
    v_exp_f32 v176, v176
    v_mfma_f32_16x16x32_bf16 v[168:171], a[160:163], v[68:71], v[228:231]
    v_exp_f32 v177, v177
    v_mfma_f32_16x16x32_bf16 v[164:167], a[164:167], v[64:67], v[224:227]
    ds_read_b64_tr_b16 a[128:129], v22 offset:16384
    ds_read_b64_tr_b16 a[130:131], v22 offset:18432
    v_mfma_f32_16x16x32_bf16 v[172:175], a[164:167], v[68:71], v[228:231]
    v_exp_f32 v178, v178
    v_mfma_f32_16x16x32_bf16 v[160:163], a[168:171], v[80:83], v[160:163]
    ds_read_b64_tr_b16 a[132:133], v23 offset:16384
    v_cvt_pk_bf16_f32 v216, v176, v177
    v_mfma_f32_16x16x32_bf16 v[168:171], a[168:171], v[84:87], v[168:171]
    v_exp_f32 v179, v179
    v_mfma_f32_16x16x32_bf16 v[164:167], a[172:175], v[80:83], v[164:167]
    ds_read_b64_tr_b16 a[134:135], v23 offset:18432
    ds_read_b64_tr_b16 a[136:137], v24 offset:16384
    v_mfma_f32_16x16x32_bf16 v[172:175], a[172:175], v[84:87], v[172:175]
    v_exp_f32 v180, v180
    v_mfma_f32_16x16x32_bf16 v[160:163], a[176:179], v[96:99], v[160:163]
    ds_read_b64_tr_b16 a[138:139], v24 offset:18432
    v_cvt_pk_bf16_f32 v217, v178, v179
    v_mfma_f32_16x16x32_bf16 v[168:171], a[176:179], v[100:103], v[168:171]
    v_exp_f32 v181, v181
    v_mfma_f32_16x16x32_bf16 v[164:167], a[180:183], v[96:99], v[164:167]
    ds_read_b64_tr_b16 a[140:141], v25 offset:16384
    ds_read_b64_tr_b16 a[142:143], v25 offset:18432
    v_mfma_f32_16x16x32_bf16 v[172:175], a[180:183], v[100:103], v[172:175]
    v_exp_f32 v182, v182
    v_mfma_f32_16x16x32_bf16 v[160:163], a[184:187], v[112:115], v[160:163]
    ds_read_b64_tr_b16 a[144:145], v22 offset:20480
    v_cvt_pk_bf16_f32 v218, v180, v181
    v_mfma_f32_16x16x32_bf16 v[168:171], a[184:187], v[116:119], v[168:171]
    v_exp_f32 v183, v183
    v_mfma_f32_16x16x32_bf16 v[164:167], a[188:191], v[112:115], v[164:167]
    ds_read_b64_tr_b16 a[146:147], v22 offset:22528
    ds_read_b64_tr_b16 a[148:149], v23 offset:20480
    v_mfma_f32_16x16x32_bf16 v[172:175], a[188:191], v[116:119], v[172:175]
    v_exp_f32 v184, v184
    v_mfma_f32_16x16x32_bf16 v[192:195], a[160:163], v[72:75], v[232:235]
    ds_read_b64_tr_b16 a[150:151], v23 offset:22528
    v_cvt_pk_bf16_f32 v219, v182, v183
    v_mfma_f32_16x16x32_bf16 v[200:203], a[160:163], v[76:79], v[236:239]
    v_exp_f32 v185, v185
    v_mfma_f32_16x16x32_bf16 v[196:199], a[164:167], v[72:75], v[232:235]
    ds_read_b64_tr_b16 a[152:153], v24 offset:20480
    ds_read_b64_tr_b16 a[154:155], v24 offset:22528
    v_mfma_f32_16x16x32_bf16 v[204:207], a[164:167], v[76:79], v[236:239]
    v_exp_f32 v186, v186
    v_mfma_f32_16x16x32_bf16 v[192:195], a[168:171], v[88:91], v[192:195]
    ds_read_b64_tr_b16 a[156:157], v25 offset:20480
    v_cvt_pk_bf16_f32 v220, v184, v185
    v_mfma_f32_16x16x32_bf16 v[200:203], a[168:171], v[92:95], v[200:203]
    v_exp_f32 v187, v187
    v_mfma_f32_16x16x32_bf16 v[196:199], a[172:175], v[88:91], v[196:199]
    ds_read_b64_tr_b16 a[158:159], v25 offset:22528
    buffer_load_dwordx4 a[228:231], v13, s[88:91], 0 offen offset:1024 sc1
    v_mfma_f32_16x16x32_bf16 v[204:207], a[172:175], v[92:95], v[204:207]
    v_exp_f32 v188, v188
    v_mfma_f32_16x16x32_bf16 v[192:195], a[176:179], v[104:107], v[192:195]
    buffer_load_dwordx4 a[232:235], v13, s[88:91], 0 offen offset:2048 sc1
    v_cvt_pk_bf16_f32 v221, v186, v187
    v_mfma_f32_16x16x32_bf16 v[200:203], a[176:179], v[108:111], v[200:203]
    v_exp_f32 v189, v189
    v_mfma_f32_16x16x32_bf16 v[196:199], a[180:183], v[104:107], v[196:199]
    buffer_load_dwordx4 a[236:239], v13, s[88:91], 0 offen offset:3072 sc1
    v_mfma_f32_16x16x32_bf16 v[204:207], a[180:183], v[108:111], v[204:207]
    v_exp_f32 v190, v190
    v_mfma_f32_16x16x32_bf16 v[192:195], a[184:187], v[120:123], v[192:195]
    buffer_load_dwordx4 a[240:243], v13, s[88:91], s56 offen offset:0 sc1
    v_cvt_pk_bf16_f32 v222, v188, v189
    v_mfma_f32_16x16x32_bf16 v[200:203], a[184:187], v[124:127], v[200:203]
    v_exp_f32 v191, v191
    v_mfma_f32_16x16x32_bf16 v[196:199], a[188:191], v[120:123], v[196:199]
    buffer_load_dwordx4 a[244:247], v13, s[88:91], s56 offen offset:1024 sc1
    v_mfma_f32_16x16x32_bf16 v[204:207], a[188:191], v[124:127], v[204:207]
    buffer_load_dwordx4 a[248:251], v13, s[88:91], s56 offen offset:2048 sc1
    v_cvt_pk_bf16_f32 v223, v190, v191
    v_mfma_f32_16x16x32_bf16 v[44:47], v[36:39], v[56:59], v[44:47]
    buffer_load_dwordx4 a[252:255], v13, s[88:91], s56 offen offset:3072 sc1
    v_mfma_f32_16x16x32_bf16 v[248:251], v[36:39], v[60:63], v[248:251]
    s_waitcnt lgkmcnt(0)
    v_exp_f32 v160, v160
    v_mfma_f32_16x16x32_bf16 a[0:3], a[128:131], v[56:59], a[0:3]
    ds_read_b64_tr_b16 a[160:161], v2 offset:0
    v_mfma_f32_16x16x32_bf16 a[8:11], a[128:131], v[60:63], a[8:11]
    v_exp_f32 v161, v161
    v_mfma_f32_16x16x32_bf16 a[4:7], a[132:135], v[56:59], a[4:7]
    ds_read_b64_tr_b16 a[162:163], v2 offset:2048
    ds_read_b64_tr_b16 a[164:165], v3 offset:0
    v_mfma_f32_16x16x32_bf16 a[12:15], a[132:135], v[60:63], a[12:15]
    v_exp_f32 v162, v162
    v_mfma_f32_16x16x32_bf16 a[16:19], a[136:139], v[56:59], a[16:19]
    ds_read_b64_tr_b16 a[166:167], v3 offset:2048
    v_cvt_pk_bf16_f32 v208, v160, v161
    v_mfma_f32_16x16x32_bf16 a[24:27], a[136:139], v[60:63], a[24:27]
    v_exp_f32 v163, v163
    v_mfma_f32_16x16x32_bf16 a[20:23], a[140:143], v[56:59], a[20:23]
    ds_read_b64_tr_b16 a[168:169], v4 offset:0
    ds_read_b64_tr_b16 a[170:171], v4 offset:2048
    v_mfma_f32_16x16x32_bf16 a[28:31], a[140:143], v[60:63], a[28:31]
    v_exp_f32 v164, v164
    v_mfma_f32_16x16x32_bf16 a[32:35], a[144:147], v[56:59], a[32:35]
    ds_read_b64_tr_b16 a[172:173], v5 offset:0
    v_cvt_pk_bf16_f32 v209, v162, v163
    v_mfma_f32_16x16x32_bf16 a[40:43], a[144:147], v[60:63], a[40:43]
    v_exp_f32 v165, v165
    v_mfma_f32_16x16x32_bf16 a[36:39], a[148:151], v[56:59], a[36:39]
    ds_read_b64_tr_b16 a[174:175], v5 offset:2048
    v_mfma_f32_16x16x32_bf16 a[44:47], a[148:151], v[60:63], a[44:47]
    v_exp_f32 v166, v166
    v_mfma_f32_16x16x32_bf16 a[48:51], a[152:155], v[56:59], a[48:51]
    ds_read_b64_tr_b16 a[176:177], v2 offset:4096
    v_cvt_pk_bf16_f32 v210, v164, v165
    v_mfma_f32_16x16x32_bf16 a[56:59], a[152:155], v[60:63], a[56:59]
    v_exp_f32 v167, v167
    v_mfma_f32_16x16x32_bf16 a[52:55], a[156:159], v[56:59], a[52:55]
    ds_read_b64_tr_b16 a[178:179], v2 offset:6144
    ds_read_b64_tr_b16 a[180:181], v3 offset:4096
    v_mfma_f32_16x16x32_bf16 a[60:63], a[156:159], v[60:63], a[60:63]
    v_exp_f32 v168, v168
    v_mfma_f32_16x16x32_bf16 v[252:255], v[36:39], v[216:219], v[252:255]
    ds_read_b64_tr_b16 a[182:183], v3 offset:6144
    v_cvt_pk_bf16_f32 v211, v166, v167
    v_mfma_f32_16x16x32_bf16 v[32:35], v[36:39], v[220:223], v[32:35]
    v_exp_f32 v169, v169
    v_mfma_f32_16x16x32_bf16 a[64:67], a[128:131], v[216:219], a[64:67]
    ds_read_b64_tr_b16 a[184:185], v4 offset:4096
    ds_read_b64_tr_b16 a[186:187], v4 offset:6144
    v_mfma_f32_16x16x32_bf16 a[72:75], a[128:131], v[220:223], a[72:75]
    v_exp_f32 v170, v170
    v_mfma_f32_16x16x32_bf16 a[68:71], a[132:135], v[216:219], a[68:71]
    ds_read_b64_tr_b16 a[188:189], v5 offset:4096
    v_cvt_pk_bf16_f32 v212, v168, v169
    v_mfma_f32_16x16x32_bf16 a[76:79], a[132:135], v[220:223], a[76:79]
    v_exp_f32 v171, v171
    v_mfma_f32_16x16x32_bf16 a[80:83], a[136:139], v[216:219], a[80:83]
    ds_read_b64_tr_b16 a[190:191], v5 offset:6144
    ds_read_b64_tr_b16 v[64:65], v2 offset:8192
    v_mfma_f32_16x16x32_bf16 a[88:91], a[136:139], v[220:223], a[88:91]
    v_exp_f32 v172, v172
    v_mfma_f32_16x16x32_bf16 a[84:87], a[140:143], v[216:219], a[84:87]
    ds_read_b64_tr_b16 v[66:67], v2 offset:10240
    v_cvt_pk_bf16_f32 v213, v170, v171
    v_mfma_f32_16x16x32_bf16 a[92:95], a[140:143], v[220:223], a[92:95]
    v_exp_f32 v173, v173
    v_mfma_f32_16x16x32_bf16 a[96:99], a[144:147], v[216:219], a[96:99]
    ds_read_b64_tr_b16 v[68:69], v3 offset:8192
    ds_read_b64_tr_b16 v[70:71], v3 offset:10240
    v_mfma_f32_16x16x32_bf16 a[104:107], a[144:147], v[220:223], a[104:107]
    v_exp_f32 v174, v174
    v_mfma_f32_16x16x32_bf16 a[100:103], a[148:151], v[216:219], a[100:103]
    ds_read_b64_tr_b16 v[72:73], v4 offset:8192
    v_cvt_pk_bf16_f32 v214, v172, v173
    v_mfma_f32_16x16x32_bf16 a[108:111], a[148:151], v[220:223], a[108:111]
    v_exp_f32 v175, v175
    v_mfma_f32_16x16x32_bf16 a[112:115], a[152:155], v[216:219], a[112:115]
    ds_read_b64_tr_b16 v[74:75], v4 offset:10240
    s_waitcnt vmcnt(20)
    v_mfma_f32_16x16x32_bf16 a[120:123], a[152:155], v[220:223], a[120:123]
    s_barrier
    v_mfma_f32_16x16x32_bf16 a[116:119], a[156:159], v[216:219], a[116:119]
    ds_read_b64_tr_b16 v[76:77], v5 offset:8192
    v_cvt_pk_bf16_f32 v215, v174, v175
    v_mfma_f32_16x16x32_bf16 a[124:127], a[156:159], v[220:223], a[124:127]
    ds_read_b64_tr_b16 v[78:79], v5 offset:10240
    ds_read_b64_tr_b16 a[128:129], v22 offset:24576
    ds_read_b64_tr_b16 a[130:131], v22 offset:26624
    ds_read_b64_tr_b16 a[132:133], v23 offset:24576
    ds_read_b64_tr_b16 a[134:135], v23 offset:26624
    ds_read_b64_tr_b16 a[136:137], v24 offset:24576
    ds_read_b64_tr_b16 a[138:139], v24 offset:26624
    ds_read_b64_tr_b16 a[140:141], v25 offset:24576
    ds_read_b64_tr_b16 a[142:143], v25 offset:26624
    ds_read_b64_tr_b16 a[144:145], v22 offset:28672
    ds_read_b64_tr_b16 a[146:147], v22 offset:30720
    ds_read_b64_tr_b16 a[148:149], v23 offset:28672
    ds_read_b64_tr_b16 a[150:151], v23 offset:30720
    ds_read_b64_tr_b16 a[152:153], v24 offset:28672
    ds_read_b64_tr_b16 a[154:155], v24 offset:30720
    ds_read_b64_tr_b16 a[156:157], v25 offset:28672
    ds_read_b64_tr_b16 a[158:159], v25 offset:30720
    s_and_b32 s46, s41, 3
    s_lshl_b32 s46, s46, 10
    s_lshl_b32 s47, s40, 14
    s_add_u32 s46, s46, s47
    v_add_u32 v224, s46, v6
    v_xor_b32 v225, 1024, v224
    v_xor_b32 v226, 2048, v224
    v_xor_b32 v227, 3072, v224
    v_add_u32 v228, s46, v7
    v_xor_b32 v229, 1024, v228
    v_xor_b32 v230, 2048, v228
    v_xor_b32 v231, 3072, v228
    v_exp_f32 v192, v192
    v_exp_f32 v193, v193
    v_mfma_f32_16x16x32_bf16 v[44:47], v[36:39], v[208:211], v[44:47]
    v_exp_f32 v194, v194
    v_mfma_f32_16x16x32_bf16 v[248:251], v[36:39], v[212:215], v[248:251]
    v_cvt_pk_bf16_f32 v216, v192, v193
    v_exp_f32 v195, v195
    s_waitcnt lgkmcnt(0)
    v_mfma_f32_16x16x32_bf16 a[0:3], a[128:131], v[208:211], a[0:3]
    s_barrier
    v_exp_f32 v196, v196
    v_mfma_f32_16x16x32_bf16 a[8:11], a[128:131], v[212:215], a[8:11]
    v_cvt_pk_bf16_f32 v217, v194, v195
    v_exp_f32 v197, v197
    v_mfma_f32_16x16x32_bf16 a[4:7], a[132:135], v[208:211], a[4:7]
    v_exp_f32 v198, v198
    v_mfma_f32_16x16x32_bf16 a[12:15], a[132:135], v[212:215], a[12:15]
    v_cvt_pk_bf16_f32 v218, v196, v197
    v_exp_f32 v199, v199
    v_mfma_f32_16x16x32_bf16 a[16:19], a[136:139], v[208:211], a[16:19]
    v_exp_f32 v200, v200
    v_mfma_f32_16x16x32_bf16 a[24:27], a[136:139], v[212:215], a[24:27]
    v_cvt_pk_bf16_f32 v219, v198, v199
    v_exp_f32 v201, v201
    v_mfma_f32_16x16x32_bf16 a[20:23], a[140:143], v[208:211], a[20:23]
    v_exp_f32 v202, v202
    v_mfma_f32_16x16x32_bf16 a[28:31], a[140:143], v[212:215], a[28:31]
    v_cvt_pk_bf16_f32 v220, v200, v201
    v_exp_f32 v203, v203
    v_mfma_f32_16x16x32_bf16 a[32:35], a[144:147], v[208:211], a[32:35]
    v_exp_f32 v204, v204
    v_mfma_f32_16x16x32_bf16 a[40:43], a[144:147], v[212:215], a[40:43]
    v_cvt_pk_bf16_f32 v221, v202, v203
    v_exp_f32 v205, v205
    v_mfma_f32_16x16x32_bf16 a[36:39], a[148:151], v[208:211], a[36:39]
    v_exp_f32 v206, v206
    v_mfma_f32_16x16x32_bf16 a[44:47], a[148:151], v[212:215], a[44:47]
    v_cvt_pk_bf16_f32 v222, v204, v205
    v_exp_f32 v207, v207
    v_mfma_f32_16x16x32_bf16 a[48:51], a[152:155], v[208:211], a[48:51]
    s_add_u32 m0, s43, 0
    s_mov_b32 s44, 196608
    v_cvt_pk_bf16_f32 v223, v206, v207
    v_mfma_f32_16x16x32_bf16 a[56:59], a[152:155], v[212:215], a[56:59]
    buffer_load_dwordx4 v14, s[20:23], s44 offen offset:0 lds
    v_mfma_f32_16x16x32_bf16 a[52:55], a[156:159], v[208:211], a[52:55]
    buffer_load_dwordx4 v15, s[20:23], s44 offen offset:1024 lds
    v_mfma_f32_16x16x32_bf16 a[60:63], a[156:159], v[212:215], a[60:63]
    buffer_load_dwordx4 v16, s[20:23], s44 offen offset:2048 lds
    v_mfma_f32_16x16x32_bf16 v[252:255], v[36:39], v[216:219], v[252:255]
    buffer_load_dwordx4 v17, s[20:23], s44 offen offset:3072 lds
    v_mfma_f32_16x16x32_bf16 v[32:35], v[36:39], v[220:223], v[32:35]
    ds_read_b64_tr_b16 v[80:81], v2 offset:12288
    v_mfma_f32_16x16x32_bf16 a[64:67], a[128:131], v[216:219], a[64:67]
    ds_read_b64_tr_b16 v[82:83], v2 offset:14336
    ds_read_b64_tr_b16 v[84:85], v3 offset:12288
    v_mfma_f32_16x16x32_bf16 a[72:75], a[128:131], v[220:223], a[72:75]
    ds_read_b64_tr_b16 v[86:87], v3 offset:14336
    ds_read_b64_tr_b16 v[88:89], v4 offset:12288
    v_mfma_f32_16x16x32_bf16 a[68:71], a[132:135], v[216:219], a[68:71]
    ds_read_b64_tr_b16 v[90:91], v4 offset:14336
    ds_read_b64_tr_b16 v[92:93], v5 offset:12288
    v_mfma_f32_16x16x32_bf16 a[76:79], a[132:135], v[220:223], a[76:79]
    ds_read_b64_tr_b16 v[94:95], v5 offset:14336
    ds_read_b64_tr_b16 v[96:97], v2 offset:16384
    v_mfma_f32_16x16x32_bf16 a[80:83], a[136:139], v[216:219], a[80:83]
    ds_read_b64_tr_b16 v[98:99], v2 offset:18432
    ds_read_b64_tr_b16 v[100:101], v3 offset:16384
    v_mfma_f32_16x16x32_bf16 a[88:91], a[136:139], v[220:223], a[88:91]
    ds_read_b64_tr_b16 v[102:103], v3 offset:18432
    ds_read_b64_tr_b16 v[104:105], v4 offset:16384
    v_mfma_f32_16x16x32_bf16 a[84:87], a[140:143], v[216:219], a[84:87]
    ds_read_b64_tr_b16 v[106:107], v4 offset:18432
    ds_read_b64_tr_b16 v[108:109], v5 offset:16384
    v_mfma_f32_16x16x32_bf16 a[92:95], a[140:143], v[220:223], a[92:95]
    ds_read_b64_tr_b16 v[110:111], v5 offset:18432
    v_mfma_f32_16x16x32_bf16 a[96:99], a[144:147], v[216:219], a[96:99]
    s_add_u32 m0, s43, 8192
    s_mov_b32 s44, 229376
    v_mfma_f32_16x16x32_bf16 a[104:107], a[144:147], v[220:223], a[104:107]
    buffer_load_dwordx4 v14, s[20:23], s44 offen offset:0 lds
    v_mfma_f32_16x16x32_bf16 a[100:103], a[148:151], v[216:219], a[100:103]
    buffer_load_dwordx4 v15, s[20:23], s44 offen offset:1024 lds
    v_mfma_f32_16x16x32_bf16 a[108:111], a[148:151], v[220:223], a[108:111]
    buffer_load_dwordx4 v16, s[20:23], s44 offen offset:2048 lds
    v_mfma_f32_16x16x32_bf16 a[112:115], a[152:155], v[216:219], a[112:115]
    buffer_load_dwordx4 v17, s[20:23], s44 offen offset:3072 lds
    v_mfma_f32_16x16x32_bf16 a[120:123], a[152:155], v[220:223], a[120:123]
    v_rcp_f32 v240, v44
    v_mfma_f32_16x16x32_bf16 a[116:119], a[156:159], v[216:219], a[116:119]
    v_rcp_f32 v242, v248
    v_mfma_f32_16x16x32_bf16 a[124:127], a[156:159], v[220:223], a[124:127]
    v_rcp_f32 v244, v252
    v_rcp_f32 v246, v32
    v_add_f32 v51, v44, v248
    v_add_f32 v52, v252, v32
    s_mov_b32 s47, 0x53800000
    v_add_f32 v51, v51, v52
    v_cmp_nge_f32 vcc, s47, v51
    v_and_b32 v52, 3, v1
    v_mul_u32_u24 v52, 24576, v52
    s_cmp_lg_u64 vcc, 0
    s_cselect_b32 s47, 1, 0
    v_mov_b32 v50, s47
    s_lshl_b32 s47, s40, 2
    s_add_u32 s47, s47, 65536
    v_add_u32 v52, s47, v52
    v_mov_b32 v51, s43
    ds_write_b32 v52, v50 offset:4096
    s_waitcnt vmcnt(24)
    ds_read_b64_tr_b16 a[128:129], v2 offset:20480
    ds_read_b64_tr_b16 a[130:131], v2 offset:22528
    ds_read_b64_tr_b16 a[132:133], v3 offset:20480
    ds_read_b64_tr_b16 a[134:135], v3 offset:22528
    ds_read_b64_tr_b16 a[136:137], v4 offset:20480
    ds_read_b64_tr_b16 a[138:139], v4 offset:22528
    ds_read_b64_tr_b16 a[140:141], v5 offset:20480
    ds_read_b64_tr_b16 a[142:143], v5 offset:22528
    v_accvgpr_read_b32 v128, a0
    v_accvgpr_read_b32 v129, a1
    v_accvgpr_read_b32 v130, a2
    v_accvgpr_read_b32 v131, a3
    v_accvgpr_read_b32 v132, a4
    v_accvgpr_read_b32 v133, a5
    v_accvgpr_read_b32 v134, a6
    v_accvgpr_read_b32 v135, a7
    v_pk_mul_f32 v[128:129], v[128:129], v[240:241] op_sel_hi:[1,0]
    v_pk_mul_f32 v[130:131], v[130:131], v[240:241] op_sel_hi:[1,0]
    v_pk_mul_f32 v[132:133], v[132:133], v[240:241] op_sel_hi:[1,0]
    v_pk_mul_f32 v[134:135], v[134:135], v[240:241] op_sel_hi:[1,0]
    v_cvt_pk_bf16_f32 v128, v128, v129
    v_cvt_pk_bf16_f32 v129, v130, v131
    v_cvt_pk_bf16_f32 v130, v132, v133
    v_cvt_pk_bf16_f32 v131, v134, v135
    ds_write_b128 v224, v[128:131] offset:0
    v_accvgpr_read_b32 v136, a8
    v_accvgpr_read_b32 v137, a9
    v_accvgpr_read_b32 v138, a10
    v_accvgpr_read_b32 v139, a11
    v_accvgpr_read_b32 v140, a12
    v_accvgpr_read_b32 v141, a13
    v_accvgpr_read_b32 v142, a14
    v_accvgpr_read_b32 v143, a15
    v_pk_mul_f32 v[136:137], v[136:137], v[242:243] op_sel_hi:[1,0]
    v_pk_mul_f32 v[138:139], v[138:139], v[242:243] op_sel_hi:[1,0]
    v_pk_mul_f32 v[140:141], v[140:141], v[242:243] op_sel_hi:[1,0]
    v_pk_mul_f32 v[142:143], v[142:143], v[242:243] op_sel_hi:[1,0]
    v_cvt_pk_bf16_f32 v136, v136, v137
    v_cvt_pk_bf16_f32 v137, v138, v139
    v_cvt_pk_bf16_f32 v138, v140, v141
    v_cvt_pk_bf16_f32 v139, v142, v143
    ds_write_b128 v225, v[136:139] offset:0
    v_accvgpr_read_b32 v144, a16
    v_accvgpr_read_b32 v145, a17
    v_accvgpr_read_b32 v146, a18
    v_accvgpr_read_b32 v147, a19
    v_accvgpr_read_b32 v148, a20
    v_accvgpr_read_b32 v149, a21
    v_accvgpr_read_b32 v150, a22
    v_accvgpr_read_b32 v151, a23
    v_pk_mul_f32 v[144:145], v[144:145], v[240:241] op_sel_hi:[1,0]
    v_pk_mul_f32 v[146:147], v[146:147], v[240:241] op_sel_hi:[1,0]
    v_pk_mul_f32 v[148:149], v[148:149], v[240:241] op_sel_hi:[1,0]
    v_pk_mul_f32 v[150:151], v[150:151], v[240:241] op_sel_hi:[1,0]
    v_cvt_pk_bf16_f32 v144, v144, v145
    v_cvt_pk_bf16_f32 v145, v146, v147
    v_cvt_pk_bf16_f32 v146, v148, v149
    v_cvt_pk_bf16_f32 v147, v150, v151
    ds_write_b128 v228, v[144:147] offset:4096
    v_accvgpr_read_b32 v152, a24
    v_accvgpr_read_b32 v153, a25
    v_accvgpr_read_b32 v154, a26
    v_accvgpr_read_b32 v155, a27
    v_accvgpr_read_b32 v156, a28
    v_accvgpr_read_b32 v157, a29
    v_accvgpr_read_b32 v158, a30
    v_accvgpr_read_b32 v159, a31
    v_pk_mul_f32 v[152:153], v[152:153], v[242:243] op_sel_hi:[1,0]
    v_pk_mul_f32 v[154:155], v[154:155], v[242:243] op_sel_hi:[1,0]
    v_pk_mul_f32 v[156:157], v[156:157], v[242:243] op_sel_hi:[1,0]
    v_pk_mul_f32 v[158:159], v[158:159], v[242:243] op_sel_hi:[1,0]
    v_cvt_pk_bf16_f32 v152, v152, v153
    v_cvt_pk_bf16_f32 v153, v154, v155
    v_cvt_pk_bf16_f32 v154, v156, v157
    v_cvt_pk_bf16_f32 v155, v158, v159
    ds_write_b128 v229, v[152:155] offset:4096
    v_accvgpr_read_b32 v160, a32
    v_accvgpr_read_b32 v161, a33
    v_accvgpr_read_b32 v162, a34
    v_accvgpr_read_b32 v163, a35
    v_accvgpr_read_b32 v164, a36
    v_accvgpr_read_b32 v165, a37
    v_accvgpr_read_b32 v166, a38
    v_accvgpr_read_b32 v167, a39
    v_pk_mul_f32 v[160:161], v[160:161], v[240:241] op_sel_hi:[1,0]
    v_pk_mul_f32 v[162:163], v[162:163], v[240:241] op_sel_hi:[1,0]
    v_pk_mul_f32 v[164:165], v[164:165], v[240:241] op_sel_hi:[1,0]
    v_pk_mul_f32 v[166:167], v[166:167], v[240:241] op_sel_hi:[1,0]
    v_cvt_pk_bf16_f32 v160, v160, v161
    v_cvt_pk_bf16_f32 v161, v162, v163
    v_cvt_pk_bf16_f32 v162, v164, v165
    v_cvt_pk_bf16_f32 v163, v166, v167
    ds_write_b128 v224, v[160:163] offset:8192
    s_waitcnt lgkmcnt(14)
    s_add_u32 m0, s43, 12288
    s_mov_b32 s44, 262144
    buffer_load_dwordx4 v14, s[20:23], s44 offen offset:0 lds
    v_accvgpr_read_b32 v168, a40
    v_accvgpr_read_b32 v169, a41
    v_accvgpr_read_b32 v170, a42
    v_accvgpr_read_b32 v171, a43
    v_accvgpr_read_b32 v172, a44
    v_accvgpr_read_b32 v173, a45
    v_accvgpr_read_b32 v174, a46
    v_accvgpr_read_b32 v175, a47
    v_pk_mul_f32 v[168:169], v[168:169], v[242:243] op_sel_hi:[1,0]
    v_pk_mul_f32 v[170:171], v[170:171], v[242:243] op_sel_hi:[1,0]
    v_pk_mul_f32 v[172:173], v[172:173], v[242:243] op_sel_hi:[1,0]
    v_pk_mul_f32 v[174:175], v[174:175], v[242:243] op_sel_hi:[1,0]
    v_cvt_pk_bf16_f32 v168, v168, v169
    v_cvt_pk_bf16_f32 v169, v170, v171
    v_cvt_pk_bf16_f32 v170, v172, v173
    v_cvt_pk_bf16_f32 v171, v174, v175
    ds_write_b128 v225, v[168:171] offset:8192
    buffer_load_dwordx4 v15, s[20:23], s44 offen offset:1024 lds
    v_accvgpr_read_b32 v176, a48
    v_accvgpr_read_b32 v177, a49
    v_accvgpr_read_b32 v178, a50
    v_accvgpr_read_b32 v179, a51
    v_accvgpr_read_b32 v180, a52
    v_accvgpr_read_b32 v181, a53
    v_accvgpr_read_b32 v182, a54
    v_accvgpr_read_b32 v183, a55
    v_pk_mul_f32 v[176:177], v[176:177], v[240:241] op_sel_hi:[1,0]
    v_pk_mul_f32 v[178:179], v[178:179], v[240:241] op_sel_hi:[1,0]
    v_pk_mul_f32 v[180:181], v[180:181], v[240:241] op_sel_hi:[1,0]
    v_pk_mul_f32 v[182:183], v[182:183], v[240:241] op_sel_hi:[1,0]
    v_cvt_pk_bf16_f32 v176, v176, v177
    v_cvt_pk_bf16_f32 v177, v178, v179
    v_cvt_pk_bf16_f32 v178, v180, v181
    v_cvt_pk_bf16_f32 v179, v182, v183
    ds_write_b128 v228, v[176:179] offset:12288
    buffer_load_dwordx4 v16, s[20:23], s44 offen offset:2048 lds
    v_accvgpr_read_b32 v184, a56
    v_accvgpr_read_b32 v185, a57
    v_accvgpr_read_b32 v186, a58
    v_accvgpr_read_b32 v187, a59
    v_accvgpr_read_b32 v188, a60
    v_accvgpr_read_b32 v189, a61
    v_accvgpr_read_b32 v190, a62
    v_accvgpr_read_b32 v191, a63
    v_pk_mul_f32 v[184:185], v[184:185], v[242:243] op_sel_hi:[1,0]
    v_pk_mul_f32 v[186:187], v[186:187], v[242:243] op_sel_hi:[1,0]
    v_pk_mul_f32 v[188:189], v[188:189], v[242:243] op_sel_hi:[1,0]
    v_pk_mul_f32 v[190:191], v[190:191], v[242:243] op_sel_hi:[1,0]
    v_cvt_pk_bf16_f32 v184, v184, v185
    v_cvt_pk_bf16_f32 v185, v186, v187
    v_cvt_pk_bf16_f32 v186, v188, v189
    v_cvt_pk_bf16_f32 v187, v190, v191
    ds_write_b128 v229, v[184:187] offset:12288
    buffer_load_dwordx4 v17, s[20:23], s44 offen offset:3072 lds
    v_accvgpr_read_b32 v128, a64
    v_accvgpr_read_b32 v129, a65
    v_accvgpr_read_b32 v130, a66
    v_accvgpr_read_b32 v131, a67
    v_accvgpr_read_b32 v132, a68
    v_accvgpr_read_b32 v133, a69
    v_accvgpr_read_b32 v134, a70
    v_accvgpr_read_b32 v135, a71
    v_pk_mul_f32 v[128:129], v[128:129], v[244:245] op_sel_hi:[1,0]
    v_pk_mul_f32 v[130:131], v[130:131], v[244:245] op_sel_hi:[1,0]
    v_pk_mul_f32 v[132:133], v[132:133], v[244:245] op_sel_hi:[1,0]
    v_pk_mul_f32 v[134:135], v[134:135], v[244:245] op_sel_hi:[1,0]
    v_cvt_pk_bf16_f32 v128, v128, v129
    v_cvt_pk_bf16_f32 v129, v130, v131
    v_cvt_pk_bf16_f32 v130, v132, v133
    v_cvt_pk_bf16_f32 v131, v134, v135
    ds_write_b128 v226, v[128:131] offset:0
    s_add_u32 m0, s43, 16384
    s_mov_b32 s44, 294912
    buffer_load_dwordx4 v14, s[20:23], s44 offen offset:0 lds
    v_accvgpr_read_b32 v136, a72
    v_accvgpr_read_b32 v137, a73
    v_accvgpr_read_b32 v138, a74
    v_accvgpr_read_b32 v139, a75
    v_accvgpr_read_b32 v140, a76
    v_accvgpr_read_b32 v141, a77
    v_accvgpr_read_b32 v142, a78
    v_accvgpr_read_b32 v143, a79
    v_pk_mul_f32 v[136:137], v[136:137], v[246:247] op_sel_hi:[1,0]
    v_pk_mul_f32 v[138:139], v[138:139], v[246:247] op_sel_hi:[1,0]
    v_pk_mul_f32 v[140:141], v[140:141], v[246:247] op_sel_hi:[1,0]
    v_pk_mul_f32 v[142:143], v[142:143], v[246:247] op_sel_hi:[1,0]
    v_cvt_pk_bf16_f32 v136, v136, v137
    v_cvt_pk_bf16_f32 v137, v138, v139
    v_cvt_pk_bf16_f32 v138, v140, v141
    v_cvt_pk_bf16_f32 v139, v142, v143
    ds_write_b128 v227, v[136:139] offset:0
    buffer_load_dwordx4 v15, s[20:23], s44 offen offset:1024 lds
    v_accvgpr_read_b32 v144, a80
    v_accvgpr_read_b32 v145, a81
    v_accvgpr_read_b32 v146, a82
    v_accvgpr_read_b32 v147, a83
    v_accvgpr_read_b32 v148, a84
    v_accvgpr_read_b32 v149, a85
    v_accvgpr_read_b32 v150, a86
    v_accvgpr_read_b32 v151, a87
    v_pk_mul_f32 v[144:145], v[144:145], v[244:245] op_sel_hi:[1,0]
    v_pk_mul_f32 v[146:147], v[146:147], v[244:245] op_sel_hi:[1,0]
    v_pk_mul_f32 v[148:149], v[148:149], v[244:245] op_sel_hi:[1,0]
    v_pk_mul_f32 v[150:151], v[150:151], v[244:245] op_sel_hi:[1,0]
    v_cvt_pk_bf16_f32 v144, v144, v145
    v_cvt_pk_bf16_f32 v145, v146, v147
L_pg9:
    s_cbranch_execz L_pgret
    v_cvt_pk_bf16_f32 v146, v148, v149
    v_cvt_pk_bf16_f32 v147, v150, v151
    ds_write_b128 v230, v[144:147] offset:4096
    buffer_load_dwordx4 v16, s[20:23], s44 offen offset:2048 lds
    v_accvgpr_read_b32 v152, a88
    v_accvgpr_read_b32 v153, a89
    v_accvgpr_read_b32 v154, a90
    v_accvgpr_read_b32 v155, a91
    v_accvgpr_read_b32 v156, a92
    v_accvgpr_read_b32 v157, a93
    v_accvgpr_read_b32 v158, a94
    v_accvgpr_read_b32 v159, a95
    v_pk_mul_f32 v[152:153], v[152:153], v[246:247] op_sel_hi:[1,0]
    v_pk_mul_f32 v[154:155], v[154:155], v[246:247] op_sel_hi:[1,0]
    v_pk_mul_f32 v[156:157], v[156:157], v[246:247] op_sel_hi:[1,0]
    v_pk_mul_f32 v[158:159], v[158:159], v[246:247] op_sel_hi:[1,0]
    v_cvt_pk_bf16_f32 v152, v152, v153
    v_cvt_pk_bf16_f32 v153, v154, v155
    v_cvt_pk_bf16_f32 v154, v156, v157
    v_cvt_pk_bf16_f32 v155, v158, v159
    ds_write_b128 v231, v[152:155] offset:4096
    buffer_load_dwordx4 v17, s[20:23], s44 offen offset:3072 lds
    v_accvgpr_read_b32 v160, a96
    v_accvgpr_read_b32 v161, a97
    v_accvgpr_read_b32 v162, a98
    v_accvgpr_read_b32 v163, a99
    v_accvgpr_read_b32 v164, a100
    v_accvgpr_read_b32 v165, a101
    v_accvgpr_read_b32 v166, a102
    v_accvgpr_read_b32 v167, a103
    v_pk_mul_f32 v[160:161], v[160:161], v[244:245] op_sel_hi:[1,0]
    v_pk_mul_f32 v[162:163], v[162:163], v[244:245] op_sel_hi:[1,0]
    v_pk_mul_f32 v[164:165], v[164:165], v[244:245] op_sel_hi:[1,0]
    v_pk_mul_f32 v[166:167], v[166:167], v[244:245] op_sel_hi:[1,0]
    v_cvt_pk_bf16_f32 v160, v160, v161
    v_cvt_pk_bf16_f32 v161, v162, v163
    v_cvt_pk_bf16_f32 v162, v164, v165
    v_cvt_pk_bf16_f32 v163, v166, v167
    ds_write_b128 v226, v[160:163] offset:8192
    s_waitcnt lgkmcnt(13)
    s_add_u32 m0, s43, 20480
    s_mov_b32 s44, 327680
    buffer_load_dwordx4 v14, s[20:23], s44 offen offset:0 lds
    v_accvgpr_read_b32 v168, a104
    v_accvgpr_read_b32 v169, a105
    v_accvgpr_read_b32 v170, a106
    v_accvgpr_read_b32 v171, a107
    v_accvgpr_read_b32 v172, a108
    v_accvgpr_read_b32 v173, a109
    v_accvgpr_read_b32 v174, a110
    v_accvgpr_read_b32 v175, a111
    v_pk_mul_f32 v[168:169], v[168:169], v[246:247] op_sel_hi:[1,0]
    v_pk_mul_f32 v[170:171], v[170:171], v[246:247] op_sel_hi:[1,0]
    v_pk_mul_f32 v[172:173], v[172:173], v[246:247] op_sel_hi:[1,0]
    v_pk_mul_f32 v[174:175], v[174:175], v[246:247] op_sel_hi:[1,0]
    v_cvt_pk_bf16_f32 v168, v168, v169
    v_cvt_pk_bf16_f32 v169, v170, v171
    v_cvt_pk_bf16_f32 v170, v172, v173
    v_cvt_pk_bf16_f32 v171, v174, v175
    ds_write_b128 v227, v[168:171] offset:8192
    buffer_load_dwordx4 v15, s[20:23], s44 offen offset:1024 lds
    v_accvgpr_read_b32 v176, a112
    v_accvgpr_read_b32 v177, a113
    v_accvgpr_read_b32 v178, a114
    v_accvgpr_read_b32 v179, a115
    v_accvgpr_read_b32 v180, a116
    v_accvgpr_read_b32 v181, a117
    v_accvgpr_read_b32 v182, a118
    v_accvgpr_read_b32 v183, a119
    v_pk_mul_f32 v[176:177], v[176:177], v[244:245] op_sel_hi:[1,0]
    v_pk_mul_f32 v[178:179], v[178:179], v[244:245] op_sel_hi:[1,0]
    v_pk_mul_f32 v[180:181], v[180:181], v[244:245] op_sel_hi:[1,0]
    v_pk_mul_f32 v[182:183], v[182:183], v[244:245] op_sel_hi:[1,0]
    v_cvt_pk_bf16_f32 v176, v176, v177
    v_cvt_pk_bf16_f32 v177, v178, v179
    v_cvt_pk_bf16_f32 v178, v180, v181
    v_cvt_pk_bf16_f32 v179, v182, v183
    ds_write_b128 v230, v[176:179] offset:12288
    buffer_load_dwordx4 v16, s[20:23], s44 offen offset:2048 lds
    v_accvgpr_read_b32 v184, a120
    v_accvgpr_read_b32 v185, a121
    v_accvgpr_read_b32 v186, a122
    v_accvgpr_read_b32 v187, a123
    v_accvgpr_read_b32 v188, a124
    v_accvgpr_read_b32 v189, a125
    v_accvgpr_read_b32 v190, a126
    v_accvgpr_read_b32 v191, a127
    v_pk_mul_f32 v[184:185], v[184:185], v[246:247] op_sel_hi:[1,0]
    v_pk_mul_f32 v[186:187], v[186:187], v[246:247] op_sel_hi:[1,0]
    v_pk_mul_f32 v[188:189], v[188:189], v[246:247] op_sel_hi:[1,0]
    v_pk_mul_f32 v[190:191], v[190:191], v[246:247] op_sel_hi:[1,0]
    v_cvt_pk_bf16_f32 v184, v184, v185
    v_cvt_pk_bf16_f32 v185, v186, v187
    v_cvt_pk_bf16_f32 v186, v188, v189
    v_cvt_pk_bf16_f32 v187, v190, v191
    ds_write_b128 v231, v[184:187] offset:12288
    buffer_load_dwordx4 v17, s[20:23], s44 offen offset:3072 lds
    s_waitcnt vmcnt(16)
    ds_read_b64_tr_b16 a[144:145], v2 offset:0
    ds_read_b64_tr_b16 a[146:147], v2 offset:2048
    ds_read_b64_tr_b16 a[148:149], v3 offset:0
    ds_read_b64_tr_b16 a[150:151], v3 offset:2048
    ds_read_b64_tr_b16 a[152:153], v4 offset:0
    ds_read_b64_tr_b16 a[154:155], v4 offset:2048
    ds_read_b64_tr_b16 a[156:157], v5 offset:0
    ds_read_b64_tr_b16 a[158:159], v5 offset:2048
    s_waitcnt lgkmcnt(0)
    s_barrier
    ds_read_b128 v[56:59], v51 offset:4096
    ds_read_b128 a[0:3], v6 offset:0
    ds_read_b128 a[4:7], v6 offset:1024
    ds_read_b128 a[8:11], v6 offset:2048
    ds_read_b128 a[12:15], v6 offset:3072
    s_waitcnt lgkmcnt(4)
    v_or3_b32 v50, v56, v57, v58
    v_or_b32 v50, v50, v59
    s_nop 0
    v_readfirstlane_b32 s46, v50
    s_nop 0
    s_andn2_b32 s46, s46, s54
    s_cbranch_scc1 L_slow
    s_add_u32 m0, s43, 4096
    s_mov_b32 s44, 360448
    buffer_load_dwordx4 v14, s[20:23], s44 offen offset:0 lds
    buffer_load_dwordx4 v15, s[20:23], s44 offen offset:1024 lds
    buffer_load_dwordx4 v16, s[20:23], s44 offen offset:2048 lds
    buffer_load_dwordx4 v17, s[20:23], s44 offen offset:3072 lds
    s_waitcnt lgkmcnt(0)
    v_mfma_f32_16x16x32_bf16 v[192:195], a[160:163], a[0:3], 0
    s_add_u32 m0, s43, 0
    s_mov_b32 s44, 393216
    v_mfma_f32_16x16x32_bf16 v[200:203], a[160:163], a[4:7], 0
    ds_read_b128 a[16:19], v7 offset:4096
    v_bfe_u32 v51, v0, 4, 2
    v_mfma_f32_16x16x32_bf16 v[208:211], a[160:163], a[8:11], 0
    ds_read_b128 a[20:23], v7 offset:5120
    v_lshlrev_b32 v51, 3, v51
    v_mfma_f32_16x16x32_bf16 v[216:219], a[160:163], a[12:15], 0
    buffer_load_dwordx4 v14, s[20:23], s44 offen offset:0 lds
    v_mfma_f32_16x16x32_bf16 v[220:223], a[164:167], a[12:15], 0
    ds_read_b128 a[24:27], v7 offset:6144
    v_and_b32 v8, 15, v0
    v_mfma_f32_16x16x32_bf16 v[212:215], a[164:167], a[8:11], 0
    ds_read_b128 a[28:31], v7 offset:7168
    v_lshl_add_u32 v50, v8, 10, v51
    v_mfma_f32_16x16x32_bf16 v[204:207], a[164:167], a[4:7], 0
    s_mov_b32 s46, 0x4275fdf0
    v_bfe_u32 v8, v0, 4, 1
    v_mfma_f32_16x16x32_bf16 v[196:199], a[164:167], a[0:3], 0
    buffer_load_dwordx4 v15, s[20:23], s44 offen offset:1024 lds
    v_mfma_f32_16x16x32_bf16 v[160:163], a[168:171], a[0:3], 0
    v_mul_u32_u24 v8, 24, v8
    v_add_u32 v52, v50, v8
    v_mfma_f32_16x16x32_bf16 v[168:171], a[168:171], a[4:7], 0
    v_mfma_f32_16x16x32_bf16 v[176:179], a[168:171], a[8:11], 0
    v_mfma_f32_16x16x32_bf16 v[184:187], a[168:171], a[12:15], 0
    buffer_load_dwordx4 v16, s[20:23], s44 offen offset:2048 lds
    v_mfma_f32_16x16x32_bf16 v[188:191], a[172:175], a[12:15], 0
    v_mfma_f32_16x16x32_bf16 v[180:183], a[172:175], a[8:11], 0
    v_mfma_f32_16x16x32_bf16 v[172:175], a[172:175], a[4:7], 0
    v_mfma_f32_16x16x32_bf16 v[164:167], a[172:175], a[0:3], 0
    buffer_load_dwordx4 v17, s[20:23], s44 offen offset:3072 lds
    s_waitcnt lgkmcnt(0)
    v_mfma_f32_16x16x32_bf16 v[192:195], a[176:179], a[16:19], v[192:195]
    ds_read_b128 a[32:35], v6 offset:8192
    v_mfma_f32_16x16x32_bf16 v[200:203], a[176:179], a[20:23], v[200:203]
    ds_read_b128 a[36:39], v6 offset:9216
    v_mfma_f32_16x16x32_bf16 v[208:211], a[176:179], a[24:27], v[208:211]
    ds_read_b128 a[40:43], v6 offset:10240
    v_mfma_f32_16x16x32_bf16 v[216:219], a[176:179], a[28:31], v[216:219]
    ds_read_b128 a[44:47], v6 offset:11264
    v_mfma_f32_16x16x32_bf16 v[220:223], a[180:183], a[28:31], v[220:223]
    s_waitcnt vmcnt(20)
    v_mfma_f32_16x16x32_bf16 v[212:215], a[180:183], a[24:27], v[212:215]
    ds_read_b64_tr_b16 a[160:161], v2 offset:8192
    v_mfma_f32_16x16x32_bf16 v[204:207], a[180:183], a[20:23], v[204:207]
    ds_read_b64_tr_b16 a[162:163], v2 offset:10240
    v_mfma_f32_16x16x32_bf16 v[196:199], a[180:183], a[16:19], v[196:199]
    ds_read_b64_tr_b16 a[164:165], v3 offset:8192
    v_mfma_f32_16x16x32_bf16 v[160:163], a[184:187], a[16:19], v[160:163]
    ds_read_b64_tr_b16 a[166:167], v3 offset:10240
    v_mfma_f32_16x16x32_bf16 v[168:171], a[184:187], a[20:23], v[168:171]
    ds_read_b64_tr_b16 a[168:169], v4 offset:8192
    v_mfma_f32_16x16x32_bf16 v[176:179], a[184:187], a[24:27], v[176:179]
    ds_read_b64_tr_b16 a[170:171], v4 offset:10240
    v_mfma_f32_16x16x32_bf16 v[184:187], a[184:187], a[28:31], v[184:187]
    ds_read_b64_tr_b16 a[172:173], v5 offset:8192
    v_mfma_f32_16x16x32_bf16 v[188:191], a[188:191], a[28:31], v[188:191]
    ds_read_b64_tr_b16 a[174:175], v5 offset:10240
    v_mfma_f32_16x16x32_bf16 v[180:183], a[188:191], a[24:27], v[180:183]
    v_mfma_f32_16x16x32_bf16 v[172:175], a[188:191], a[20:23], v[172:175]
    v_mfma_f32_16x16x32_bf16 v[164:167], a[188:191], a[16:19], v[164:167]
    s_waitcnt lgkmcnt(0)
    v_mfma_f32_16x16x32_bf16 v[192:195], v[64:67], a[32:35], v[192:195]
    s_add_u32 m0, s43, 8192
    s_mov_b32 s44, 425984
    v_mfma_f32_16x16x32_bf16 v[200:203], v[64:67], a[36:39], v[200:203]
    ds_read_b128 a[48:51], v7 offset:12288
    ds_read_b128 a[52:55], v7 offset:13312
    v_mfma_f32_16x16x32_bf16 v[208:211], v[64:67], a[40:43], v[208:211]
    ds_read_b128 a[56:59], v7 offset:14336
    ds_read_b128 a[60:63], v7 offset:15360
    v_mfma_f32_16x16x32_bf16 v[216:219], v[64:67], a[44:47], v[216:219]
    buffer_load_dwordx4 v14, s[20:23], s44 offen offset:0 lds
    v_mfma_f32_16x16x32_bf16 v[220:223], v[68:71], a[44:47], v[220:223]
    s_waitcnt vmcnt(17)
    ds_read_b64_tr_b16 a[176:177], v2 offset:12288
    v_mfma_f32_16x16x32_bf16 v[212:215], v[68:71], a[40:43], v[212:215]
    ds_read_b64_tr_b16 a[178:179], v2 offset:14336
    ds_read_b64_tr_b16 a[180:181], v3 offset:12288
    v_mfma_f32_16x16x32_bf16 v[204:207], v[68:71], a[36:39], v[204:207]
    ds_read_b64_tr_b16 a[182:183], v3 offset:14336
    ds_read_b64_tr_b16 a[184:185], v4 offset:12288
    v_mfma_f32_16x16x32_bf16 v[196:199], v[68:71], a[32:35], v[196:199]
    buffer_load_dwordx4 v15, s[20:23], s44 offen offset:1024 lds
    v_mfma_f32_16x16x32_bf16 v[160:163], v[72:75], a[32:35], v[160:163]
    ds_read_b64_tr_b16 a[186:187], v4 offset:14336
    ds_read_b64_tr_b16 a[188:189], v5 offset:12288
    v_mfma_f32_16x16x32_bf16 v[168:171], v[72:75], a[36:39], v[168:171]
    ds_read_b64_tr_b16 a[190:191], v5 offset:14336
    v_mfma_f32_16x16x32_bf16 v[176:179], v[72:75], a[40:43], v[176:179]
    v_mfma_f32_16x16x32_bf16 v[184:187], v[72:75], a[44:47], v[184:187]
    buffer_load_dwordx4 v16, s[20:23], s44 offen offset:2048 lds
    v_mfma_f32_16x16x32_bf16 v[188:191], v[76:79], a[44:47], v[188:191]
    v_mfma_f32_16x16x32_bf16 v[180:183], v[76:79], a[40:43], v[180:183]
    v_mfma_f32_16x16x32_bf16 v[172:175], v[76:79], a[36:39], v[172:175]
    v_mfma_f32_16x16x32_bf16 v[164:167], v[76:79], a[32:35], v[164:167]
    buffer_load_dwordx4 v17, s[20:23], s44 offen offset:3072 lds
    s_waitcnt lgkmcnt(0)
    v_mfma_f32_16x16x32_bf16 v[192:195], v[80:83], a[48:51], v[192:195]
    s_add_u32 m0, s43, 12288
    s_mov_b32 s44, 458752
    v_mfma_f32_16x16x32_bf16 v[200:203], v[80:83], a[52:55], v[200:203]
    ds_read_b128 a[64:67], v6 offset:16384
    ds_read_b128 a[68:71], v6 offset:17408
    v_mfma_f32_16x16x32_bf16 v[208:211], v[80:83], a[56:59], v[208:211]
    ds_read_b128 a[72:75], v6 offset:18432
    ds_read_b128 a[76:79], v6 offset:19456
    v_mfma_f32_16x16x32_bf16 v[216:219], v[80:83], a[60:63], v[216:219]
    buffer_load_dwordx4 v14, s[20:23], s44 offen offset:0 lds
    v_mfma_f32_16x16x32_bf16 v[220:223], v[84:87], a[60:63], v[220:223]
    s_waitcnt vmcnt(17)
    ds_read_b64_tr_b16 v[64:65], v2 offset:16384
    v_mfma_f32_16x16x32_bf16 v[212:215], v[84:87], a[56:59], v[212:215]
    ds_read_b64_tr_b16 v[66:67], v2 offset:18432
    ds_read_b64_tr_b16 v[68:69], v3 offset:16384
    v_mfma_f32_16x16x32_bf16 v[204:207], v[84:87], a[52:55], v[204:207]
    ds_read_b64_tr_b16 v[70:71], v3 offset:18432
    ds_read_b64_tr_b16 v[72:73], v4 offset:16384
    v_mfma_f32_16x16x32_bf16 v[196:199], v[84:87], a[48:51], v[196:199]
    buffer_load_dwordx4 v15, s[20:23], s44 offen offset:1024 lds
    v_mfma_f32_16x16x32_bf16 v[160:163], v[88:91], a[48:51], v[160:163]
    ds_read_b64_tr_b16 v[74:75], v4 offset:18432
    ds_read_b64_tr_b16 v[76:77], v5 offset:16384
    v_mfma_f32_16x16x32_bf16 v[168:171], v[88:91], a[52:55], v[168:171]
    ds_read_b64_tr_b16 v[78:79], v5 offset:18432
    v_mfma_f32_16x16x32_bf16 v[176:179], v[88:91], a[56:59], v[176:179]
    v_mfma_f32_16x16x32_bf16 v[184:187], v[88:91], a[60:63], v[184:187]
    buffer_load_dwordx4 v16, s[20:23], s44 offen offset:2048 lds
    v_mfma_f32_16x16x32_bf16 v[188:191], v[92:95], a[60:63], v[188:191]
    v_mfma_f32_16x16x32_bf16 v[180:183], v[92:95], a[56:59], v[180:183]
    v_mfma_f32_16x16x32_bf16 v[172:175], v[92:95], a[52:55], v[172:175]
    v_mfma_f32_16x16x32_bf16 v[164:167], v[92:95], a[48:51], v[164:167]
    buffer_load_dwordx4 v17, s[20:23], s44 offen offset:3072 lds
    s_waitcnt lgkmcnt(0)
    v_mfma_f32_16x16x32_bf16 v[192:195], v[96:99], a[64:67], v[192:195]
    s_add_u32 m0, s43, 16384
    s_mov_b32 s44, 491520
    v_mfma_f32_16x16x32_bf16 v[200:203], v[96:99], a[68:71], v[200:203]
    ds_read_b128 a[80:83], v7 offset:20480
    ds_read_b128 a[84:87], v7 offset:21504
    v_mfma_f32_16x16x32_bf16 v[208:211], v[96:99], a[72:75], v[208:211]
    ds_read_b128 a[88:91], v7 offset:22528
    ds_read_b128 a[92:95], v7 offset:23552
    v_mfma_f32_16x16x32_bf16 v[216:219], v[96:99], a[76:79], v[216:219]
    buffer_load_dwordx4 v14, s[20:23], s44 offen offset:0 lds
    v_mfma_f32_16x16x32_bf16 v[220:223], v[100:103], a[76:79], v[220:223]
    s_waitcnt vmcnt(17)
    ds_read_b64_tr_b16 v[80:81], v2 offset:20480
    v_mfma_f32_16x16x32_bf16 v[212:215], v[100:103], a[72:75], v[212:215]
    ds_read_b64_tr_b16 v[82:83], v2 offset:22528
    ds_read_b64_tr_b16 v[84:85], v3 offset:20480
    v_mfma_f32_16x16x32_bf16 v[204:207], v[100:103], a[68:71], v[204:207]
    ds_read_b64_tr_b16 v[86:87], v3 offset:22528
    ds_read_b64_tr_b16 v[88:89], v4 offset:20480
    v_mfma_f32_16x16x32_bf16 v[196:199], v[100:103], a[64:67], v[196:199]
    buffer_load_dwordx4 v15, s[20:23], s44 offen offset:1024 lds
    v_mfma_f32_16x16x32_bf16 v[160:163], v[104:107], a[64:67], v[160:163]
    ds_read_b64_tr_b16 v[90:91], v4 offset:22528
    ds_read_b64_tr_b16 v[92:93], v5 offset:20480
    v_mfma_f32_16x16x32_bf16 v[168:171], v[104:107], a[68:71], v[168:171]
    ds_read_b64_tr_b16 v[94:95], v5 offset:22528
    v_mfma_f32_16x16x32_bf16 v[176:179], v[104:107], a[72:75], v[176:179]
    v_mfma_f32_16x16x32_bf16 v[184:187], v[104:107], a[76:79], v[184:187]
    buffer_load_dwordx4 v16, s[20:23], s44 offen offset:2048 lds
    v_mfma_f32_16x16x32_bf16 v[188:191], v[108:111], a[76:79], v[188:191]
    v_mfma_f32_16x16x32_bf16 v[180:183], v[108:111], a[72:75], v[180:183]
    v_mfma_f32_16x16x32_bf16 v[172:175], v[108:111], a[68:71], v[172:175]
    v_mfma_f32_16x16x32_bf16 v[164:167], v[108:111], a[64:67], v[164:167]
    buffer_load_dwordx4 v17, s[20:23], s44 offen offset:3072 lds
    s_waitcnt lgkmcnt(0)
    v_mfma_f32_16x16x32_bf16 v[192:195], a[128:131], a[80:83], v[192:195]
    s_add_u32 m0, s43, 20480
    s_mov_b32 s44, 128
    v_mfma_f32_16x16x32_bf16 v[200:203], a[128:131], a[84:87], v[200:203]
    ds_read_b128 a[96:99], v6 offset:24576
    ds_read_b128 a[100:103], v6 offset:25600
    v_mfma_f32_16x16x32_bf16 v[208:211], a[128:131], a[88:91], v[208:211]
    ds_read_b128 a[104:107], v6 offset:26624
    ds_read_b128 a[108:111], v6 offset:27648
    v_mfma_f32_16x16x32_bf16 v[216:219], a[128:131], a[92:95], v[216:219]
    buffer_load_dwordx4 v14, s[20:23], s44 offen offset:0 lds
    v_mfma_f32_16x16x32_bf16 v[220:223], a[132:135], a[92:95], v[220:223]
    s_waitcnt vmcnt(17)
    ds_read_b64_tr_b16 v[96:97], v2 offset:4096
    v_mfma_f32_16x16x32_bf16 v[212:215], a[132:135], a[88:91], v[212:215]
    ds_read_b64_tr_b16 v[98:99], v2 offset:6144
    ds_read_b64_tr_b16 v[100:101], v3 offset:4096
    v_mfma_f32_16x16x32_bf16 v[204:207], a[132:135], a[84:87], v[204:207]
    ds_read_b64_tr_b16 v[102:103], v3 offset:6144
    ds_read_b64_tr_b16 v[104:105], v4 offset:4096
    v_mfma_f32_16x16x32_bf16 v[196:199], a[132:135], a[80:83], v[196:199]
    buffer_load_dwordx4 v15, s[20:23], s44 offen offset:1024 lds
    v_mfma_f32_16x16x32_bf16 v[160:163], a[136:139], a[80:83], v[160:163]
    ds_read_b64_tr_b16 v[106:107], v4 offset:6144
    ds_read_b64_tr_b16 v[108:109], v5 offset:4096
    v_mfma_f32_16x16x32_bf16 v[168:171], a[136:139], a[84:87], v[168:171]
    ds_read_b64_tr_b16 v[110:111], v5 offset:6144
    v_mfma_f32_16x16x32_bf16 v[176:179], a[136:139], a[88:91], v[176:179]
    v_accvgpr_read_b32 v26, a192
    v_accvgpr_read_b32 v27, a193
    v_mfma_f32_16x16x32_bf16 v[184:187], a[136:139], a[92:95], v[184:187]
    buffer_load_dwordx4 v16, s[20:23], s44 offen offset:2048 lds
    v_mfma_f32_16x16x32_bf16 v[188:191], a[140:143], a[92:95], v[188:191]
    v_accvgpr_read_b32 v28, a194
    v_accvgpr_read_b32 v29, a195
    v_mfma_f32_16x16x32_bf16 v[180:183], a[140:143], a[88:91], v[180:183]
    v_lshlrev_b32 v112, 16, v26
    v_and_b32 v113, s51, v26
    v_mfma_f32_16x16x32_bf16 v[172:175], a[140:143], a[84:87], v[172:175]
    v_lshlrev_b32 v114, 16, v27
    v_and_b32 v115, s51, v27
    v_mfma_f32_16x16x32_bf16 v[164:167], a[140:143], a[80:83], v[164:167]
    buffer_load_dwordx4 v17, s[20:23], s44 offen offset:3072 lds
    s_waitcnt lgkmcnt(0)
    v_mfma_f32_16x16x32_bf16 v[192:195], a[144:147], a[96:99], v[192:195]
    s_add_u32 m0, s43, 4096
    s_mov_b32 s44, 32896
    v_mfma_f32_16x16x32_bf16 v[200:203], a[144:147], a[100:103], v[200:203]
    ds_read_b128 a[112:115], v7 offset:28672
    ds_read_b128 a[116:119], v7 offset:29696
    v_mfma_f32_16x16x32_bf16 v[208:211], a[144:147], a[104:107], v[208:211]
    ds_read_b128 a[120:123], v7 offset:30720
    ds_read_b128 a[124:127], v7 offset:31744
    v_mfma_f32_16x16x32_bf16 v[216:219], a[144:147], a[108:111], v[216:219]
    buffer_load_dwordx4 v14, s[20:23], s44 offen offset:0 lds
    v_mfma_f32_16x16x32_bf16 v[220:223], a[148:151], a[108:111], v[220:223]
    s_waitcnt vmcnt(17)
    ds_read_b64_tr_b16 a[128:129], v2 offset:0
    v_mfma_f32_16x16x32_bf16 v[212:215], a[148:151], a[104:107], v[212:215]
    ds_read_b64_tr_b16 a[130:131], v2 offset:2048
    ds_read_b64_tr_b16 a[132:133], v3 offset:0
    v_mfma_f32_16x16x32_bf16 v[204:207], a[148:151], a[100:103], v[204:207]
    ds_read_b64_tr_b16 a[134:135], v3 offset:2048
    ds_read_b64_tr_b16 a[136:137], v4 offset:0
    v_mfma_f32_16x16x32_bf16 v[196:199], a[148:151], a[96:99], v[196:199]
    buffer_load_dwordx4 v15, s[20:23], s44 offen offset:1024 lds
    v_mfma_f32_16x16x32_bf16 v[160:163], a[152:155], a[96:99], v[160:163]
    ds_read_b64_tr_b16 a[138:139], v4 offset:2048
    ds_read_b64_tr_b16 a[140:141], v5 offset:0
    v_mfma_f32_16x16x32_bf16 v[168:171], a[152:155], a[100:103], v[168:171]
    ds_read_b64_tr_b16 a[142:143], v5 offset:2048
    v_lshlrev_b32 v116, 16, v28
    v_mfma_f32_16x16x32_bf16 v[176:179], a[152:155], a[104:107], v[176:179]
    v_and_b32 v117, s51, v28
    v_lshlrev_b32 v118, 16, v29
    v_mfma_f32_16x16x32_bf16 v[184:187], a[152:155], a[108:111], v[184:187]
    buffer_load_dwordx4 v16, s[20:23], s44 offen offset:2048 lds
    v_mfma_f32_16x16x32_bf16 v[188:191], a[156:159], a[108:111], v[188:191]
    v_and_b32 v119, s51, v29
    v_accvgpr_read_b32 v26, a196
    v_mfma_f32_16x16x32_bf16 v[180:183], a[156:159], a[104:107], v[180:183]
    v_accvgpr_read_b32 v27, a197
    v_accvgpr_read_b32 v28, a198
    v_mfma_f32_16x16x32_bf16 v[172:175], a[156:159], a[100:103], v[172:175]
    v_accvgpr_read_b32 v29, a199
    v_lshlrev_b32 v18, 16, v26
    v_mfma_f32_16x16x32_bf16 v[164:167], a[156:159], a[96:99], v[164:167]
    buffer_load_dwordx4 v17, s[20:23], s44 offen offset:3072 lds
    s_waitcnt lgkmcnt(0)
    v_mfma_f32_16x16x32_bf16 v[192:195], a[160:163], a[112:115], v[192:195]
    s_add_u32 m0, s43, 0
    s_mov_b32 s44, 65664
    v_mfma_f32_16x16x32_bf16 v[200:203], a[160:163], a[116:119], v[200:203]
    ds_read_b128 v[128:131], v6 offset:32768
    ds_read_b128 v[132:135], v6 offset:33792
    v_mfma_f32_16x16x32_bf16 v[208:211], a[160:163], a[120:123], v[208:211]
    ds_read_b128 v[136:139], v6 offset:34816
    ds_read_b128 v[140:143], v6 offset:35840
    v_mfma_f32_16x16x32_bf16 v[216:219], a[160:163], a[124:127], v[216:219]
    buffer_load_dwordx4 v14, s[20:23], s44 offen offset:0 lds
    v_mfma_f32_16x16x32_bf16 v[220:223], a[164:167], a[124:127], v[220:223]
    s_waitcnt vmcnt(17)
    ds_read_b64_tr_b16 a[144:145], v2 offset:8192
    v_mfma_f32_16x16x32_bf16 v[212:215], a[164:167], a[120:123], v[212:215]
    ds_read_b64_tr_b16 a[146:147], v2 offset:10240
    ds_read_b64_tr_b16 a[148:149], v3 offset:8192
    v_mfma_f32_16x16x32_bf16 v[204:207], a[164:167], a[116:119], v[204:207]
    ds_read_b64_tr_b16 a[150:151], v3 offset:10240
    ds_read_b64_tr_b16 a[152:153], v4 offset:8192
    v_mfma_f32_16x16x32_bf16 v[196:199], a[164:167], a[112:115], v[196:199]
    buffer_load_dwordx4 v15, s[20:23], s44 offen offset:1024 lds
    v_mfma_f32_16x16x32_bf16 v[160:163], a[168:171], a[112:115], v[160:163]
    ds_read_b64_tr_b16 a[154:155], v4 offset:10240
    ds_read_b64_tr_b16 a[156:157], v5 offset:8192
    v_mfma_f32_16x16x32_bf16 v[168:171], a[168:171], a[116:119], v[168:171]
    ds_read_b64_tr_b16 a[158:159], v5 offset:10240
    v_and_b32 v19, s51, v26
    v_mfma_f32_16x16x32_bf16 v[176:179], a[168:171], a[120:123], v[176:179]
    v_lshlrev_b32 v20, 16, v27
    v_and_b32 v21, s51, v27
    v_mfma_f32_16x16x32_bf16 v[184:187], a[168:171], a[124:127], v[184:187]
    buffer_load_dwordx4 v16, s[20:23], s44 offen offset:2048 lds
    v_mfma_f32_16x16x32_bf16 v[188:191], a[172:175], a[124:127], v[188:191]
    v_lshlrev_b32 v22, 16, v28
    v_and_b32 v23, s51, v28
    v_mfma_f32_16x16x32_bf16 v[180:183], a[172:175], a[120:123], v[180:183]
    v_lshlrev_b32 v24, 16, v29
    v_and_b32 v25, s51, v29
    v_mfma_f32_16x16x32_bf16 v[172:175], a[172:175], a[116:119], v[172:175]
    v_add_f32 v112, v112, v18
    v_add_f32 v113, v113, v19
    v_mfma_f32_16x16x32_bf16 v[164:167], a[172:175], a[112:115], v[164:167]
    buffer_load_dwordx4 v17, s[20:23], s44 offen offset:3072 lds
    s_waitcnt lgkmcnt(0)
    v_mfma_f32_16x16x32_bf16 v[192:195], a[176:179], v[128:131], v[192:195]
    s_add_u32 m0, s43, 8192
    s_mov_b32 s44, 98432
    v_mfma_f32_16x16x32_bf16 v[200:203], a[176:179], v[132:135], v[200:203]
    ds_read_b128 v[144:147], v7 offset:36864
    ds_read_b128 v[148:151], v7 offset:37888
    v_mfma_f32_16x16x32_bf16 v[208:211], a[176:179], v[136:139], v[208:211]
    ds_read_b128 v[152:155], v7 offset:38912
    ds_read_b128 v[156:159], v7 offset:39936
    v_mfma_f32_16x16x32_bf16 v[216:219], a[176:179], v[140:143], v[216:219]
    buffer_load_dwordx4 v14, s[20:23], s44 offen offset:0 lds
    v_mfma_f32_16x16x32_bf16 v[220:223], a[180:183], v[140:143], v[220:223]
    s_waitcnt vmcnt(17)
    ds_read_b64_tr_b16 a[160:161], v2 offset:12288
    v_mfma_f32_16x16x32_bf16 v[212:215], a[180:183], v[136:139], v[212:215]
    ds_read_b64_tr_b16 a[162:163], v2 offset:14336
    ds_read_b64_tr_b16 a[164:165], v3 offset:12288
    v_mfma_f32_16x16x32_bf16 v[204:207], a[180:183], v[132:135], v[204:207]
    ds_read_b64_tr_b16 a[166:167], v3 offset:14336
    ds_read_b64_tr_b16 a[168:169], v4 offset:12288
    v_mfma_f32_16x16x32_bf16 v[196:199], a[180:183], v[128:131], v[196:199]
    buffer_load_dwordx4 v15, s[20:23], s44 offen offset:1024 lds
    v_mfma_f32_16x16x32_bf16 v[160:163], a[184:187], v[128:131], v[160:163]
    ds_read_b64_tr_b16 a[170:171], v4 offset:14336
    ds_read_b64_tr_b16 a[172:173], v5 offset:12288
    v_mfma_f32_16x16x32_bf16 v[168:171], a[184:187], v[132:135], v[168:171]
    ds_read_b64_tr_b16 a[174:175], v5 offset:14336
    v_add_f32 v114, v114, v20
    v_mfma_f32_16x16x32_bf16 v[176:179], a[184:187], v[136:139], v[176:179]
    v_add_f32 v115, v115, v21
    v_add_f32 v116, v116, v22
    v_mfma_f32_16x16x32_bf16 v[184:187], a[184:187], v[140:143], v[184:187]
    buffer_load_dwordx4 v16, s[20:23], s44 offen offset:2048 lds
    v_mfma_f32_16x16x32_bf16 v[188:191], a[188:191], v[140:143], v[188:191]
    v_add_f32 v117, v117, v23
    v_add_f32 v118, v118, v24
    v_mfma_f32_16x16x32_bf16 v[180:183], a[188:191], v[136:139], v[180:183]
    v_add_f32 v119, v119, v25
    v_accvgpr_read_b32 v26, a200
    v_mfma_f32_16x16x32_bf16 v[172:175], a[188:191], v[132:135], v[172:175]
    v_accvgpr_read_b32 v27, a201
    v_accvgpr_read_b32 v28, a202
    v_mfma_f32_16x16x32_bf16 v[164:167], a[188:191], v[128:131], v[164:167]
    buffer_load_dwordx4 v17, s[20:23], s44 offen offset:3072 lds
    s_waitcnt lgkmcnt(0)
    v_mfma_f32_16x16x32_bf16 v[192:195], v[64:67], v[144:147], v[192:195]
    s_add_u32 m0, s43, 12288
    s_mov_b32 s44, 131200
    v_mfma_f32_16x16x32_bf16 v[200:203], v[64:67], v[148:151], v[200:203]
    ds_read_b128 v[128:131], v6 offset:40960
    ds_read_b128 v[132:135], v6 offset:41984
    v_mfma_f32_16x16x32_bf16 v[208:211], v[64:67], v[152:155], v[208:211]
    ds_read_b128 v[136:139], v6 offset:43008
    ds_read_b128 v[140:143], v6 offset:44032
    v_mfma_f32_16x16x32_bf16 v[216:219], v[64:67], v[156:159], v[216:219]
    buffer_load_dwordx4 v14, s[20:23], s44 offen offset:0 lds
    v_mfma_f32_16x16x32_bf16 v[220:223], v[68:71], v[156:159], v[220:223]
    s_waitcnt vmcnt(17)
    ds_read_b64_tr_b16 a[176:177], v2 offset:16384
    v_mfma_f32_16x16x32_bf16 v[212:215], v[68:71], v[152:155], v[212:215]
    ds_read_b64_tr_b16 a[178:179], v2 offset:18432
    ds_read_b64_tr_b16 a[180:181], v3 offset:16384
    v_mfma_f32_16x16x32_bf16 v[204:207], v[68:71], v[148:151], v[204:207]
    ds_read_b64_tr_b16 a[182:183], v3 offset:18432
    ds_read_b64_tr_b16 a[184:185], v4 offset:16384
    v_mfma_f32_16x16x32_bf16 v[196:199], v[68:71], v[144:147], v[196:199]
    buffer_load_dwordx4 v15, s[20:23], s44 offen offset:1024 lds
    v_mfma_f32_16x16x32_bf16 v[160:163], v[72:75], v[144:147], v[160:163]
    ds_read_b64_tr_b16 a[186:187], v4 offset:18432
    ds_read_b64_tr_b16 a[188:189], v5 offset:16384
    v_mfma_f32_16x16x32_bf16 v[168:171], v[72:75], v[148:151], v[168:171]
    ds_read_b64_tr_b16 a[190:191], v5 offset:18432
    v_accvgpr_read_b32 v29, a203
    v_mfma_f32_16x16x32_bf16 v[176:179], v[72:75], v[152:155], v[176:179]
    v_lshlrev_b32 v18, 16, v26
    v_and_b32 v19, s51, v26
    v_mfma_f32_16x16x32_bf16 v[184:187], v[72:75], v[156:159], v[184:187]
    buffer_load_dwordx4 v16, s[20:23], s44 offen offset:2048 lds
    v_mfma_f32_16x16x32_bf16 v[188:191], v[76:79], v[156:159], v[188:191]
    v_lshlrev_b32 v20, 16, v27
    v_and_b32 v21, s51, v27
    v_mfma_f32_16x16x32_bf16 v[180:183], v[76:79], v[152:155], v[180:183]
    v_lshlrev_b32 v22, 16, v28
    v_and_b32 v23, s51, v28
    v_mfma_f32_16x16x32_bf16 v[172:175], v[76:79], v[148:151], v[172:175]
    v_lshlrev_b32 v24, 16, v29
    v_and_b32 v25, s51, v29
    v_mfma_f32_16x16x32_bf16 v[164:167], v[76:79], v[144:147], v[164:167]
    buffer_load_dwordx4 v17, s[20:23], s44 offen offset:3072 lds
    s_waitcnt lgkmcnt(0)
    v_mfma_f32_16x16x32_bf16 v[192:195], v[80:83], v[128:131], v[192:195]
    s_add_u32 m0, s43, 16384
    s_mov_b32 s44, 163968
    v_mfma_f32_16x16x32_bf16 v[200:203], v[80:83], v[132:135], v[200:203]
    ds_read_b128 v[144:147], v7 offset:45056
    ds_read_b128 v[148:151], v7 offset:46080
    v_mfma_f32_16x16x32_bf16 v[208:211], v[80:83], v[136:139], v[208:211]
    ds_read_b128 v[152:155], v7 offset:47104
    ds_read_b128 v[156:159], v7 offset:48128
    v_mfma_f32_16x16x32_bf16 v[216:219], v[80:83], v[140:143], v[216:219]
    buffer_load_dwordx4 v14, s[20:23], s44 offen offset:0 lds
    v_mfma_f32_16x16x32_bf16 v[220:223], v[84:87], v[140:143], v[220:223]
    s_waitcnt vmcnt(17)
    ds_read_b64_tr_b16 v[64:65], v2 offset:20480
    v_mfma_f32_16x16x32_bf16 v[212:215], v[84:87], v[136:139], v[212:215]
    ds_read_b64_tr_b16 v[66:67], v2 offset:22528
    ds_read_b64_tr_b16 v[68:69], v3 offset:20480
    v_mfma_f32_16x16x32_bf16 v[204:207], v[84:87], v[132:135], v[204:207]
    ds_read_b64_tr_b16 v[70:71], v3 offset:22528
    ds_read_b64_tr_b16 v[72:73], v4 offset:20480
    v_mfma_f32_16x16x32_bf16 v[196:199], v[84:87], v[128:131], v[196:199]
L_pg10:
    s_cbranch_execz L_pgret
    buffer_load_dwordx4 v15, s[20:23], s44 offen offset:1024 lds
    v_mfma_f32_16x16x32_bf16 v[160:163], v[88:91], v[128:131], v[160:163]
    ds_read_b64_tr_b16 v[74:75], v4 offset:22528
    ds_read_b64_tr_b16 v[76:77], v5 offset:20480
    v_mfma_f32_16x16x32_bf16 v[168:171], v[88:91], v[132:135], v[168:171]
    ds_read_b64_tr_b16 v[78:79], v5 offset:22528
    v_add_f32 v112, v112, v18
    v_mfma_f32_16x16x32_bf16 v[176:179], v[88:91], v[136:139], v[176:179]
    v_add_f32 v113, v113, v19
    v_add_f32 v114, v114, v20
    v_mfma_f32_16x16x32_bf16 v[184:187], v[88:91], v[140:143], v[184:187]
    buffer_load_dwordx4 v16, s[20:23], s44 offen offset:2048 lds
    v_mfma_f32_16x16x32_bf16 v[188:191], v[92:95], v[140:143], v[188:191]
    v_add_f32 v115, v115, v21
    v_add_f32 v116, v116, v22
    v_mfma_f32_16x16x32_bf16 v[180:183], v[92:95], v[136:139], v[180:183]
    v_add_f32 v117, v117, v23
    v_add_f32 v118, v118, v24
    v_mfma_f32_16x16x32_bf16 v[172:175], v[92:95], v[132:135], v[172:175]
    v_add_f32 v119, v119, v25
    v_accvgpr_read_b32 v26, a204
    v_mfma_f32_16x16x32_bf16 v[164:167], v[92:95], v[128:131], v[164:167]
    buffer_load_dwordx4 v17, s[20:23], s44 offen offset:3072 lds
    s_waitcnt lgkmcnt(0)
    v_mfma_f32_16x16x32_bf16 v[192:195], v[96:99], v[144:147], v[192:195]
    s_add_u32 m0, s43, 20480
    s_mov_b32 s44, 196736
    v_mfma_f32_16x16x32_bf16 v[200:203], v[96:99], v[148:151], v[200:203]
    ds_read_b128 v[128:131], v6 offset:49152
    ds_read_b128 v[132:135], v6 offset:50176
    v_mfma_f32_16x16x32_bf16 v[208:211], v[96:99], v[152:155], v[208:211]
    ds_read_b128 v[136:139], v6 offset:51200
    ds_read_b128 v[140:143], v6 offset:52224
    v_mfma_f32_16x16x32_bf16 v[216:219], v[96:99], v[156:159], v[216:219]
    buffer_load_dwordx4 v14, s[20:23], s44 offen offset:0 lds
    v_mfma_f32_16x16x32_bf16 v[220:223], v[100:103], v[156:159], v[220:223]
    s_waitcnt vmcnt(17)
    ds_read_b64_tr_b16 v[80:81], v2 offset:4096
    v_mfma_f32_16x16x32_bf16 v[212:215], v[100:103], v[152:155], v[212:215]
    ds_read_b64_tr_b16 v[82:83], v2 offset:6144
    ds_read_b64_tr_b16 v[84:85], v3 offset:4096
    v_mfma_f32_16x16x32_bf16 v[204:207], v[100:103], v[148:151], v[204:207]
    ds_read_b64_tr_b16 v[86:87], v3 offset:6144
    ds_read_b64_tr_b16 v[88:89], v4 offset:4096
    v_mfma_f32_16x16x32_bf16 v[196:199], v[100:103], v[144:147], v[196:199]
    buffer_load_dwordx4 v15, s[20:23], s44 offen offset:1024 lds
    v_mfma_f32_16x16x32_bf16 v[160:163], v[104:107], v[144:147], v[160:163]
    ds_read_b64_tr_b16 v[90:91], v4 offset:6144
    ds_read_b64_tr_b16 v[92:93], v5 offset:4096
    v_mfma_f32_16x16x32_bf16 v[168:171], v[104:107], v[148:151], v[168:171]
    ds_read_b64_tr_b16 v[94:95], v5 offset:6144
    v_accvgpr_read_b32 v27, a205
    v_mfma_f32_16x16x32_bf16 v[176:179], v[104:107], v[152:155], v[176:179]
    v_accvgpr_read_b32 v28, a206
    v_accvgpr_read_b32 v29, a207
    v_mfma_f32_16x16x32_bf16 v[184:187], v[104:107], v[156:159], v[184:187]
    buffer_load_dwordx4 v16, s[20:23], s44 offen offset:2048 lds
    v_mfma_f32_16x16x32_bf16 v[188:191], v[108:111], v[156:159], v[188:191]
    v_lshlrev_b32 v18, 16, v26
    v_and_b32 v19, s51, v26
    v_mfma_f32_16x16x32_bf16 v[180:183], v[108:111], v[152:155], v[180:183]
    v_lshlrev_b32 v20, 16, v27
    v_and_b32 v21, s51, v27
    v_mfma_f32_16x16x32_bf16 v[172:175], v[108:111], v[148:151], v[172:175]
    v_lshlrev_b32 v22, 16, v28
    v_and_b32 v23, s51, v28
    v_mfma_f32_16x16x32_bf16 v[164:167], v[108:111], v[144:147], v[164:167]
    buffer_load_dwordx4 v17, s[20:23], s44 offen offset:3072 lds
    s_waitcnt lgkmcnt(0)
    v_mfma_f32_16x16x32_bf16 v[192:195], a[128:131], v[128:131], v[192:195]
    s_add_u32 m0, s43, 4096
    s_mov_b32 s44, 229504
    v_mfma_f32_16x16x32_bf16 v[200:203], a[128:131], v[132:135], v[200:203]
    ds_read_b128 v[144:147], v7 offset:53248
    ds_read_b128 v[148:151], v7 offset:54272
    v_mfma_f32_16x16x32_bf16 v[208:211], a[128:131], v[136:139], v[208:211]
    ds_read_b128 v[152:155], v7 offset:55296
    ds_read_b128 v[156:159], v7 offset:56320
    v_mfma_f32_16x16x32_bf16 v[216:219], a[128:131], v[140:143], v[216:219]
    buffer_load_dwordx4 v14, s[20:23], s44 offen offset:0 lds
    v_mfma_f32_16x16x32_bf16 v[220:223], a[132:135], v[140:143], v[220:223]
    s_waitcnt vmcnt(17)
    ds_read_b64_tr_b16 v[96:97], v2 offset:0
    v_mfma_f32_16x16x32_bf16 v[212:215], a[132:135], v[136:139], v[212:215]
    ds_read_b64_tr_b16 v[98:99], v2 offset:2048
    ds_read_b64_tr_b16 v[100:101], v3 offset:0
    v_mfma_f32_16x16x32_bf16 v[204:207], a[132:135], v[132:135], v[204:207]
    ds_read_b64_tr_b16 v[102:103], v3 offset:2048
    ds_read_b64_tr_b16 v[104:105], v4 offset:0
    v_mfma_f32_16x16x32_bf16 v[196:199], a[132:135], v[128:131], v[196:199]
    buffer_load_dwordx4 v15, s[20:23], s44 offen offset:1024 lds
    v_mfma_f32_16x16x32_bf16 v[160:163], a[136:139], v[128:131], v[160:163]
    ds_read_b64_tr_b16 v[106:107], v4 offset:2048
    ds_read_b64_tr_b16 v[108:109], v5 offset:0
    v_mfma_f32_16x16x32_bf16 v[168:171], a[136:139], v[132:135], v[168:171]
    ds_read_b64_tr_b16 v[110:111], v5 offset:2048
    v_lshlrev_b32 v24, 16, v29
    v_mfma_f32_16x16x32_bf16 v[176:179], a[136:139], v[136:139], v[176:179]
    v_and_b32 v25, s51, v29
    v_add_f32 v112, v112, v18
    v_mfma_f32_16x16x32_bf16 v[184:187], a[136:139], v[140:143], v[184:187]
    buffer_load_dwordx4 v16, s[20:23], s44 offen offset:2048 lds
    v_mfma_f32_16x16x32_bf16 v[188:191], a[140:143], v[140:143], v[188:191]
    v_add_f32 v113, v113, v19
    v_add_f32 v114, v114, v20
    v_mfma_f32_16x16x32_bf16 v[180:183], a[140:143], v[136:139], v[180:183]
    v_add_f32 v115, v115, v21
    v_add_f32 v116, v116, v22
    v_mfma_f32_16x16x32_bf16 v[172:175], a[140:143], v[132:135], v[172:175]
    v_add_f32 v117, v117, v23
    v_add_f32 v118, v118, v24
    v_mfma_f32_16x16x32_bf16 v[164:167], a[140:143], v[128:131], v[164:167]
    buffer_load_dwordx4 v17, s[20:23], s44 offen offset:3072 lds
    s_waitcnt lgkmcnt(0)
    v_mfma_f32_16x16x32_bf16 v[192:195], a[144:147], v[144:147], v[192:195]
    s_add_u32 m0, s43, 0
    s_mov_b32 s44, 262272
    v_mfma_f32_16x16x32_bf16 v[200:203], a[144:147], v[148:151], v[200:203]
    ds_read_b128 v[128:131], v6 offset:57344
    ds_read_b128 v[132:135], v6 offset:58368
    v_mfma_f32_16x16x32_bf16 v[208:211], a[144:147], v[152:155], v[208:211]
    ds_read_b128 v[136:139], v6 offset:59392
    ds_read_b128 v[140:143], v6 offset:60416
    v_mfma_f32_16x16x32_bf16 v[216:219], a[144:147], v[156:159], v[216:219]
    buffer_load_dwordx4 v14, s[20:23], s44 offen offset:0 lds
    v_mfma_f32_16x16x32_bf16 v[220:223], a[148:151], v[156:159], v[220:223]
    s_waitcnt vmcnt(17)
    ds_read_b64_tr_b16 a[128:129], v2 offset:8192
    v_mfma_f32_16x16x32_bf16 v[212:215], a[148:151], v[152:155], v[212:215]
    ds_read_b64_tr_b16 a[130:131], v2 offset:10240
    ds_read_b64_tr_b16 a[132:133], v3 offset:8192
    v_mfma_f32_16x16x32_bf16 v[204:207], a[148:151], v[148:151], v[204:207]
    ds_read_b64_tr_b16 a[134:135], v3 offset:10240
    ds_read_b64_tr_b16 a[136:137], v4 offset:8192
    v_mfma_f32_16x16x32_bf16 v[196:199], a[148:151], v[144:147], v[196:199]
    buffer_load_dwordx4 v15, s[20:23], s44 offen offset:1024 lds
    v_mfma_f32_16x16x32_bf16 v[160:163], a[152:155], v[144:147], v[160:163]
    ds_read_b64_tr_b16 a[138:139], v4 offset:10240
    ds_read_b64_tr_b16 a[140:141], v5 offset:8192
    v_mfma_f32_16x16x32_bf16 v[168:171], a[152:155], v[148:151], v[168:171]
    ds_read_b64_tr_b16 a[142:143], v5 offset:10240
    v_add_f32 v119, v119, v25
    v_mfma_f32_16x16x32_bf16 v[176:179], a[152:155], v[152:155], v[176:179]
    v_accvgpr_read_b32 v26, a208
    v_accvgpr_read_b32 v27, a209
    v_mfma_f32_16x16x32_bf16 v[184:187], a[152:155], v[156:159], v[184:187]
    buffer_load_dwordx4 v16, s[20:23], s44 offen offset:2048 lds
    v_mfma_f32_16x16x32_bf16 v[188:191], a[156:159], v[156:159], v[188:191]
    v_accvgpr_read_b32 v28, a210
    v_accvgpr_read_b32 v29, a211
    v_mfma_f32_16x16x32_bf16 v[180:183], a[156:159], v[152:155], v[180:183]
    v_lshlrev_b32 v18, 16, v26
    v_and_b32 v19, s51, v26
    v_mfma_f32_16x16x32_bf16 v[172:175], a[156:159], v[148:151], v[172:175]
    v_lshlrev_b32 v20, 16, v27
    v_and_b32 v21, s51, v27
    v_mfma_f32_16x16x32_bf16 v[164:167], a[156:159], v[144:147], v[164:167]
    buffer_load_dwordx4 v17, s[20:23], s44 offen offset:3072 lds
    s_waitcnt lgkmcnt(0)
    v_mfma_f32_16x16x32_bf16 v[192:195], a[160:163], v[128:131], v[192:195]
    s_add_u32 m0, s43, 8192
    s_mov_b32 s44, 295040
    v_mfma_f32_16x16x32_bf16 v[200:203], a[160:163], v[132:135], v[200:203]
    ds_read_b128 v[144:147], v7 offset:61440
    ds_read_b128 v[148:151], v7 offset:62464
    v_mfma_f32_16x16x32_bf16 v[208:211], a[160:163], v[136:139], v[208:211]
    ds_read_b128 v[152:155], v7 offset:63488
    ds_read_b128 v[156:159], v7 offset:64512
    v_mfma_f32_16x16x32_bf16 v[216:219], a[160:163], v[140:143], v[216:219]
    buffer_load_dwordx4 v14, s[20:23], s44 offen offset:0 lds
    v_mfma_f32_16x16x32_bf16 v[220:223], a[164:167], v[140:143], v[220:223]
    s_waitcnt vmcnt(17)
    ds_read_b64_tr_b16 a[144:145], v2 offset:12288
    v_mfma_f32_16x16x32_bf16 v[212:215], a[164:167], v[136:139], v[212:215]
    ds_read_b64_tr_b16 a[146:147], v2 offset:14336
    ds_read_b64_tr_b16 a[148:149], v3 offset:12288
    v_mfma_f32_16x16x32_bf16 v[204:207], a[164:167], v[132:135], v[204:207]
    ds_read_b64_tr_b16 a[150:151], v3 offset:14336
    ds_read_b64_tr_b16 a[152:153], v4 offset:12288
    v_mfma_f32_16x16x32_bf16 v[196:199], a[164:167], v[128:131], v[196:199]
    buffer_load_dwordx4 v15, s[20:23], s44 offen offset:1024 lds
    v_mfma_f32_16x16x32_bf16 v[160:163], a[168:171], v[128:131], v[160:163]
    ds_read_b64_tr_b16 a[154:155], v4 offset:14336
    ds_read_b64_tr_b16 a[156:157], v5 offset:12288
    v_mfma_f32_16x16x32_bf16 v[168:171], a[168:171], v[132:135], v[168:171]
    ds_read_b64_tr_b16 a[158:159], v5 offset:14336
    v_lshlrev_b32 v22, 16, v28
    v_mfma_f32_16x16x32_bf16 v[176:179], a[168:171], v[136:139], v[176:179]
    v_and_b32 v23, s51, v28
    v_lshlrev_b32 v24, 16, v29
    v_mfma_f32_16x16x32_bf16 v[184:187], a[168:171], v[140:143], v[184:187]
    buffer_load_dwordx4 v16, s[20:23], s44 offen offset:2048 lds
    v_mfma_f32_16x16x32_bf16 v[188:191], a[172:175], v[140:143], v[188:191]
    v_and_b32 v25, s51, v29
    v_add_f32 v112, v112, v18
    v_mfma_f32_16x16x32_bf16 v[180:183], a[172:175], v[136:139], v[180:183]
    v_add_f32 v113, v113, v19
    v_add_f32 v114, v114, v20
    v_mfma_f32_16x16x32_bf16 v[172:175], a[172:175], v[132:135], v[172:175]
    v_add_f32 v115, v115, v21
    v_add_f32 v116, v116, v22
    v_mfma_f32_16x16x32_bf16 v[164:167], a[172:175], v[128:131], v[164:167]
    buffer_load_dwordx4 v17, s[20:23], s44 offen offset:3072 lds
    s_waitcnt lgkmcnt(0)
    v_mfma_f32_16x16x32_bf16 v[192:195], a[176:179], v[144:147], v[192:195]
    s_add_u32 m0, s43, 12288
    s_mov_b32 s44, 327808
    v_mfma_f32_16x16x32_bf16 v[200:203], a[176:179], v[148:151], v[200:203]
    s_waitcnt vmcnt(16)
    v_add_f32 v117, v117, v23
    v_mfma_f32_16x16x32_bf16 v[208:211], a[176:179], v[152:155], v[208:211]
    ds_read_b64_tr_b16 a[160:161], v2 offset:16384
    v_add_f32 v118, v118, v24
    v_mfma_f32_16x16x32_bf16 v[216:219], a[176:179], v[156:159], v[216:219]
    buffer_load_dwordx4 v14, s[20:23], s44 offen offset:0 lds
    v_mfma_f32_16x16x32_bf16 v[220:223], a[180:183], v[156:159], v[220:223]
    ds_read_b64_tr_b16 a[162:163], v2 offset:18432
    v_add_f32 v119, v119, v25
    v_mfma_f32_16x16x32_bf16 v[212:215], a[180:183], v[152:155], v[212:215]
    ds_read_b64_tr_b16 a[164:165], v3 offset:16384
    v_accvgpr_read_b32 v26, a212
    v_mfma_f32_16x16x32_bf16 v[204:207], a[180:183], v[148:151], v[204:207]
    ds_read_b64_tr_b16 a[166:167], v3 offset:18432
    v_accvgpr_read_b32 v27, a213
    v_mfma_f32_16x16x32_bf16 v[196:199], a[180:183], v[144:147], v[196:199]
    buffer_load_dwordx4 v15, s[20:23], s44 offen offset:1024 lds
    v_mfma_f32_16x16x32_bf16 v[160:163], a[184:187], v[144:147], v[160:163]
    ds_read_b64_tr_b16 a[168:169], v4 offset:16384
    v_accvgpr_read_b32 v28, a214
    v_mfma_f32_16x16x32_bf16 v[168:171], a[184:187], v[148:151], v[168:171]
    ds_read_b64_tr_b16 a[170:171], v4 offset:18432
    v_accvgpr_read_b32 v29, a215
    v_mfma_f32_16x16x32_bf16 v[176:179], a[184:187], v[152:155], v[176:179]
    ds_read_b64_tr_b16 a[172:173], v5 offset:16384
    v_lshlrev_b32 v18, 16, v26
    v_mfma_f32_16x16x32_bf16 v[184:187], a[184:187], v[156:159], v[184:187]
    buffer_load_dwordx4 v16, s[20:23], s44 offen offset:2048 lds
    v_mfma_f32_16x16x32_bf16 v[188:191], a[188:191], v[156:159], v[188:191]
    ds_read_b64_tr_b16 a[174:175], v5 offset:18432
    v_and_b32 v19, s51, v26
    v_mfma_f32_16x16x32_bf16 v[180:183], a[188:191], v[152:155], v[180:183]
    v_lshlrev_b32 v20, 16, v27
    v_and_b32 v21, s51, v27
    v_mfma_f32_16x16x32_bf16 v[172:175], a[188:191], v[148:151], v[172:175]
    v_lshlrev_b32 v22, 16, v28
    v_and_b32 v23, s51, v28
    v_mfma_f32_16x16x32_bf16 v[164:167], a[188:191], v[144:147], v[164:167]
    buffer_load_dwordx4 v17, s[20:23], s44 offen offset:3072 lds
    s_waitcnt lgkmcnt(0)
    v_mfma_f32_16x16x32_bf16 v[128:131], v[64:67], a[0:3], 0
    s_add_u32 m0, s43, 16384
    s_mov_b32 s44, 360576
    v_mfma_f32_16x16x32_bf16 v[136:139], v[64:67], a[4:7], 0
    s_waitcnt vmcnt(16)
    v_lshlrev_b32 v24, 16, v29
    v_mfma_f32_16x16x32_bf16 v[144:147], v[64:67], a[8:11], 0
    ds_read_b64_tr_b16 a[176:177], v2 offset:20480
    v_and_b32 v25, s51, v29
    v_mfma_f32_16x16x32_bf16 v[152:155], v[64:67], a[12:15], 0
    buffer_load_dwordx4 v14, s[20:23], s44 offen offset:0 lds
    v_mfma_f32_16x16x32_bf16 v[156:159], v[68:71], a[12:15], 0
    ds_read_b64_tr_b16 a[178:179], v2 offset:22528
    v_add_f32 v112, v112, v18
    v_mfma_f32_16x16x32_bf16 v[148:151], v[68:71], a[8:11], 0
    ds_read_b64_tr_b16 a[180:181], v3 offset:20480
    v_add_f32 v113, v113, v19
    v_mfma_f32_16x16x32_bf16 v[140:143], v[68:71], a[4:7], 0
    ds_read_b64_tr_b16 a[182:183], v3 offset:22528
    v_add_f32 v114, v114, v20
    v_mfma_f32_16x16x32_bf16 v[132:135], v[68:71], a[0:3], 0
    buffer_load_dwordx4 v15, s[20:23], s44 offen offset:1024 lds
    v_mfma_f32_16x16x32_bf16 v[224:227], v[72:75], a[0:3], 0
    ds_read_b64_tr_b16 a[184:185], v4 offset:20480
    v_add_f32 v115, v115, v21
    v_mfma_f32_16x16x32_bf16 v[232:235], v[72:75], a[4:7], 0
    ds_read_b64_tr_b16 a[186:187], v4 offset:22528
    v_add_f32 v116, v116, v22
    v_mfma_f32_16x16x32_bf16 v[240:243], v[72:75], a[8:11], 0
    ds_read_b64_tr_b16 a[188:189], v5 offset:20480
    v_add_f32 v117, v117, v23
    v_mfma_f32_16x16x32_bf16 v[248:251], v[72:75], a[12:15], 0
    buffer_load_dwordx4 v16, s[20:23], s44 offen offset:2048 lds
    v_mfma_f32_16x16x32_bf16 v[252:255], v[76:79], a[12:15], 0
    ds_read_b64_tr_b16 a[190:191], v5 offset:22528
    v_add_f32 v118, v118, v24
    v_mfma_f32_16x16x32_bf16 v[244:247], v[76:79], a[8:11], 0
    v_add_f32 v119, v119, v25
    v_accvgpr_read_b32 v26, a216
    v_mfma_f32_16x16x32_bf16 v[236:239], v[76:79], a[4:7], 0
    v_accvgpr_read_b32 v27, a217
    v_accvgpr_read_b32 v28, a218
    v_mfma_f32_16x16x32_bf16 v[228:231], v[76:79], a[0:3], 0
    buffer_load_dwordx4 v17, s[20:23], s44 offen offset:3072 lds
    s_waitcnt lgkmcnt(0)
    v_mfma_f32_16x16x32_bf16 v[128:131], v[80:83], a[16:19], v[128:131]
    s_add_u32 m0, s43, 20480
    s_mov_b32 s44, 393344
    v_mfma_f32_16x16x32_bf16 v[136:139], v[80:83], a[20:23], v[136:139]
    s_waitcnt vmcnt(16)
    v_accvgpr_read_b32 v29, a219
    v_mfma_f32_16x16x32_bf16 v[144:147], v[80:83], a[24:27], v[144:147]
    ds_read_b64_tr_b16 v[64:65], v2 offset:4096
    v_lshlrev_b32 v18, 16, v26
    v_mfma_f32_16x16x32_bf16 v[152:155], v[80:83], a[28:31], v[152:155]
    buffer_load_dwordx4 v14, s[20:23], s44 offen offset:0 lds
    v_mfma_f32_16x16x32_bf16 v[156:159], v[84:87], a[28:31], v[156:159]
    ds_read_b64_tr_b16 v[66:67], v2 offset:6144
    v_and_b32 v19, s51, v26
    v_mfma_f32_16x16x32_bf16 v[148:151], v[84:87], a[24:27], v[148:151]
    ds_read_b64_tr_b16 v[68:69], v3 offset:4096
    v_lshlrev_b32 v20, 16, v27
    v_mfma_f32_16x16x32_bf16 v[140:143], v[84:87], a[20:23], v[140:143]
    ds_read_b64_tr_b16 v[70:71], v3 offset:6144
    v_and_b32 v21, s51, v27
    v_mfma_f32_16x16x32_bf16 v[132:135], v[84:87], a[16:19], v[132:135]
    buffer_load_dwordx4 v15, s[20:23], s44 offen offset:1024 lds
    v_mfma_f32_16x16x32_bf16 v[224:227], v[88:91], a[16:19], v[224:227]
    ds_read_b64_tr_b16 v[72:73], v4 offset:4096
    v_lshlrev_b32 v22, 16, v28
    v_mfma_f32_16x16x32_bf16 v[232:235], v[88:91], a[20:23], v[232:235]
    ds_read_b64_tr_b16 v[74:75], v4 offset:6144
    v_and_b32 v23, s51, v28
    v_mfma_f32_16x16x32_bf16 v[240:243], v[88:91], a[24:27], v[240:243]
    ds_read_b64_tr_b16 v[76:77], v5 offset:4096
    v_lshlrev_b32 v24, 16, v29
    v_mfma_f32_16x16x32_bf16 v[248:251], v[88:91], a[28:31], v[248:251]
    buffer_load_dwordx4 v16, s[20:23], s44 offen offset:2048 lds
    v_mfma_f32_16x16x32_bf16 v[252:255], v[92:95], a[28:31], v[252:255]
    ds_read_b64_tr_b16 v[78:79], v5 offset:6144
    v_and_b32 v25, s51, v29
    v_mfma_f32_16x16x32_bf16 v[244:247], v[92:95], a[24:27], v[244:247]
    v_add_f32 v112, v112, v18
    v_add_f32 v113, v113, v19
    v_mfma_f32_16x16x32_bf16 v[236:239], v[92:95], a[20:23], v[236:239]
    v_add_f32 v114, v114, v20
    v_add_f32 v115, v115, v21
    v_mfma_f32_16x16x32_bf16 v[228:231], v[92:95], a[16:19], v[228:231]
    buffer_load_dwordx4 v17, s[20:23], s44 offen offset:3072 lds
    s_waitcnt lgkmcnt(0)
    v_mfma_f32_16x16x32_bf16 v[128:131], v[96:99], a[32:35], v[128:131]
    s_add_u32 m0, s43, 4096
    s_mov_b32 s44, 426112
    v_mfma_f32_16x16x32_bf16 v[136:139], v[96:99], a[36:39], v[136:139]
    s_waitcnt vmcnt(16)
    v_add_f32 v116, v116, v22
    v_mfma_f32_16x16x32_bf16 v[144:147], v[96:99], a[40:43], v[144:147]
    ds_read_b64_tr_b16 v[80:81], v2 offset:0
    v_add_f32 v117, v117, v23
    v_mfma_f32_16x16x32_bf16 v[152:155], v[96:99], a[44:47], v[152:155]
    buffer_load_dwordx4 v14, s[20:23], s44 offen offset:0 lds
    v_mfma_f32_16x16x32_bf16 v[156:159], v[100:103], a[44:47], v[156:159]
    ds_read_b64_tr_b16 v[82:83], v2 offset:2048
    v_add_f32 v118, v118, v24
    v_mfma_f32_16x16x32_bf16 v[148:151], v[100:103], a[40:43], v[148:151]
    ds_read_b64_tr_b16 v[84:85], v3 offset:0
    v_add_f32 v119, v119, v25
    v_mfma_f32_16x16x32_bf16 v[140:143], v[100:103], a[36:39], v[140:143]
    ds_read_b64_tr_b16 v[86:87], v3 offset:2048
    v_accvgpr_read_b32 v26, a220
    v_mfma_f32_16x16x32_bf16 v[132:135], v[100:103], a[32:35], v[132:135]
    buffer_load_dwordx4 v15, s[20:23], s44 offen offset:1024 lds
    v_mfma_f32_16x16x32_bf16 v[224:227], v[104:107], a[32:35], v[224:227]
    ds_read_b64_tr_b16 v[88:89], v4 offset:0
    v_accvgpr_read_b32 v27, a221
    v_mfma_f32_16x16x32_bf16 v[232:235], v[104:107], a[36:39], v[232:235]
    ds_read_b64_tr_b16 v[90:91], v4 offset:2048
    v_accvgpr_read_b32 v28, a222
    v_mfma_f32_16x16x32_bf16 v[240:243], v[104:107], a[40:43], v[240:243]
    ds_read_b64_tr_b16 v[92:93], v5 offset:0
    v_accvgpr_read_b32 v29, a223
    v_mfma_f32_16x16x32_bf16 v[248:251], v[104:107], a[44:47], v[248:251]
    buffer_load_dwordx4 v16, s[20:23], s44 offen offset:2048 lds
    v_mfma_f32_16x16x32_bf16 v[252:255], v[108:111], a[44:47], v[252:255]
    ds_read_b64_tr_b16 v[94:95], v5 offset:2048
    v_lshlrev_b32 v18, 16, v26
    v_mfma_f32_16x16x32_bf16 v[244:247], v[108:111], a[40:43], v[244:247]
    v_and_b32 v19, s51, v26
    v_lshlrev_b32 v20, 16, v27
    v_mfma_f32_16x16x32_bf16 v[236:239], v[108:111], a[36:39], v[236:239]
    v_and_b32 v21, s51, v27
    v_lshlrev_b32 v22, 16, v28
    v_mfma_f32_16x16x32_bf16 v[228:231], v[108:111], a[32:35], v[228:231]
    buffer_load_dwordx4 v17, s[20:23], s44 offen offset:3072 lds
    s_waitcnt lgkmcnt(0)
    v_mfma_f32_16x16x32_bf16 v[128:131], a[128:131], a[48:51], v[128:131]
    s_add_u32 m0, s43, 0
    s_mov_b32 s44, 458880
    v_mfma_f32_16x16x32_bf16 v[136:139], a[128:131], a[52:55], v[136:139]
    s_waitcnt vmcnt(16)
    v_cvt_pk_bf16_f32 v200, v200, v201
    v_mfma_f32_16x16x32_bf16 v[144:147], a[128:131], a[56:59], v[144:147]
    ds_read_b64_tr_b16 v[96:97], v2 offset:8192
    v_cvt_pk_bf16_f32 v201, v202, v203
    v_mfma_f32_16x16x32_bf16 v[152:155], a[128:131], a[60:63], v[152:155]
    buffer_load_dwordx4 v14, s[20:23], s44 offen offset:0 lds
    v_mfma_f32_16x16x32_bf16 v[156:159], a[132:135], a[60:63], v[156:159]
    ds_read_b64_tr_b16 v[98:99], v2 offset:10240
    v_cvt_pk_bf16_f32 v202, v204, v205
    v_mfma_f32_16x16x32_bf16 v[148:151], a[132:135], a[56:59], v[148:151]
    ds_read_b64_tr_b16 v[100:101], v3 offset:8192
    v_cvt_pk_bf16_f32 v203, v206, v207
    v_mfma_f32_16x16x32_bf16 v[140:143], a[132:135], a[52:55], v[140:143]
    ds_read_b64_tr_b16 v[102:103], v3 offset:10240
    buffer_store_dwordx4 v[200:203], v30, s[36:39], s17 offen sc1
    v_mfma_f32_16x16x32_bf16 v[132:135], a[132:135], a[48:51], v[132:135]
    buffer_load_dwordx4 v15, s[20:23], s44 offen offset:1024 lds
    v_mfma_f32_16x16x32_bf16 v[224:227], a[136:139], a[48:51], v[224:227]
    ds_read_b64_tr_b16 v[104:105], v4 offset:8192
    v_and_b32 v23, s51, v28
    v_mfma_f32_16x16x32_bf16 v[232:235], a[136:139], a[52:55], v[232:235]
    ds_read_b64_tr_b16 v[106:107], v4 offset:10240
    v_lshlrev_b32 v24, 16, v29
    v_mfma_f32_16x16x32_bf16 v[240:243], a[136:139], a[56:59], v[240:243]
    ds_read_b64_tr_b16 v[108:109], v5 offset:8192
    v_and_b32 v25, s51, v29
    v_mfma_f32_16x16x32_bf16 v[248:251], a[136:139], a[60:63], v[248:251]
    buffer_load_dwordx4 v16, s[20:23], s44 offen offset:2048 lds
    v_mfma_f32_16x16x32_bf16 v[252:255], a[140:143], a[60:63], v[252:255]
    ds_read_b64_tr_b16 v[110:111], v5 offset:10240
    v_add_f32 v112, v112, v18
    v_mfma_f32_16x16x32_bf16 v[244:247], a[140:143], a[56:59], v[244:247]
    v_add_f32 v113, v113, v19
    v_add_f32 v114, v114, v20
    v_mfma_f32_16x16x32_bf16 v[236:239], a[140:143], a[52:55], v[236:239]
    v_add_f32 v115, v115, v21
    v_add_f32 v116, v116, v22
    v_mfma_f32_16x16x32_bf16 v[228:231], a[140:143], a[48:51], v[228:231]
    buffer_load_dwordx4 v17, s[20:23], s44 offen offset:3072 lds
    s_waitcnt lgkmcnt(0)
    v_mfma_f32_16x16x32_bf16 v[128:131], a[144:147], a[64:67], v[128:131]
    s_add_u32 m0, s43, 8192
    s_mov_b32 s44, 491648
    v_mfma_f32_16x16x32_bf16 v[136:139], a[144:147], a[68:71], v[136:139]
    s_waitcnt vmcnt(17)
    v_cvt_pk_bf16_f32 v208, v208, v209
    v_mfma_f32_16x16x32_bf16 v[144:147], a[144:147], a[72:75], v[144:147]
    ds_read_b64_tr_b16 a[128:129], v2 offset:12288
    v_cvt_pk_bf16_f32 v209, v210, v211
    v_mfma_f32_16x16x32_bf16 v[152:155], a[144:147], a[76:79], v[152:155]
    buffer_load_dwordx4 v14, s[20:23], s44 offen offset:0 lds
    v_mfma_f32_16x16x32_bf16 v[156:159], a[148:151], a[76:79], v[156:159]
    ds_read_b64_tr_b16 a[130:131], v2 offset:14336
    v_cvt_pk_bf16_f32 v210, v212, v213
    v_mfma_f32_16x16x32_bf16 v[148:151], a[148:151], a[72:75], v[148:151]
    ds_read_b64_tr_b16 a[132:133], v3 offset:12288
    v_cvt_pk_bf16_f32 v211, v214, v215
    v_mfma_f32_16x16x32_bf16 v[140:143], a[148:151], a[68:71], v[140:143]
    ds_read_b64_tr_b16 a[134:135], v3 offset:14336
    buffer_store_dwordx4 v[208:211], v30, s[36:39], s18 offen sc1
    v_mfma_f32_16x16x32_bf16 v[132:135], a[148:151], a[64:67], v[132:135]
    buffer_load_dwordx4 v15, s[20:23], s44 offen offset:1024 lds
    v_mfma_f32_16x16x32_bf16 v[224:227], a[152:155], a[64:67], v[224:227]
    ds_read_b64_tr_b16 a[136:137], v4 offset:12288
    v_add_f32 v117, v117, v23
    v_mfma_f32_16x16x32_bf16 v[232:235], a[152:155], a[68:71], v[232:235]
    ds_read_b64_tr_b16 a[138:139], v4 offset:14336
    v_add_f32 v118, v118, v24
    v_mfma_f32_16x16x32_bf16 v[240:243], a[152:155], a[72:75], v[240:243]
    ds_read_b64_tr_b16 a[140:141], v5 offset:12288
    v_add_f32 v119, v119, v25
    v_mfma_f32_16x16x32_bf16 v[248:251], a[152:155], a[76:79], v[248:251]
    buffer_load_dwordx4 v16, s[20:23], s44 offen offset:2048 lds
    v_mfma_f32_16x16x32_bf16 v[252:255], a[156:159], a[76:79], v[252:255]
    ds_read_b64_tr_b16 a[142:143], v5 offset:14336
    v_accvgpr_read_b32 v26, a224
    v_mfma_f32_16x16x32_bf16 v[244:247], a[156:159], a[72:75], v[244:247]
    v_accvgpr_read_b32 v27, a225
    v_accvgpr_read_b32 v28, a226
    v_mfma_f32_16x16x32_bf16 v[236:239], a[156:159], a[68:71], v[236:239]
    v_accvgpr_read_b32 v29, a227
    v_lshlrev_b32 v120, 16, v26
    v_mfma_f32_16x16x32_bf16 v[228:231], a[156:159], a[64:67], v[228:231]
    buffer_load_dwordx4 v17, s[20:23], s44 offen offset:3072 lds
    s_waitcnt lgkmcnt(0)
    v_mfma_f32_16x16x32_bf16 v[128:131], a[160:163], a[80:83], v[128:131]
    s_waitcnt vmcnt(18)
    v_cvt_pk_bf16_f32 v216, v216, v217
    v_mfma_f32_16x16x32_bf16 v[136:139], a[160:163], a[84:87], v[136:139]
    ds_read_b64_tr_b16 a[144:145], v2 offset:16384
    v_cvt_pk_bf16_f32 v217, v218, v219
    v_mfma_f32_16x16x32_bf16 v[144:147], a[160:163], a[88:91], v[144:147]
    ds_read_b64_tr_b16 a[146:147], v2 offset:18432
    v_cvt_pk_bf16_f32 v218, v220, v221
    v_mfma_f32_16x16x32_bf16 v[152:155], a[160:163], a[92:95], v[152:155]
    ds_read_b64_tr_b16 a[148:149], v3 offset:16384
    v_cvt_pk_bf16_f32 v219, v222, v223
    v_mfma_f32_16x16x32_bf16 v[156:159], a[164:167], a[92:95], v[156:159]
    ds_read_b64_tr_b16 a[150:151], v3 offset:18432
    buffer_store_dwordx4 v[216:219], v30, s[36:39], s19 offen sc1
    v_mfma_f32_16x16x32_bf16 v[148:151], a[164:167], a[88:91], v[148:151]
    ds_read_b64_tr_b16 a[152:153], v4 offset:16384
    v_and_b32 v121, s51, v26
    v_mfma_f32_16x16x32_bf16 v[140:143], a[164:167], a[84:87], v[140:143]
    ds_read_b64_tr_b16 a[154:155], v4 offset:18432
    v_lshlrev_b32 v122, 16, v27
    v_mfma_f32_16x16x32_bf16 v[132:135], a[164:167], a[80:83], v[132:135]
    ds_read_b64_tr_b16 a[156:157], v5 offset:16384
    v_and_b32 v123, s51, v27
    v_mfma_f32_16x16x32_bf16 v[224:227], a[168:171], a[80:83], v[224:227]
    ds_read_b64_tr_b16 a[158:159], v5 offset:18432
    v_lshlrev_b32 v124, 16, v28
    v_mfma_f32_16x16x32_bf16 v[232:235], a[168:171], a[84:87], v[232:235]
    v_and_b32 v125, s51, v28
    v_lshlrev_b32 v126, 16, v29
    v_mfma_f32_16x16x32_bf16 v[240:243], a[168:171], a[88:91], v[240:243]
    v_and_b32 v127, s51, v29
    v_accvgpr_read_b32 v26, a228
    v_mfma_f32_16x16x32_bf16 v[248:251], a[168:171], a[92:95], v[248:251]
    v_accvgpr_read_b32 v27, a229
    v_accvgpr_read_b32 v28, a230
    v_mfma_f32_16x16x32_bf16 v[252:255], a[172:175], a[92:95], v[252:255]
    v_accvgpr_read_b32 v29, a231
    v_lshlrev_b32 v18, 16, v26
    v_mfma_f32_16x16x32_bf16 v[244:247], a[172:175], a[88:91], v[244:247]
    v_and_b32 v19, s51, v26
    v_lshlrev_b32 v20, 16, v27
    v_mfma_f32_16x16x32_bf16 v[236:239], a[172:175], a[84:87], v[236:239]
    v_and_b32 v21, s51, v27
    v_lshlrev_b32 v22, 16, v28
    v_mfma_f32_16x16x32_bf16 v[228:231], a[172:175], a[80:83], v[228:231]
    v_and_b32 v23, s51, v28
    v_lshlrev_b32 v24, 16, v29
    s_waitcnt lgkmcnt(0)
    v_mfma_f32_16x16x32_bf16 v[128:131], a[176:179], a[96:99], v[128:131]
    s_waitcnt vmcnt(15)
    v_cvt_pk_bf16_f32 v160, v160, v161
    v_mfma_f32_16x16x32_bf16 v[136:139], a[176:179], a[100:103], v[136:139]
    ds_read_b64_tr_b16 a[160:161], v2 offset:20480
    v_cvt_pk_bf16_f32 v161, v162, v163
    v_mfma_f32_16x16x32_bf16 v[144:147], a[176:179], a[104:107], v[144:147]
    ds_read_b64_tr_b16 a[162:163], v2 offset:22528
    v_cvt_pk_bf16_f32 v162, v164, v165
    v_mfma_f32_16x16x32_bf16 v[152:155], a[176:179], a[108:111], v[152:155]
    ds_read_b64_tr_b16 a[164:165], v3 offset:20480
    v_cvt_pk_bf16_f32 v163, v166, v167
    v_mfma_f32_16x16x32_bf16 v[156:159], a[180:183], a[108:111], v[156:159]
    ds_read_b64_tr_b16 a[166:167], v3 offset:22528
    buffer_store_dwordx4 v[160:163], v30, s[36:39], s24 offen sc1
    v_mfma_f32_16x16x32_bf16 v[148:151], a[180:183], a[104:107], v[148:151]
    ds_read_b64_tr_b16 a[168:169], v4 offset:20480
    v_and_b32 v25, s51, v29
    v_mfma_f32_16x16x32_bf16 v[140:143], a[180:183], a[100:103], v[140:143]
    ds_read_b64_tr_b16 a[170:171], v4 offset:22528
    v_add_f32 v120, v120, v18
    v_mfma_f32_16x16x32_bf16 v[132:135], a[180:183], a[96:99], v[132:135]
    ds_read_b64_tr_b16 a[172:173], v5 offset:20480
    v_add_f32 v121, v121, v19
    v_mfma_f32_16x16x32_bf16 v[224:227], a[184:187], a[96:99], v[224:227]
    ds_read_b64_tr_b16 a[174:175], v5 offset:22528
    v_add_f32 v122, v122, v20
    v_mfma_f32_16x16x32_bf16 v[232:235], a[184:187], a[100:103], v[232:235]
    v_add_f32 v123, v123, v21
    v_add_f32 v124, v124, v22
    v_mfma_f32_16x16x32_bf16 v[240:243], a[184:187], a[104:107], v[240:243]
    v_add_f32 v125, v125, v23
    v_add_f32 v126, v126, v24
    v_mfma_f32_16x16x32_bf16 v[248:251], a[184:187], a[108:111], v[248:251]
    v_add_f32 v127, v127, v25
    v_accvgpr_read_b32 v26, a232
    v_mfma_f32_16x16x32_bf16 v[252:255], a[188:191], a[108:111], v[252:255]
    v_accvgpr_read_b32 v27, a233
    v_accvgpr_read_b32 v28, a234
    v_mfma_f32_16x16x32_bf16 v[244:247], a[188:191], a[104:107], v[244:247]
    v_accvgpr_read_b32 v29, a235
    v_lshlrev_b32 v18, 16, v26
    v_mfma_f32_16x16x32_bf16 v[236:239], a[188:191], a[100:103], v[236:239]
    v_and_b32 v19, s51, v26
    v_lshlrev_b32 v20, 16, v27
    v_mfma_f32_16x16x32_bf16 v[228:231], a[188:191], a[96:99], v[228:231]
    v_and_b32 v21, s51, v27
    v_lshlrev_b32 v22, 16, v28
    s_waitcnt lgkmcnt(0)
    v_mfma_f32_16x16x32_bf16 v[128:131], v[64:67], a[112:115], v[128:131]
    ds_read_b128 a[0:3], v6 offset:32768
    v_cvt_pk_bf16_f32 v168, v168, v169
    v_mfma_f32_16x16x32_bf16 v[136:139], v[64:67], a[116:119], v[136:139]
    ds_read_b128 a[4:7], v6 offset:33792
    v_cvt_pk_bf16_f32 v169, v170, v171
    v_mfma_f32_16x16x32_bf16 v[144:147], v[64:67], a[120:123], v[144:147]
    ds_read_b128 a[8:11], v6 offset:34816
    v_cvt_pk_bf16_f32 v170, v172, v173
    v_mfma_f32_16x16x32_bf16 v[152:155], v[64:67], a[124:127], v[152:155]
    ds_read_b128 a[12:15], v6 offset:35840
    v_cvt_pk_bf16_f32 v171, v174, v175
L_pg11:
    s_cbranch_execz L_pgret
    v_mfma_f32_16x16x32_bf16 v[156:159], v[68:71], a[124:127], v[156:159]
    s_waitcnt vmcnt(12)
    buffer_store_dwordx4 v[168:171], v30, s[36:39], s25 offen sc1
    v_mfma_f32_16x16x32_bf16 v[148:151], v[68:71], a[120:123], v[148:151]
    ds_read_b64_tr_b16 a[176:177], v2 offset:4096
    v_and_b32 v23, s51, v28
    v_mfma_f32_16x16x32_bf16 v[140:143], v[68:71], a[116:119], v[140:143]
    ds_read_b64_tr_b16 a[178:179], v2 offset:6144
    v_lshlrev_b32 v24, 16, v29
    v_mfma_f32_16x16x32_bf16 v[132:135], v[68:71], a[112:115], v[132:135]
    ds_read_b64_tr_b16 a[180:181], v3 offset:4096
    v_and_b32 v25, s51, v29
    v_mfma_f32_16x16x32_bf16 v[224:227], v[72:75], a[112:115], v[224:227]
    ds_read_b64_tr_b16 a[182:183], v3 offset:6144
    v_add_f32 v120, v120, v18
    v_mfma_f32_16x16x32_bf16 v[232:235], v[72:75], a[116:119], v[232:235]
    ds_read_b64_tr_b16 a[184:185], v4 offset:4096
    v_add_f32 v121, v121, v19
    v_mfma_f32_16x16x32_bf16 v[240:243], v[72:75], a[120:123], v[240:243]
    ds_read_b64_tr_b16 a[186:187], v4 offset:6144
    v_add_f32 v122, v122, v20
    v_mfma_f32_16x16x32_bf16 v[248:251], v[72:75], a[124:127], v[248:251]
    ds_read_b64_tr_b16 a[188:189], v5 offset:4096
    v_add_f32 v123, v123, v21
    v_mfma_f32_16x16x32_bf16 v[252:255], v[76:79], a[124:127], v[252:255]
    ds_read_b64_tr_b16 a[190:191], v5 offset:6144
    v_add_f32 v124, v124, v22
    v_mfma_f32_16x16x32_bf16 v[244:247], v[76:79], a[120:123], v[244:247]
    v_add_f32 v125, v125, v23
    v_add_f32 v126, v126, v24
    v_mfma_f32_16x16x32_bf16 v[236:239], v[76:79], a[116:119], v[236:239]
    v_add_f32 v127, v127, v25
    v_accvgpr_read_b32 v26, a236
    v_mfma_f32_16x16x32_bf16 v[228:231], v[76:79], a[112:115], v[228:231]
    v_accvgpr_read_b32 v27, a237
    v_accvgpr_read_b32 v28, a238
    s_waitcnt lgkmcnt(0)
    v_mfma_f32_16x16x32_bf16 v[128:131], v[80:83], a[0:3], v[128:131]
    ds_read_b128 a[16:19], v7 offset:36864
    v_cvt_pk_bf16_f32 v176, v176, v177
    v_mfma_f32_16x16x32_bf16 v[136:139], v[80:83], a[4:7], v[136:139]
    ds_read_b128 a[20:23], v7 offset:37888
    v_cvt_pk_bf16_f32 v177, v178, v179
    v_mfma_f32_16x16x32_bf16 v[144:147], v[80:83], a[8:11], v[144:147]
    ds_read_b128 a[24:27], v7 offset:38912
    v_cvt_pk_bf16_f32 v178, v180, v181
    v_mfma_f32_16x16x32_bf16 v[152:155], v[80:83], a[12:15], v[152:155]
    ds_read_b128 a[28:31], v7 offset:39936
    v_cvt_pk_bf16_f32 v179, v182, v183
    v_mfma_f32_16x16x32_bf16 v[156:159], v[84:87], a[12:15], v[156:159]
    buffer_store_dwordx4 v[176:179], v30, s[36:39], s26 offen sc1
    v_mfma_f32_16x16x32_bf16 v[148:151], v[84:87], a[8:11], v[148:151]
    v_accvgpr_read_b32 v29, a239
    v_lshlrev_b32 v18, 16, v26
    v_mfma_f32_16x16x32_bf16 v[140:143], v[84:87], a[4:7], v[140:143]
    v_and_b32 v19, s51, v26
    v_lshlrev_b32 v20, 16, v27
    v_mfma_f32_16x16x32_bf16 v[132:135], v[84:87], a[0:3], v[132:135]
    v_and_b32 v21, s51, v27
    v_lshlrev_b32 v22, 16, v28
    v_mfma_f32_16x16x32_bf16 v[224:227], v[88:91], a[0:3], v[224:227]
    v_and_b32 v23, s51, v28
    v_lshlrev_b32 v24, 16, v29
    v_mfma_f32_16x16x32_bf16 v[232:235], v[88:91], a[4:7], v[232:235]
    v_and_b32 v25, s51, v29
    v_add_f32 v120, v120, v18
    v_mfma_f32_16x16x32_bf16 v[240:243], v[88:91], a[8:11], v[240:243]
    v_add_f32 v121, v121, v19
    v_add_f32 v122, v122, v20
    v_mfma_f32_16x16x32_bf16 v[248:251], v[88:91], a[12:15], v[248:251]
    v_add_f32 v123, v123, v21
    v_add_f32 v124, v124, v22
    v_mfma_f32_16x16x32_bf16 v[252:255], v[92:95], a[12:15], v[252:255]
    v_add_f32 v125, v125, v23
    v_add_f32 v126, v126, v24
    v_mfma_f32_16x16x32_bf16 v[244:247], v[92:95], a[8:11], v[244:247]
    v_add_f32 v127, v127, v25
    v_accvgpr_read_b32 v26, a240
    v_mfma_f32_16x16x32_bf16 v[236:239], v[92:95], a[4:7], v[236:239]
    v_accvgpr_read_b32 v27, a241
    v_accvgpr_read_b32 v28, a242
    v_mfma_f32_16x16x32_bf16 v[228:231], v[92:95], a[0:3], v[228:231]
    v_accvgpr_read_b32 v29, a243
    v_lshlrev_b32 v18, 16, v26
    s_waitcnt lgkmcnt(0)
    v_mfma_f32_16x16x32_bf16 v[128:131], v[96:99], a[16:19], v[128:131]
    ds_read_b128 a[32:35], v6 offset:40960
    v_cvt_pk_bf16_f32 v184, v184, v185
    v_mfma_f32_16x16x32_bf16 v[136:139], v[96:99], a[20:23], v[136:139]
    ds_read_b128 a[36:39], v6 offset:41984
    v_cvt_pk_bf16_f32 v185, v186, v187
    v_mfma_f32_16x16x32_bf16 v[144:147], v[96:99], a[24:27], v[144:147]
    ds_read_b128 a[40:43], v6 offset:43008
    v_cvt_pk_bf16_f32 v186, v188, v189
    v_mfma_f32_16x16x32_bf16 v[152:155], v[96:99], a[28:31], v[152:155]
    ds_read_b128 a[44:47], v6 offset:44032
    v_cvt_pk_bf16_f32 v187, v190, v191
    v_mfma_f32_16x16x32_bf16 v[156:159], v[100:103], a[28:31], v[156:159]
    s_waitcnt vmcnt(9)
    buffer_store_dwordx4 v[184:187], v30, s[36:39], s27 offen sc1
    v_mfma_f32_16x16x32_bf16 v[148:151], v[100:103], a[24:27], v[148:151]
    ds_read_b64_tr_b16 v[64:65], v2 offset:0
    v_and_b32 v19, s51, v26
    v_mfma_f32_16x16x32_bf16 v[140:143], v[100:103], a[20:23], v[140:143]
    ds_read_b64_tr_b16 v[66:67], v2 offset:2048
    v_lshlrev_b32 v20, 16, v27
    v_mfma_f32_16x16x32_bf16 v[132:135], v[100:103], a[16:19], v[132:135]
    ds_read_b64_tr_b16 v[68:69], v3 offset:0
    v_and_b32 v21, s51, v27
    v_mfma_f32_16x16x32_bf16 v[224:227], v[104:107], a[16:19], v[224:227]
    ds_read_b64_tr_b16 v[70:71], v3 offset:2048
    v_lshlrev_b32 v22, 16, v28
    v_mfma_f32_16x16x32_bf16 v[232:235], v[104:107], a[20:23], v[232:235]
    ds_read_b64_tr_b16 v[72:73], v4 offset:0
    v_and_b32 v23, s51, v28
    v_mfma_f32_16x16x32_bf16 v[240:243], v[104:107], a[24:27], v[240:243]
    ds_read_b64_tr_b16 v[74:75], v4 offset:2048
    v_lshlrev_b32 v24, 16, v29
    v_mfma_f32_16x16x32_bf16 v[248:251], v[104:107], a[28:31], v[248:251]
    ds_read_b64_tr_b16 v[76:77], v5 offset:0
    v_and_b32 v25, s51, v29
    v_mfma_f32_16x16x32_bf16 v[252:255], v[108:111], a[28:31], v[252:255]
    ds_read_b64_tr_b16 v[78:79], v5 offset:2048
    v_add_f32 v120, v120, v18
    v_mfma_f32_16x16x32_bf16 v[244:247], v[108:111], a[24:27], v[244:247]
    v_add_f32 v121, v121, v19
    v_add_f32 v122, v122, v20
    v_mfma_f32_16x16x32_bf16 v[236:239], v[108:111], a[20:23], v[236:239]
    v_add_f32 v123, v123, v21
    v_add_f32 v124, v124, v22
    v_mfma_f32_16x16x32_bf16 v[228:231], v[108:111], a[16:19], v[228:231]
    v_add_f32 v125, v125, v23
    v_add_f32 v126, v126, v24
    s_waitcnt lgkmcnt(0)
    v_mfma_f32_16x16x32_bf16 v[128:131], a[128:131], a[32:35], v[128:131]
    ds_read_b128 a[48:51], v7 offset:45056
    v_add_f32 v127, v127, v25
    v_mfma_f32_16x16x32_bf16 v[136:139], a[128:131], a[36:39], v[136:139]
    ds_read_b128 a[52:55], v7 offset:46080
    v_accvgpr_read_b32 v26, a244
    v_mfma_f32_16x16x32_bf16 v[144:147], a[128:131], a[40:43], v[144:147]
    ds_read_b128 a[56:59], v7 offset:47104
    v_accvgpr_read_b32 v27, a245
    v_mfma_f32_16x16x32_bf16 v[152:155], a[128:131], a[44:47], v[152:155]
    ds_read_b128 a[60:63], v7 offset:48128
    v_accvgpr_read_b32 v28, a246
    v_mfma_f32_16x16x32_bf16 v[156:159], a[132:135], a[44:47], v[156:159]
    s_waitcnt vmcnt(5)
    v_accvgpr_read_b32 v29, a247
    v_mfma_f32_16x16x32_bf16 v[148:151], a[132:135], a[40:43], v[148:151]
    ds_read_b64_tr_b16 v[80:81], v2 offset:8192
    v_lshlrev_b32 v18, 16, v26
    v_mfma_f32_16x16x32_bf16 v[140:143], a[132:135], a[36:39], v[140:143]
    ds_read_b64_tr_b16 v[82:83], v2 offset:10240
    v_and_b32 v19, s51, v26
    v_mfma_f32_16x16x32_bf16 v[132:135], a[132:135], a[32:35], v[132:135]
    ds_read_b64_tr_b16 v[84:85], v3 offset:8192
    v_lshlrev_b32 v20, 16, v27
    v_mfma_f32_16x16x32_bf16 v[224:227], a[136:139], a[32:35], v[224:227]
    ds_read_b64_tr_b16 v[86:87], v3 offset:10240
    v_and_b32 v21, s51, v27
    v_mfma_f32_16x16x32_bf16 v[232:235], a[136:139], a[36:39], v[232:235]
    ds_read_b64_tr_b16 v[88:89], v4 offset:8192
    v_lshlrev_b32 v22, 16, v28
    v_mfma_f32_16x16x32_bf16 v[240:243], a[136:139], a[40:43], v[240:243]
    ds_read_b64_tr_b16 v[90:91], v4 offset:10240
    v_and_b32 v23, s51, v28
    v_mfma_f32_16x16x32_bf16 v[248:251], a[136:139], a[44:47], v[248:251]
    ds_read_b64_tr_b16 v[92:93], v5 offset:8192
    v_lshlrev_b32 v24, 16, v29
    v_mfma_f32_16x16x32_bf16 v[252:255], a[140:143], a[44:47], v[252:255]
    ds_read_b64_tr_b16 v[94:95], v5 offset:10240
    v_and_b32 v25, s51, v29
    v_mfma_f32_16x16x32_bf16 v[244:247], a[140:143], a[40:43], v[244:247]
    v_add_f32 v120, v120, v18
    v_add_f32 v121, v121, v19
    v_mfma_f32_16x16x32_bf16 v[236:239], a[140:143], a[36:39], v[236:239]
    v_add_f32 v122, v122, v20
    v_add_f32 v123, v123, v21
    v_mfma_f32_16x16x32_bf16 v[228:231], a[140:143], a[32:35], v[228:231]
    v_add_f32 v124, v124, v22
    v_add_f32 v125, v125, v23
    s_waitcnt lgkmcnt(0)
    v_mfma_f32_16x16x32_bf16 v[128:131], a[144:147], a[48:51], v[128:131]
    ds_read_b128 a[64:67], v6 offset:49152
    buffer_load_dwordx2 v[46:47], v51, s[92:95], 0 offen offset:160
    v_mfma_f32_16x16x32_bf16 v[136:139], a[144:147], a[52:55], v[136:139]
    ds_read_b128 a[68:71], v6 offset:50176
    buffer_load_dwordx2 v[62:63], v50, s[4:7], s49 offen offset:160
    v_mfma_f32_16x16x32_bf16 v[144:147], a[144:147], a[56:59], v[144:147]
    ds_read_b128 a[72:75], v6 offset:51200
    buffer_load_dwordx2 v[44:45], v51, s[92:95], 0 offen offset:128
    v_mfma_f32_16x16x32_bf16 v[152:155], a[144:147], a[60:63], v[152:155]
    ds_read_b128 a[76:79], v6 offset:52224
    buffer_load_dwordx2 v[60:61], v50, s[4:7], s49 offen offset:128
    v_mfma_f32_16x16x32_bf16 v[156:159], a[148:151], a[60:63], v[156:159]
    buffer_load_dwordx2 v[42:43], v51, s[92:95], 0 offen offset:32
    v_mfma_f32_16x16x32_bf16 v[148:151], a[148:151], a[56:59], v[148:151]
    buffer_load_dwordx2 v[58:59], v50, s[4:7], s49 offen offset:32
    v_mfma_f32_16x16x32_bf16 v[140:143], a[148:151], a[52:55], v[140:143]
    buffer_load_dwordx2 v[40:41], v51, s[92:95], 0 offen offset:0
    v_mfma_f32_16x16x32_bf16 v[132:135], a[148:151], a[48:51], v[132:135]
    buffer_load_dwordx2 v[56:57], v50, s[4:7], s49 offen offset:0
    v_mfma_f32_16x16x32_bf16 v[224:227], a[152:155], a[48:51], v[224:227]
    v_add_f32 v126, v126, v24
    v_add_f32 v127, v127, v25
    v_mfma_f32_16x16x32_bf16 v[232:235], a[152:155], a[52:55], v[232:235]
    v_accvgpr_read_b32 v26, a248
    v_accvgpr_read_b32 v27, a249
    v_mfma_f32_16x16x32_bf16 v[240:243], a[152:155], a[56:59], v[240:243]
    v_accvgpr_read_b32 v28, a250
    v_accvgpr_read_b32 v29, a251
    v_mfma_f32_16x16x32_bf16 v[248:251], a[152:155], a[60:63], v[248:251]
    v_lshlrev_b32 v18, 16, v26
    v_and_b32 v19, s51, v26
    v_mfma_f32_16x16x32_bf16 v[252:255], a[156:159], a[60:63], v[252:255]
    v_lshlrev_b32 v20, 16, v27
    v_and_b32 v21, s51, v27
    v_mfma_f32_16x16x32_bf16 v[244:247], a[156:159], a[56:59], v[244:247]
    v_lshlrev_b32 v22, 16, v28
    v_and_b32 v23, s51, v28
    v_mfma_f32_16x16x32_bf16 v[236:239], a[156:159], a[52:55], v[236:239]
    v_lshlrev_b32 v24, 16, v29
    v_and_b32 v25, s51, v29
    v_mfma_f32_16x16x32_bf16 v[228:231], a[156:159], a[48:51], v[228:231]
    v_add_f32 v120, v120, v18
    v_add_f32 v121, v121, v19
    s_waitcnt lgkmcnt(0)
    v_mfma_f32_16x16x32_bf16 v[128:131], a[160:163], a[64:67], v[128:131]
    ds_read_b128 a[80:83], v7 offset:53248
    v_add_f32 v122, v122, v20
    v_mfma_f32_16x16x32_bf16 v[136:139], a[160:163], a[68:71], v[136:139]
    ds_read_b128 a[84:87], v7 offset:54272
    v_add_f32 v123, v123, v21
    v_mfma_f32_16x16x32_bf16 v[144:147], a[160:163], a[72:75], v[144:147]
    ds_read_b128 a[88:91], v7 offset:55296
    v_add_f32 v124, v124, v22
    v_mfma_f32_16x16x32_bf16 v[152:155], a[160:163], a[76:79], v[152:155]
    ds_read_b128 a[92:95], v7 offset:56320
    v_add_f32 v125, v125, v23
    v_mfma_f32_16x16x32_bf16 v[156:159], a[164:167], a[76:79], v[156:159]
    v_add_f32 v126, v126, v24
    v_add_f32 v127, v127, v25
    v_mfma_f32_16x16x32_bf16 v[148:151], a[164:167], a[72:75], v[148:151]
    v_accvgpr_read_b32 v26, a252
    v_accvgpr_read_b32 v27, a253
    v_mfma_f32_16x16x32_bf16 v[140:143], a[164:167], a[68:71], v[140:143]
    v_accvgpr_read_b32 v28, a254
    v_accvgpr_read_b32 v29, a255
    v_mfma_f32_16x16x32_bf16 v[132:135], a[164:167], a[64:67], v[132:135]
    v_lshlrev_b32 v18, 16, v26
    v_and_b32 v19, s51, v26
    v_mfma_f32_16x16x32_bf16 v[224:227], a[168:171], a[64:67], v[224:227]
    v_lshlrev_b32 v20, 16, v27
    v_and_b32 v21, s51, v27
    v_mfma_f32_16x16x32_bf16 v[232:235], a[168:171], a[68:71], v[232:235]
    v_lshlrev_b32 v22, 16, v28
    v_and_b32 v23, s51, v28
    v_mfma_f32_16x16x32_bf16 v[240:243], a[168:171], a[72:75], v[240:243]
    v_lshlrev_b32 v24, 16, v29
    v_and_b32 v25, s51, v29
    v_mfma_f32_16x16x32_bf16 v[248:251], a[168:171], a[76:79], v[248:251]
    v_add_f32 v120, v120, v18
    v_add_f32 v121, v121, v19
    v_mfma_f32_16x16x32_bf16 v[252:255], a[172:175], a[76:79], v[252:255]
    v_add_f32 v122, v122, v20
    v_add_f32 v123, v123, v21
    v_mfma_f32_16x16x32_bf16 v[244:247], a[172:175], a[72:75], v[244:247]
    v_add_f32 v124, v124, v22
    v_add_f32 v125, v125, v23
    v_mfma_f32_16x16x32_bf16 v[236:239], a[172:175], a[68:71], v[236:239]
    v_add_f32 v126, v126, v24
    v_add_f32 v127, v127, v25
    v_mfma_f32_16x16x32_bf16 v[228:231], a[172:175], a[64:67], v[228:231]
    s_waitcnt lgkmcnt(0)
    v_mfma_f32_16x16x32_bf16 v[128:131], a[176:179], a[80:83], v[128:131]
    ds_read_b128 a[96:99], v6 offset:57344
    v_mfma_f32_16x16x32_bf16 v[136:139], a[176:179], a[84:87], v[136:139]
    ds_read_b128 a[100:103], v6 offset:58368
    v_mfma_f32_16x16x32_bf16 v[144:147], a[176:179], a[88:91], v[144:147]
    ds_read_b128 a[104:107], v6 offset:59392
    v_mfma_f32_16x16x32_bf16 v[152:155], a[176:179], a[92:95], v[152:155]
    ds_read_b128 a[108:111], v6 offset:60416
    v_mfma_f32_16x16x32_bf16 v[156:159], a[180:183], a[92:95], v[156:159]
    ds_read_b128 a[112:115], v7 offset:61440
    v_mfma_f32_16x16x32_bf16 v[148:151], a[180:183], a[88:91], v[148:151]
    ds_read_b128 a[116:119], v7 offset:62464
    v_mfma_f32_16x16x32_bf16 v[140:143], a[180:183], a[84:87], v[140:143]
    ds_read_b128 a[120:123], v7 offset:63488
    v_mfma_f32_16x16x32_bf16 v[132:135], a[180:183], a[80:83], v[132:135]
    ds_read_b128 a[124:127], v7 offset:64512
    v_mfma_f32_16x16x32_bf16 v[224:227], a[184:187], a[80:83], v[224:227]
    v_mfma_f32_16x16x32_bf16 v[232:235], a[184:187], a[84:87], v[232:235]
    v_mfma_f32_16x16x32_bf16 v[240:243], a[184:187], a[88:91], v[240:243]
    v_mfma_f32_16x16x32_bf16 v[248:251], a[184:187], a[92:95], v[248:251]
    v_mfma_f32_16x16x32_bf16 v[252:255], a[188:191], a[92:95], v[252:255]
    v_mfma_f32_16x16x32_bf16 v[244:247], a[188:191], a[88:91], v[244:247]
    v_mfma_f32_16x16x32_bf16 v[236:239], a[188:191], a[84:87], v[236:239]
    v_mfma_f32_16x16x32_bf16 v[228:231], a[188:191], a[80:83], v[228:231]
    s_waitcnt lgkmcnt(0)
    v_mfma_f32_16x16x32_bf16 v[136:139], v[64:67], a[100:103], v[136:139]
    v_mfma_f32_16x16x32_bf16 v[140:143], v[68:71], a[100:103], v[140:143]
    v_mfma_f32_16x16x32_bf16 v[136:139], v[80:83], a[116:119], v[136:139]
    v_mfma_f32_16x16x32_bf16 v[140:143], v[84:87], a[116:119], v[140:143]
    v_mfma_f32_16x16x32_bf16 v[144:147], v[64:67], a[104:107], v[144:147]
    s_nop 1
    v_mfma_f32_16x16x32_bf16 v[148:151], v[68:71], a[104:107], v[148:151]
    v_mfma_f32_16x16x32_bf16 v[144:147], v[80:83], a[120:123], v[144:147]
    v_mfma_f32_16x16x32_bf16 v[148:151], v[84:87], a[120:123], v[148:151]
    v_mfma_f32_16x16x32_bf16 v[152:155], v[64:67], a[108:111], v[152:155]
    v_cvt_pk_bf16_f32 v136, v136, v137
    v_cvt_pk_bf16_f32 v137, v138, v139
    v_cvt_pk_bf16_f32 v138, v140, v141
    v_mfma_f32_16x16x32_bf16 v[156:159], v[68:71], a[108:111], v[156:159]
    v_cvt_pk_bf16_f32 v139, v142, v143
    v_mfma_f32_16x16x32_bf16 v[152:155], v[80:83], a[124:127], v[152:155]
    buffer_store_dwordx4 v[136:139], v31, s[36:39], s17 offen sc1
    v_mfma_f32_16x16x32_bf16 v[156:159], v[84:87], a[124:127], v[156:159]
    v_mfma_f32_16x16x32_bf16 v[224:227], v[72:75], a[96:99], v[224:227]
    v_cvt_pk_bf16_f32 v144, v144, v145
    v_cvt_pk_bf16_f32 v145, v146, v147
    v_cvt_pk_bf16_f32 v146, v148, v149
    v_mfma_f32_16x16x32_bf16 v[228:231], v[76:79], a[96:99], v[228:231]
    v_cvt_pk_bf16_f32 v147, v150, v151
    v_mfma_f32_16x16x32_bf16 v[224:227], v[88:91], a[112:115], v[224:227]
    buffer_store_dwordx4 v[144:147], v31, s[36:39], s18 offen sc1
    v_mfma_f32_16x16x32_bf16 v[228:231], v[92:95], a[112:115], v[228:231]
    v_mfma_f32_16x16x32_bf16 v[232:235], v[72:75], a[100:103], v[232:235]
    v_cvt_pk_bf16_f32 v152, v152, v153
    v_cvt_pk_bf16_f32 v153, v154, v155
    v_cvt_pk_bf16_f32 v154, v156, v157
    v_mfma_f32_16x16x32_bf16 v[236:239], v[76:79], a[100:103], v[236:239]
    v_cvt_pk_bf16_f32 v155, v158, v159
    v_mfma_f32_16x16x32_bf16 v[232:235], v[88:91], a[116:119], v[232:235]
    buffer_store_dwordx4 v[152:155], v31, s[36:39], s19 offen sc1
    v_mfma_f32_16x16x32_bf16 v[236:239], v[92:95], a[116:119], v[236:239]
    v_mfma_f32_16x16x32_bf16 v[240:243], v[72:75], a[104:107], v[240:243]
    v_cvt_pk_bf16_f32 v224, v224, v225
    v_cvt_pk_bf16_f32 v225, v226, v227
    v_cvt_pk_bf16_f32 v226, v228, v229
    v_mfma_f32_16x16x32_bf16 v[244:247], v[76:79], a[104:107], v[244:247]
    v_cvt_pk_bf16_f32 v227, v230, v231
    v_mfma_f32_16x16x32_bf16 v[240:243], v[88:91], a[120:123], v[240:243]
    buffer_store_dwordx4 v[224:227], v31, s[36:39], s24 offen sc1
    v_mfma_f32_16x16x32_bf16 v[244:247], v[92:95], a[120:123], v[244:247]
    v_mfma_f32_16x16x32_bf16 v[248:251], v[72:75], a[108:111], v[248:251]
    v_cvt_pk_bf16_f32 v232, v232, v233
    v_cvt_pk_bf16_f32 v233, v234, v235
    v_cvt_pk_bf16_f32 v234, v236, v237
    v_mfma_f32_16x16x32_bf16 v[252:255], v[76:79], a[108:111], v[252:255]
    v_cvt_pk_bf16_f32 v235, v238, v239
    v_mfma_f32_16x16x32_bf16 v[248:251], v[88:91], a[124:127], v[248:251]
    buffer_store_dwordx4 v[232:235], v31, s[36:39], s25 offen sc1
    v_mfma_f32_16x16x32_bf16 v[252:255], v[92:95], a[124:127], v[252:255]
    v_mfma_f32_16x16x32_bf16 v[128:131], v[64:67], a[96:99], v[128:131]
    v_cvt_pk_bf16_f32 v240, v240, v241
    v_cvt_pk_bf16_f32 v241, v242, v243
    v_cvt_pk_bf16_f32 v242, v244, v245
    v_mfma_f32_16x16x32_bf16 v[132:135], v[68:71], a[96:99], v[132:135]
    v_cvt_pk_bf16_f32 v243, v246, v247
    v_mfma_f32_16x16x32_bf16 v[128:131], v[80:83], a[112:115], v[128:131]
    buffer_store_dwordx4 v[240:243], v31, s[36:39], s26 offen sc1
    v_mfma_f32_16x16x32_bf16 v[132:135], v[84:87], a[112:115], v[132:135]
    v_cvt_pk_bf16_f32 v248, v248, v249
    v_cvt_pk_bf16_f32 v249, v250, v251
    v_cvt_pk_bf16_f32 v250, v252, v253
    v_cvt_pk_bf16_f32 v251, v254, v255
    buffer_store_dwordx4 v[248:251], v31, s[36:39], s27 offen sc1
    s_waitcnt vmcnt(7)
    v_lshlrev_b32 v18, 16, v40
    v_and_b32 v19, s51, v40
    v_lshlrev_b32 v20, 16, v41
    v_and_b32 v21, s51, v41
    v_lshlrev_b32 v22, 16, v42
    v_and_b32 v23, s51, v42
    v_lshlrev_b32 v24, 16, v43
    v_and_b32 v25, s51, v43
    v_fma_f32 v112, v112, s46, v18
    v_fma_f32 v113, v113, s46, v19
    v_fma_f32 v114, v114, s46, v20
    v_fma_f32 v115, v115, s46, v21
    v_fma_f32 v116, v116, s46, v22
    v_fma_f32 v117, v117, s46, v23
    v_fma_f32 v118, v118, s46, v24
    v_fma_f32 v119, v119, s46, v25
    v_mul_f32 v18, 0xbfb8aa3b, v112
    v_mul_f32 v19, 0xbfb8aa3b, v113
    v_mul_f32 v20, 0xbfb8aa3b, v114
    v_mul_f32 v21, 0xbfb8aa3b, v115
    v_mul_f32 v22, 0xbfb8aa3b, v116
    v_mul_f32 v23, 0xbfb8aa3b, v117
    v_mul_f32 v24, 0xbfb8aa3b, v118
    v_mul_f32 v25, 0xbfb8aa3b, v119
    v_exp_f32 v18, v18
    v_exp_f32 v19, v19
    v_exp_f32 v20, v20
    v_exp_f32 v21, v21
    v_exp_f32 v22, v22
    buffer_load_dwordx4 v[160:163], v30, s[88:91], 0 offen offset:1024 sc1
    buffer_load_dwordx4 v[164:167], v30, s[88:91], 0 offen offset:2048 sc1
    buffer_load_dwordx4 v[168:171], v30, s[88:91], 0 offen offset:3072 sc1
    buffer_load_dwordx4 v[172:175], v30, s[88:91], s56 offen offset:0 sc1
    buffer_load_dwordx4 v[176:179], v30, s[88:91], s56 offen offset:1024 sc1
    buffer_load_dwordx4 v[180:183], v30, s[88:91], s56 offen offset:2048 sc1
    buffer_load_dwordx4 v[184:187], v30, s[88:91], s56 offen offset:3072 sc1
    v_exp_f32 v23, v23
    v_exp_f32 v24, v24
    v_exp_f32 v25, v25
    v_add_f32 v18, 1.0, v18
    v_add_f32 v19, 1.0, v19
    v_add_f32 v20, 1.0, v20
    v_add_f32 v21, 1.0, v21
    v_add_f32 v22, 1.0, v22
    v_add_f32 v23, 1.0, v23
    v_add_f32 v24, 1.0, v24
    v_add_f32 v25, 1.0, v25
    v_rcp_f32 v18, v18
    v_rcp_f32 v19, v19
    v_rcp_f32 v20, v20
    v_rcp_f32 v21, v21
    v_rcp_f32 v22, v22
    v_rcp_f32 v23, v23
    v_rcp_f32 v24, v24
    v_rcp_f32 v25, v25
    v_mul_f32 v112, v112, v18
    v_mul_f32 v113, v113, v19
    v_mul_f32 v114, v114, v20
    v_mul_f32 v115, v115, v21
    v_mul_f32 v116, v116, v22
    v_mul_f32 v117, v117, v23
    v_mul_f32 v118, v118, v24
    v_mul_f32 v119, v119, v25
    v_lshlrev_b32 v18, 16, v44
    v_and_b32 v19, s51, v44
    v_lshlrev_b32 v20, 16, v45
    buffer_load_dwordx4 v[200:203], v31, s[88:91], 0 offen offset:1024 sc1
    buffer_load_dwordx4 v[204:207], v31, s[88:91], 0 offen offset:2048 sc1
    buffer_load_dwordx4 v[208:211], v31, s[88:91], 0 offen offset:3072 sc1
    buffer_load_dwordx4 v[212:215], v31, s[88:91], s56 offen offset:0 sc1
    buffer_load_dwordx4 v[216:219], v31, s[88:91], s56 offen offset:1024 sc1
    buffer_load_dwordx4 v[220:223], v31, s[88:91], s56 offen offset:2048 sc1
    buffer_load_dwordx4 v[188:191], v31, s[88:91], s56 offen offset:3072 sc1
    v_and_b32 v21, s51, v45
    v_lshlrev_b32 v22, 16, v46
    v_and_b32 v23, s51, v46
    v_lshlrev_b32 v24, 16, v47
    v_and_b32 v25, s51, v47
    v_fma_f32 v120, v120, s46, v18
    v_fma_f32 v121, v121, s46, v19
    v_fma_f32 v122, v122, s46, v20
    v_fma_f32 v123, v123, s46, v21
    v_fma_f32 v124, v124, s46, v22
    v_fma_f32 v125, v125, s46, v23
    v_fma_f32 v126, v126, s46, v24
    v_fma_f32 v127, v127, s46, v25
    v_mul_f32 v18, 0xbfb8aa3b, v120
    v_mul_f32 v19, 0xbfb8aa3b, v121
    v_mul_f32 v20, 0xbfb8aa3b, v122
    v_mul_f32 v21, 0xbfb8aa3b, v123
    v_mul_f32 v22, 0xbfb8aa3b, v124
    v_mul_f32 v23, 0xbfb8aa3b, v125
    v_mul_f32 v24, 0xbfb8aa3b, v126
    v_mul_f32 v25, 0xbfb8aa3b, v127
    v_exp_f32 v18, v18
    v_exp_f32 v19, v19
    v_exp_f32 v20, v20
    v_exp_f32 v21, v21
    v_exp_f32 v22, v22
    v_exp_f32 v23, v23
    v_exp_f32 v24, v24
    v_exp_f32 v25, v25
    v_add_f32 v18, 1.0, v18
    v_add_f32 v19, 1.0, v19
    v_add_f32 v20, 1.0, v20
    v_add_f32 v21, 1.0, v21
    v_add_f32 v22, 1.0, v22
    v_add_f32 v23, 1.0, v23
    v_add_f32 v24, 1.0, v24
    v_add_f32 v25, 1.0, v25
    v_rcp_f32 v18, v18
    v_rcp_f32 v19, v19
    v_rcp_f32 v20, v20
    v_rcp_f32 v21, v21
    v_rcp_f32 v22, v22
    v_rcp_f32 v23, v23
    v_rcp_f32 v24, v24
    v_rcp_f32 v25, v25
    v_mul_f32 v120, v120, v18
    v_mul_f32 v121, v121, v19
    v_mul_f32 v122, v122, v20
    v_mul_f32 v123, v123, v21
    v_mul_f32 v124, v124, v22
    v_mul_f32 v125, v125, v23
    v_mul_f32 v126, v126, v24
    v_mul_f32 v127, v127, v25
    s_mov_b64 s[52:53], -1
    s_mov_b32 s47, 0
    v_lshlrev_b32 v88, 16, v56
    v_and_b32 v89, s51, v56
    v_lshlrev_b32 v90, 16, v57
    v_and_b32 v91, s51, v57
    v_lshlrev_b32 v92, 16, v58
    v_and_b32 v93, s51, v58
    v_lshlrev_b32 v94, 16, v59
    v_and_b32 v95, s51, v59
    v_lshlrev_b32 v96, 16, v60
    v_and_b32 v97, s51, v60
    v_lshlrev_b32 v98, 16, v61
    v_and_b32 v99, s51, v61
    v_lshlrev_b32 v100, 16, v62
    v_and_b32 v101, s51, v62
    v_lshlrev_b32 v102, 16, v63
    v_and_b32 v103, s51, v63
L_sum:
    s_waitcnt vmcnt(13)
    v_lshlrev_b32 v80, 16, v160
    v_and_b32 v81, s51, v160
    v_lshlrev_b32 v82, 16, v161
    v_and_b32 v83, s51, v161
    v_lshlrev_b32 v84, 16, v162
    v_and_b32 v85, s51, v162
    v_lshlrev_b32 v86, 16, v163
    v_and_b32 v87, s51, v163
    v_pk_add_f32 v[64:65], v[192:193], v[80:81]
    v_pk_add_f32 v[66:67], v[194:195], v[82:83]
    v_pk_add_f32 v[68:69], v[196:197], v[84:85]
    v_pk_add_f32 v[70:71], v[198:199], v[86:87]
    s_waitcnt vmcnt(12)
    v_lshlrev_b32 v80, 16, v164
    v_and_b32 v81, s51, v164
    v_lshlrev_b32 v82, 16, v165
    v_and_b32 v83, s51, v165
    v_lshlrev_b32 v84, 16, v166
    v_and_b32 v85, s51, v166
    v_lshlrev_b32 v86, 16, v167
    v_and_b32 v87, s51, v167
    v_pk_add_f32 v[64:65], v[64:65], v[80:81]
    v_pk_add_f32 v[66:67], v[66:67], v[82:83]
    v_pk_add_f32 v[68:69], v[68:69], v[84:85]
    v_pk_add_f32 v[70:71], v[70:71], v[86:87]
    s_waitcnt vmcnt(11)
    v_lshlrev_b32 v80, 16, v168
    v_and_b32 v81, s51, v168
    v_lshlrev_b32 v82, 16, v169
    v_and_b32 v83, s51, v169
    v_lshlrev_b32 v84, 16, v170
    v_and_b32 v85, s51, v170
    v_lshlrev_b32 v86, 16, v171
    v_and_b32 v87, s51, v171
    v_pk_add_f32 v[64:65], v[64:65], v[80:81]
    v_pk_add_f32 v[66:67], v[66:67], v[82:83]
    v_pk_add_f32 v[68:69], v[68:69], v[84:85]
    v_pk_add_f32 v[70:71], v[70:71], v[86:87]
    s_waitcnt vmcnt(10)
    v_lshlrev_b32 v80, 16, v172
    v_and_b32 v81, s51, v172
    v_lshlrev_b32 v82, 16, v173
    v_and_b32 v83, s51, v173
    v_lshlrev_b32 v84, 16, v174
    v_and_b32 v85, s51, v174
    v_lshlrev_b32 v86, 16, v175
    v_and_b32 v87, s51, v175
    v_pk_add_f32 v[64:65], v[64:65], v[80:81]
    v_pk_add_f32 v[66:67], v[66:67], v[82:83]
    v_pk_add_f32 v[68:69], v[68:69], v[84:85]
    v_pk_add_f32 v[70:71], v[70:71], v[86:87]
    s_waitcnt vmcnt(9)
    v_lshlrev_b32 v80, 16, v176
    v_and_b32 v81, s51, v176
    v_lshlrev_b32 v82, 16, v177
    v_and_b32 v83, s51, v177
    v_lshlrev_b32 v84, 16, v178
    v_and_b32 v85, s51, v178
    v_lshlrev_b32 v86, 16, v179
    v_and_b32 v87, s51, v179
    v_pk_add_f32 v[64:65], v[64:65], v[80:81]
    v_pk_add_f32 v[66:67], v[66:67], v[82:83]
    v_pk_add_f32 v[68:69], v[68:69], v[84:85]
    v_pk_add_f32 v[70:71], v[70:71], v[86:87]
    s_waitcnt vmcnt(8)
    v_lshlrev_b32 v80, 16, v180
    v_and_b32 v81, s51, v180
    v_lshlrev_b32 v82, 16, v181
    v_and_b32 v83, s51, v181
    v_lshlrev_b32 v84, 16, v182
    v_and_b32 v85, s51, v182
    v_lshlrev_b32 v86, 16, v183
    v_and_b32 v87, s51, v183
    v_pk_add_f32 v[64:65], v[64:65], v[80:81]
    v_pk_add_f32 v[66:67], v[66:67], v[82:83]
    v_pk_add_f32 v[68:69], v[68:69], v[84:85]
    v_pk_add_f32 v[70:71], v[70:71], v[86:87]
    s_waitcnt vmcnt(7)
    v_lshlrev_b32 v80, 16, v184
    v_and_b32 v81, s51, v184
    v_lshlrev_b32 v82, 16, v185
    v_and_b32 v83, s51, v185
    v_lshlrev_b32 v84, 16, v186
    v_and_b32 v85, s51, v186
    v_lshlrev_b32 v86, 16, v187
    v_and_b32 v87, s51, v187
    v_pk_add_f32 v[64:65], v[64:65], v[80:81]
    v_pk_add_f32 v[66:67], v[66:67], v[82:83]
    v_pk_add_f32 v[68:69], v[68:69], v[84:85]
    v_pk_add_f32 v[70:71], v[70:71], v[86:87]
    v_pk_add_f32 v[80:81], v[64:65], v[66:67]
    v_pk_add_f32 v[82:83], v[68:69], v[70:71]
    v_pk_add_f32 v[80:81], v[80:81], v[82:83]
    v_cmp_u_f32 vcc, v80, v81
    v_pk_fma_f32 v[64:65], v[64:65], v[112:113], v[88:89]
    v_pk_fma_f32 v[66:67], v[66:67], v[114:115], v[90:91]
    v_pk_fma_f32 v[68:69], v[68:69], v[116:117], v[92:93]
    v_pk_fma_f32 v[70:71], v[70:71], v[118:119], v[94:95]
    s_and_b64 vcc, vcc, s[52:53]
    s_cbranch_scc1 L_miss0
    v_cvt_pk_bf16_f32 v104, v64, v65
    v_cvt_pk_bf16_f32 v105, v66, v67
    v_cvt_pk_bf16_f32 v106, v68, v69
    v_cvt_pk_bf16_f32 v107, v70, v71
    s_nop 0
    v_permlane16_swap_b32 v104, v106
    v_permlane16_swap_b32 v105, v107
    buffer_store_dwordx4 v[104:107], v52, s[96:99], s49 offen offset:0
    s_mov_b32 s55, 0xffff
    s_cmp_lg_u32 s47, 0
    s_cbranch_scc1 L_missl
L_sum1:
    s_waitcnt vmcnt(7)
    v_lshlrev_b32 v80, 16, v200
    v_and_b32 v81, s51, v200
    v_lshlrev_b32 v82, 16, v201
    v_and_b32 v83, s51, v201
    v_lshlrev_b32 v84, 16, v202
    v_and_b32 v85, s51, v202
    v_lshlrev_b32 v86, 16, v203
    v_and_b32 v87, s51, v203
    v_pk_add_f32 v[72:73], v[128:129], v[80:81]
    v_pk_add_f32 v[74:75], v[130:131], v[82:83]
    v_pk_add_f32 v[76:77], v[132:133], v[84:85]
    v_pk_add_f32 v[78:79], v[134:135], v[86:87]
    s_waitcnt vmcnt(6)
    v_lshlrev_b32 v80, 16, v204
    v_and_b32 v81, s51, v204
    v_lshlrev_b32 v82, 16, v205
    v_and_b32 v83, s51, v205
    v_lshlrev_b32 v84, 16, v206
    v_and_b32 v85, s51, v206
    v_lshlrev_b32 v86, 16, v207
    v_and_b32 v87, s51, v207
    v_pk_add_f32 v[72:73], v[72:73], v[80:81]
    v_pk_add_f32 v[74:75], v[74:75], v[82:83]
    v_pk_add_f32 v[76:77], v[76:77], v[84:85]
    v_pk_add_f32 v[78:79], v[78:79], v[86:87]
    s_waitcnt vmcnt(5)
    v_lshlrev_b32 v80, 16, v208
    v_and_b32 v81, s51, v208
    v_lshlrev_b32 v82, 16, v209
    v_and_b32 v83, s51, v209
    v_lshlrev_b32 v84, 16, v210
    v_and_b32 v85, s51, v210
    v_lshlrev_b32 v86, 16, v211
    v_and_b32 v87, s51, v211
    v_pk_add_f32 v[72:73], v[72:73], v[80:81]
L_pg12:
    s_cbranch_execz L_pgret
    v_pk_add_f32 v[74:75], v[74:75], v[82:83]
    v_pk_add_f32 v[76:77], v[76:77], v[84:85]
    v_pk_add_f32 v[78:79], v[78:79], v[86:87]
    s_waitcnt vmcnt(4)
    v_lshlrev_b32 v80, 16, v212
    v_and_b32 v81, s51, v212
    v_lshlrev_b32 v82, 16, v213
    v_and_b32 v83, s51, v213
    v_lshlrev_b32 v84, 16, v214
    v_and_b32 v85, s51, v214
    v_lshlrev_b32 v86, 16, v215
    v_and_b32 v87, s51, v215
    v_pk_add_f32 v[72:73], v[72:73], v[80:81]
    v_pk_add_f32 v[74:75], v[74:75], v[82:83]
    v_pk_add_f32 v[76:77], v[76:77], v[84:85]
    v_pk_add_f32 v[78:79], v[78:79], v[86:87]
    s_waitcnt vmcnt(3)
    v_lshlrev_b32 v80, 16, v216
    v_and_b32 v81, s51, v216
    v_lshlrev_b32 v82, 16, v217
    v_and_b32 v83, s51, v217
    v_lshlrev_b32 v84, 16, v218
    v_and_b32 v85, s51, v218
    v_lshlrev_b32 v86, 16, v219
    v_and_b32 v87, s51, v219
    v_pk_add_f32 v[72:73], v[72:73], v[80:81]
    v_pk_add_f32 v[74:75], v[74:75], v[82:83]
    v_pk_add_f32 v[76:77], v[76:77], v[84:85]
    v_pk_add_f32 v[78:79], v[78:79], v[86:87]
    s_waitcnt vmcnt(2)
    v_lshlrev_b32 v80, 16, v220
    v_and_b32 v81, s51, v220
    v_lshlrev_b32 v82, 16, v221
    v_and_b32 v83, s51, v221
    v_lshlrev_b32 v84, 16, v222
    v_and_b32 v85, s51, v222
    v_lshlrev_b32 v86, 16, v223
    v_and_b32 v87, s51, v223
    v_pk_add_f32 v[72:73], v[72:73], v[80:81]
    v_pk_add_f32 v[74:75], v[74:75], v[82:83]
    v_pk_add_f32 v[76:77], v[76:77], v[84:85]
    v_pk_add_f32 v[78:79], v[78:79], v[86:87]
    s_waitcnt vmcnt(1)
    v_lshlrev_b32 v80, 16, v188
    v_and_b32 v81, s51, v188
    v_lshlrev_b32 v82, 16, v189
    v_and_b32 v83, s51, v189
    v_lshlrev_b32 v84, 16, v190
    v_and_b32 v85, s51, v190
    v_lshlrev_b32 v86, 16, v191
    v_and_b32 v87, s51, v191
    v_pk_add_f32 v[72:73], v[72:73], v[80:81]
    v_pk_add_f32 v[74:75], v[74:75], v[82:83]
    v_pk_add_f32 v[76:77], v[76:77], v[84:85]
    v_pk_add_f32 v[78:79], v[78:79], v[86:87]
    v_pk_add_f32 v[80:81], v[72:73], v[74:75]
    v_pk_add_f32 v[82:83], v[76:77], v[78:79]
    v_pk_add_f32 v[80:81], v[80:81], v[82:83]
    v_cmp_u_f32 vcc, v80, v81
    v_pk_fma_f32 v[72:73], v[72:73], v[120:121], v[96:97]
    v_pk_fma_f32 v[74:75], v[74:75], v[122:123], v[98:99]
    v_pk_fma_f32 v[76:77], v[76:77], v[124:125], v[100:101]
    v_pk_fma_f32 v[78:79], v[78:79], v[126:127], v[102:103]
    s_and_b64 vcc, vcc, s[52:53]
    s_cbranch_scc1 L_miss1
    v_cvt_pk_bf16_f32 v108, v72, v73
    v_cvt_pk_bf16_f32 v109, v74, v75
    v_cvt_pk_bf16_f32 v110, v76, v77
    v_cvt_pk_bf16_f32 v111, v78, v79
    s_nop 0
    v_permlane16_swap_b32 v108, v110
    v_permlane16_swap_b32 v109, v111
    buffer_store_dwordx4 v[108:111], v52, s[96:99], s49 offen offset:128
L_main_end:
    s_endpgm
L_spin_gate:
    s_mov_b32 s45, 200000
L_spinl_gate:
    buffer_load_dword v54, v51, s[64:67], 0 offen sc1
    s_waitcnt vmcnt(0)
    v_cmp_le_u32 vcc, 1, v54
    s_sub_u32 s45, s45, 1
    s_cbranch_scc1 L_ok_gate
    s_cmp_eq_u64 vcc, -1
    s_cbranch_scc0 L_spinl_gate
    s_branch L_ok_gate
L_spin_f:
    s_mov_b32 s45, 200000
L_spinl_f:
    buffer_load_dword v55, v11, s[60:63], 0 offen sc1
    s_waitcnt vmcnt(0)
    v_cmp_le_u32 vcc, 1, v55
    s_sub_u32 s45, s45, 1
    s_cbranch_scc1 L_ok_f
    s_cmp_eq_u64 vcc, -1
    s_cbranch_scc0 L_spinl_f
    s_branch L_ok_f
L_miss0:
    s_mov_b32 s47, 0xfefe
    s_mov_b32 s55, 0xff
    s_branch L_miss
L_miss1:
    s_mov_b32 s47, 0xfe00
L_miss:
    s_mov_b32 s46, 0xff81ff81
    s_mov_b32 s45, 200000
L_missl:
    s_waitcnt vmcnt(0)
    s_bitcmp1_b32 s47, 1
    s_cbranch_scc0 L_have1
    v_cmp_eq_u32 vcc, s46, v160
    v_cmp_eq_u32 s[52:53], s46, v161
    v_cmp_eq_u32 s[70:71], s46, v162
    s_or_b64 s[52:53], vcc, s[52:53]
    v_cmp_eq_u32 vcc, s46, v163
    s_or_b64 s[70:71], s[70:71], s[52:53]
    s_bitset0_b32 s47, 1
    s_or_b64 s[70:71], s[70:71], vcc
    s_cbranch_scc0 L_have1
    s_bitset1_b32 s47, 1
    buffer_load_dwordx4 v[160:163], v30, s[88:91], 0 offen offset:1024 sc1
L_have1:
    s_bitcmp1_b32 s47, 2
    s_cbranch_scc0 L_have2
    v_cmp_eq_u32 vcc, s46, v164
    v_cmp_eq_u32 s[52:53], s46, v165
    v_cmp_eq_u32 s[70:71], s46, v166
    s_or_b64 s[52:53], vcc, s[52:53]
    v_cmp_eq_u32 vcc, s46, v167
    s_or_b64 s[70:71], s[70:71], s[52:53]
    s_bitset0_b32 s47, 2
    s_or_b64 s[70:71], s[70:71], vcc
    s_cbranch_scc0 L_have2
    s_bitset1_b32 s47, 2
    buffer_load_dwordx4 v[164:167], v30, s[88:91], 0 offen offset:2048 sc1
L_have2:
    s_bitcmp1_b32 s47, 3
    s_cbranch_scc0 L_have3
    v_cmp_eq_u32 vcc, s46, v168
    v_cmp_eq_u32 s[52:53], s46, v169
    v_cmp_eq_u32 s[70:71], s46, v170
    s_or_b64 s[52:53], vcc, s[52:53]
    v_cmp_eq_u32 vcc, s46, v171
    s_or_b64 s[70:71], s[70:71], s[52:53]
    s_bitset0_b32 s47, 3
    s_or_b64 s[70:71], s[70:71], vcc
    s_cbranch_scc0 L_have3
    s_bitset1_b32 s47, 3
    buffer_load_dwordx4 v[168:171], v30, s[88:91], 0 offen offset:3072 sc1
L_have3:
    s_bitcmp1_b32 s47, 4
    s_cbranch_scc0 L_have4
    v_cmp_eq_u32 vcc, s46, v172
    v_cmp_eq_u32 s[52:53], s46, v173
    v_cmp_eq_u32 s[70:71], s46, v174
    s_or_b64 s[52:53], vcc, s[52:53]
    v_cmp_eq_u32 vcc, s46, v175
    s_or_b64 s[70:71], s[70:71], s[52:53]
    s_bitset0_b32 s47, 4
    s_or_b64 s[70:71], s[70:71], vcc
    s_cbranch_scc0 L_have4
    s_bitset1_b32 s47, 4
    buffer_load_dwordx4 v[172:175], v30, s[88:91], s56 offen offset:0 sc1
L_have4:
    s_bitcmp1_b32 s47, 5
    s_cbranch_scc0 L_have5
    v_cmp_eq_u32 vcc, s46, v176
    v_cmp_eq_u32 s[52:53], s46, v177
    v_cmp_eq_u32 s[70:71], s46, v178
    s_or_b64 s[52:53], vcc, s[52:53]
    v_cmp_eq_u32 vcc, s46, v179
    s_or_b64 s[70:71], s[70:71], s[52:53]
    s_bitset0_b32 s47, 5
    s_or_b64 s[70:71], s[70:71], vcc
    s_cbranch_scc0 L_have5
    s_bitset1_b32 s47, 5
    buffer_load_dwordx4 v[176:179], v30, s[88:91], s56 offen offset:1024 sc1
L_have5:
    s_bitcmp1_b32 s47, 6
    s_cbranch_scc0 L_have6
    v_cmp_eq_u32 vcc, s46, v180
    v_cmp_eq_u32 s[52:53], s46, v181
    v_cmp_eq_u32 s[70:71], s46, v182
    s_or_b64 s[52:53], vcc, s[52:53]
    v_cmp_eq_u32 vcc, s46, v183
    s_or_b64 s[70:71], s[70:71], s[52:53]
    s_bitset0_b32 s47, 6
    s_or_b64 s[70:71], s[70:71], vcc
    s_cbranch_scc0 L_have6
    s_bitset1_b32 s47, 6
    buffer_load_dwordx4 v[180:183], v30, s[88:91], s56 offen offset:2048 sc1
L_have6:
    s_bitcmp1_b32 s47, 7
    s_cbranch_scc0 L_have7
    v_cmp_eq_u32 vcc, s46, v184
    v_cmp_eq_u32 s[52:53], s46, v185
    v_cmp_eq_u32 s[70:71], s46, v186
    s_or_b64 s[52:53], vcc, s[52:53]
    v_cmp_eq_u32 vcc, s46, v187
    s_or_b64 s[70:71], s[70:71], s[52:53]
    s_bitset0_b32 s47, 7
    s_or_b64 s[70:71], s[70:71], vcc
    s_cbranch_scc0 L_have7
    s_bitset1_b32 s47, 7
    buffer_load_dwordx4 v[184:187], v30, s[88:91], s56 offen offset:3072 sc1
L_have7:
    s_bitcmp1_b32 s47, 9
    s_cbranch_scc0 L_have9
    v_cmp_eq_u32 vcc, s46, v200
    v_cmp_eq_u32 s[52:53], s46, v201
    v_cmp_eq_u32 s[70:71], s46, v202
    s_or_b64 s[52:53], vcc, s[52:53]
    v_cmp_eq_u32 vcc, s46, v203
    s_or_b64 s[70:71], s[70:71], s[52:53]
    s_bitset0_b32 s47, 9
    s_or_b64 s[70:71], s[70:71], vcc
    s_cbranch_scc0 L_have9
    s_bitset1_b32 s47, 9
    buffer_load_dwordx4 v[200:203], v31, s[88:91], 0 offen offset:1024 sc1
L_have9:
    s_bitcmp1_b32 s47, 10
    s_cbranch_scc0 L_have10
    v_cmp_eq_u32 vcc, s46, v204
    v_cmp_eq_u32 s[52:53], s46, v205
    v_cmp_eq_u32 s[70:71], s46, v206
    s_or_b64 s[52:53], vcc, s[52:53]
    v_cmp_eq_u32 vcc, s46, v207
    s_or_b64 s[70:71], s[70:71], s[52:53]
    s_bitset0_b32 s47, 10
    s_or_b64 s[70:71], s[70:71], vcc
    s_cbranch_scc0 L_have10
    s_bitset1_b32 s47, 10
    buffer_load_dwordx4 v[204:207], v31, s[88:91], 0 offen offset:2048 sc1
L_have10:
    s_bitcmp1_b32 s47, 11
    s_cbranch_scc0 L_have11
    v_cmp_eq_u32 vcc, s46, v208
    v_cmp_eq_u32 s[52:53], s46, v209
    v_cmp_eq_u32 s[70:71], s46, v210
    s_or_b64 s[52:53], vcc, s[52:53]
    v_cmp_eq_u32 vcc, s46, v211
    s_or_b64 s[70:71], s[70:71], s[52:53]
    s_bitset0_b32 s47, 11
    s_or_b64 s[70:71], s[70:71], vcc
    s_cbranch_scc0 L_have11
    s_bitset1_b32 s47, 11
    buffer_load_dwordx4 v[208:211], v31, s[88:91], 0 offen offset:3072 sc1
L_have11:
    s_bitcmp1_b32 s47, 12
    s_cbranch_scc0 L_have12
    v_cmp_eq_u32 vcc, s46, v212
    v_cmp_eq_u32 s[52:53], s46, v213
    v_cmp_eq_u32 s[70:71], s46, v214
    s_or_b64 s[52:53], vcc, s[52:53]
    v_cmp_eq_u32 vcc, s46, v215
    s_or_b64 s[70:71], s[70:71], s[52:53]
    s_bitset0_b32 s47, 12
    s_or_b64 s[70:71], s[70:71], vcc
    s_cbranch_scc0 L_have12
    s_bitset1_b32 s47, 12
    buffer_load_dwordx4 v[212:215], v31, s[88:91], s56 offen offset:0 sc1
L_have12:
    s_bitcmp1_b32 s47, 13
    s_cbranch_scc0 L_have13
    v_cmp_eq_u32 vcc, s46, v216
    v_cmp_eq_u32 s[52:53], s46, v217
    v_cmp_eq_u32 s[70:71], s46, v218
    s_or_b64 s[52:53], vcc, s[52:53]
    v_cmp_eq_u32 vcc, s46, v219
    s_or_b64 s[70:71], s[70:71], s[52:53]
    s_bitset0_b32 s47, 13
    s_or_b64 s[70:71], s[70:71], vcc
    s_cbranch_scc0 L_have13
    s_bitset1_b32 s47, 13
    buffer_load_dwordx4 v[216:219], v31, s[88:91], s56 offen offset:1024 sc1
L_have13:
    s_bitcmp1_b32 s47, 14
    s_cbranch_scc0 L_have14
    v_cmp_eq_u32 vcc, s46, v220
    v_cmp_eq_u32 s[52:53], s46, v221
    v_cmp_eq_u32 s[70:71], s46, v222
    s_or_b64 s[52:53], vcc, s[52:53]
    v_cmp_eq_u32 vcc, s46, v223
    s_or_b64 s[70:71], s[70:71], s[52:53]
    s_bitset0_b32 s47, 14
    s_or_b64 s[70:71], s[70:71], vcc
    s_cbranch_scc0 L_have14
    s_bitset1_b32 s47, 14
    buffer_load_dwordx4 v[220:223], v31, s[88:91], s56 offen offset:2048 sc1
L_have14:
    s_bitcmp1_b32 s47, 15
    s_cbranch_scc0 L_have15
    v_cmp_eq_u32 vcc, s46, v188
    v_cmp_eq_u32 s[52:53], s46, v189
    v_cmp_eq_u32 s[70:71], s46, v190
    s_or_b64 s[52:53], vcc, s[52:53]
    v_cmp_eq_u32 vcc, s46, v191
    s_or_b64 s[70:71], s[70:71], s[52:53]
    s_bitset0_b32 s47, 15
    s_or_b64 s[70:71], s[70:71], vcc
    s_cbranch_scc0 L_have15
    s_bitset1_b32 s47, 15
    buffer_load_dwordx4 v[188:191], v31, s[88:91], s56 offen offset:3072 sc1
L_have15:
    s_sub_u32 s45, s45, 1
    s_cbranch_scc0 L_missc
    s_waitcnt vmcnt(0)
    s_mov_b32 s47, 0
L_missc:
    s_and_b32 s70, s47, s55
    s_cbranch_scc1 L_missl
    s_mov_b64 s[52:53], 0
    s_cmp_eq_u32 s55, 0xff
    s_cbranch_scc1 L_sum
    s_branch L_sum1
L_slow:
    s_waitcnt vmcnt(0) lgkmcnt(0)
    s_barrier
    s_mov_b32 s54, 1
    s_branch L_restart
L_maxpass:
    s_mov_b32 s48, 0
    s_mov_b32 s45, 16
    v_mov_b32 v32, 0xff800000
    v_mov_b32 v33, 0xff800000
    v_mov_b32 v34, 0xff800000
    v_mov_b32 v35, 0xff800000
L_slow_loop:
    s_add_u32 m0, s50, 49152
    s_nop 0
    buffer_load_dwordx4 v26, s[8:11], s48 offen lds
    buffer_load_dwordx4 v27, s[8:11], s48 offen offset:1024 lds
    s_waitcnt vmcnt(0)
    s_barrier
    ds_read_b128 a[160:163], v18 offset:16384
    ds_read_b128 a[164:167], v18 offset:20480
    ds_read_b128 a[168:171], v19 offset:16384
    ds_read_b128 a[172:175], v19 offset:20480
    ds_read_b128 a[176:179], v20 offset:16384
    ds_read_b128 a[180:183], v20 offset:20480
    ds_read_b128 a[184:187], v21 offset:16384
    ds_read_b128 a[188:191], v21 offset:20480
    s_waitcnt lgkmcnt(0)
    s_barrier
    v_mfma_f32_16x16x32_bf16 v[224:227], a[160:163], v[64:67], 0
    v_mfma_f32_16x16x32_bf16 v[232:235], a[160:163], v[68:71], 0
    v_mfma_f32_16x16x32_bf16 v[228:231], a[164:167], v[64:67], 0
    v_mfma_f32_16x16x32_bf16 v[236:239], a[164:167], v[68:71], 0
    v_mfma_f32_16x16x32_bf16 v[224:227], a[168:171], v[80:83], v[224:227]
    v_mfma_f32_16x16x32_bf16 v[232:235], a[168:171], v[84:87], v[232:235]
    v_mfma_f32_16x16x32_bf16 v[228:231], a[172:175], v[80:83], v[228:231]
    v_mfma_f32_16x16x32_bf16 v[236:239], a[172:175], v[84:87], v[236:239]
    v_mfma_f32_16x16x32_bf16 v[224:227], a[176:179], v[96:99], v[224:227]
    v_mfma_f32_16x16x32_bf16 v[232:235], a[176:179], v[100:103], v[232:235]
    v_mfma_f32_16x16x32_bf16 v[228:231], a[180:183], v[96:99], v[228:231]
    v_mfma_f32_16x16x32_bf16 v[236:239], a[180:183], v[100:103], v[236:239]
    v_mfma_f32_16x16x32_bf16 v[224:227], a[184:187], v[112:115], v[224:227]
    v_mfma_f32_16x16x32_bf16 v[232:235], a[184:187], v[116:119], v[232:235]
    v_mfma_f32_16x16x32_bf16 v[228:231], a[188:191], v[112:115], v[228:231]
    v_mfma_f32_16x16x32_bf16 v[236:239], a[188:191], v[116:119], v[236:239]
    v_mfma_f32_16x16x32_bf16 v[240:243], a[160:163], v[72:75], 0
    v_mfma_f32_16x16x32_bf16 v[248:251], a[160:163], v[76:79], 0
    v_mfma_f32_16x16x32_bf16 v[244:247], a[164:167], v[72:75], 0
    v_mfma_f32_16x16x32_bf16 v[252:255], a[164:167], v[76:79], 0
    v_mfma_f32_16x16x32_bf16 v[240:243], a[168:171], v[88:91], v[240:243]
    v_mfma_f32_16x16x32_bf16 v[248:251], a[168:171], v[92:95], v[248:251]
    v_mfma_f32_16x16x32_bf16 v[244:247], a[172:175], v[88:91], v[244:247]
    v_mfma_f32_16x16x32_bf16 v[252:255], a[172:175], v[92:95], v[252:255]
    v_mfma_f32_16x16x32_bf16 v[240:243], a[176:179], v[104:107], v[240:243]
    v_mfma_f32_16x16x32_bf16 v[248:251], a[176:179], v[108:111], v[248:251]
    v_mfma_f32_16x16x32_bf16 v[244:247], a[180:183], v[104:107], v[244:247]
    v_mfma_f32_16x16x32_bf16 v[252:255], a[180:183], v[108:111], v[252:255]
    v_mfma_f32_16x16x32_bf16 v[240:243], a[184:187], v[120:123], v[240:243]
    v_mfma_f32_16x16x32_bf16 v[248:251], a[184:187], v[124:127], v[248:251]
    v_mfma_f32_16x16x32_bf16 v[244:247], a[188:191], v[120:123], v[244:247]
    v_mfma_f32_16x16x32_bf16 v[252:255], a[188:191], v[124:127], v[252:255]
    s_nop 7
    s_nop 7
    s_add_u32 s48, s48, 8192
    v_max3_f32 v32, v32, v224, v225
    v_max3_f32 v32, v32, v226, v227
    v_max3_f32 v32, v32, v228, v229
    v_max3_f32 v32, v32, v230, v231
    v_max3_f32 v33, v33, v232, v233
    v_max3_f32 v33, v33, v234, v235
    v_max3_f32 v33, v33, v236, v237
    v_max3_f32 v33, v33, v238, v239
    v_max3_f32 v34, v34, v240, v241
    v_max3_f32 v34, v34, v242, v243
    v_max3_f32 v34, v34, v244, v245
    v_max3_f32 v34, v34, v246, v247
    v_max3_f32 v35, v35, v248, v249
    v_max3_f32 v35, v35, v250, v251
    v_max3_f32 v35, v35, v252, v253
    v_max3_f32 v35, v35, v254, v255
    s_sub_u32 s45, s45, 1
    s_cmp_lg_u32 s45, 0
    s_cbranch_scc1 L_slow_loop
    v_mov_b32 v50, v32
    s_nop 1
    v_permlane32_swap_b32 v32, v50
    s_nop 0
    v_max_f32 v32, v32, v50
    v_mov_b32 v50, v32
    s_nop 1
    v_permlane16_swap_b32 v32, v50
    s_nop 0
    v_max_f32 v32, v32, v50
    v_mov_b32 v50, v33
    s_nop 1
    v_permlane32_swap_b32 v33, v50
    s_nop 0
    v_max_f32 v33, v33, v50
    v_mov_b32 v50, v33
    s_nop 1
    v_permlane16_swap_b32 v33, v50
    s_nop 0
    v_max_f32 v33, v33, v50
    v_mov_b32 v50, v34
    s_nop 1
    v_permlane32_swap_b32 v34, v50
    s_nop 0
    v_max_f32 v34, v34, v50
    v_mov_b32 v50, v34
    s_nop 1
    v_permlane16_swap_b32 v34, v50
    s_nop 0
    v_max_f32 v34, v34, v50
    v_mov_b32 v50, v35
    s_nop 1
    v_permlane32_swap_b32 v35, v50
    s_nop 0
    v_max_f32 v35, v35, v50
    v_mov_b32 v50, v35
    s_nop 1
    v_permlane16_swap_b32 v35, v50
    s_nop 0
    v_max_f32 v35, v35, v50
    s_branch L_maxret
L_code_end:
.section .rodata,"a"
.p2align 6
.amdhsa_kernel recurrent_scan__sliding_block_cached__dense_activation_squared_relu__prompt_kernel
  .amdhsa_next_free_vgpr 512
  .amdhsa_next_free_sgpr 102
  .amdhsa_accum_offset 256
  .amdhsa_group_segment_fixed_size 0
  .amdhsa_kernarg_size 104
  .amdhsa_user_sgpr_count 2
  .amdhsa_user_sgpr_kernarg_segment_ptr 1
  .amdhsa_system_sgpr_workgroup_id_x 1
.end_amdhsa_kernel
```
